```python
import torch

def _softmax(x, axis=-1):
    return torch.softmax(x, dim=axis)
def _gelu(x):
    return torch.nn.functional.gelu(x, approximate="tanh")
def _silu(x):
    return torch.nn.functional.silu(x)
def _sigmoid(x):
    return torch.sigmoid(x)
def _layernorm(x, axis=-1, eps=1e-5):
    m = x.mean(dim=axis, keepdim=True)
    v = x.var(dim=axis, keepdim=True, unbiased=False)
    return (x - m) / torch.sqrt(v + eps)
def _scatter_add(tgt, idx, src, axis=0):
    return tgt.clone().index_add_(axis, idx, src)
def _segment_sum(src, seg, n):
    out = torch.zeros((n,) + src.shape[1:], dtype=src.dtype)
    return out.index_add_(0, seg, src)
def _pad(x, pw):
    flat = tuple(v for pair in reversed(pw) for v in pair)
    return torch.nn.functional.pad(x, flat)

kernel_name = 'parallel_sum__compressed_kv_cla__mixer_token_mlp__prompt'

def setup_inputs():

    _w = (lambda a: (lambda t: t.to(torch.bfloat16) if t.is_floating_point() else t)(torch.as_tensor(a)))
    def _A_setup():
        B, H, Sq, Sk, D, M = 1, 32, 2048, 2048, 128, 640
        Dc = 4 * D
        return {
            "x": _w((lambda *s: torch.randn(*s, dtype=torch.bfloat16) * 0.05)(B, Sq, M)),
            "c_kv": _w((lambda *s: torch.randn(*s, dtype=torch.bfloat16) * 0.2)(B, Sk, Dc)),
            "w_q": _w((lambda *s: torch.randn(*s, dtype=torch.bfloat16) * 6.4)(M, H, D) * (M ** -0.5)),
            "w_uk": _w((lambda *s: torch.randn(*s, dtype=torch.bfloat16) * 6.4)(Dc, H, D) * (Dc ** -0.5)),
            "w_uv": _w((lambda *s: torch.randn(*s, dtype=torch.bfloat16) * 0.2)(Dc, H, D) * (Dc ** -0.5)),
            "w_o": _w((lambda *s: torch.randn(*s, dtype=torch.bfloat16) * 0.2)(H, D, M) * ((H * D) ** -0.5)),
        }
    _A_in = _A_setup()

    def _B_setup():
        B, S, D, F = 1, 2048, 640, 1728
        return {
            "x": _w((lambda *s: torch.randn(*s, dtype=torch.bfloat16) * 0.05)(B, S, D)),
            "w1": _w((lambda *s: torch.randn(*s, dtype=torch.bfloat16) * 0.4)(S, F) * (S ** -0.5)),
            "b1": _w((lambda *s: torch.randn(*s, dtype=torch.bfloat16) * 3.2)(F) * 0.02),
            "w2": _w((lambda *s: torch.randn(*s, dtype=torch.bfloat16) * 0.2)(F, S) * (F ** -0.5)),
            "b2": _w((lambda *s: torch.randn(*s, dtype=torch.bfloat16) * 0.8)(S) * 0.02),
        }
    _B_in = _B_setup()

    return {
        "A_x": _A_in["x"],
        "A_c_kv": _A_in["c_kv"],
        "A_w_q": _A_in["w_q"],
        "A_w_uk": _A_in["w_uk"],
        "A_w_uv": _A_in["w_uv"],
        "A_w_o": _A_in["w_o"],
        "B_x": _B_in["x"],
        "B_w1": _B_in["w1"],
        "B_b1": _B_in["b1"],
        "B_w2": _B_in["w2"],
        "B_b2": _B_in["b2"],
    }

def reference(A_x, A_c_kv, A_w_q, A_w_uk, A_w_uv, A_w_o, B_x, B_w1, B_b1, B_w2, B_b2):
    def _A_ref(x, c_kv, w_q, w_uk, w_uv, w_o):
        B, Sq, M = x.shape[0], x.shape[1], x.shape[2]
        Sk = c_kv.shape[1]
        H, D = w_q.shape[1], w_q.shape[2]
        q = torch.einsum("bqm,mhd->bhqd", x, w_q)
        k = torch.einsum("bkc,chd->bhkd", c_kv, w_uk)
        v = torch.einsum("bkc,chd->bhkd", c_kv, w_uv)
        scores = torch.einsum("bhqd,bhkd->bhqk", q, k) * (D ** -0.5)
        off = Sk - Sq
        qi = torch.arange(Sq)[:, None]
        kj = torch.arange(Sk)[None, :]
        cmask = kj <= (qi + off)
        scores = torch.where(cmask[None, None], scores, -1e9)
        p = _softmax(scores, axis=-1)
        ctx = torch.einsum("bhqk,bhkd->bhqd", p, v)
        return torch.einsum("bhqd,hdm->bqm", ctx, w_o)

    def _B_ref(x, w1, b1, w2, b2):
        B, S, D = x.shape
        h = _layernorm(x, axis=-1)
        u = torch.einsum("bsd,sf->bdf", h, w1) + b1
        u = _gelu(u)
        y = torch.einsum("bdf,fs->bds", u, w2) + b2
        return (lambda x, *d: x.permute(*d))(y, 0, 2, 1)

    x = A_x
    xn = _layernorm(x, axis=-1)
    return x + _A_ref(xn, A_c_kv, A_w_q, A_w_uk, A_w_uv, A_w_o) + _B_ref(xn, B_w1, B_b1, B_w2, B_b2)
```

```asm
; @launch kernel=ln_kernel grid=(512,1,1) block=(512,1,1) lds=16384
; @launch kernel=gemm1_kernel grid=(424,1,1) block=(512,1,1) lds=131072
; @launch kernel=attn_kernel grid=(256,1,1) block=(512,1,1) lds=131072
; @launch kernel=final_kernel grid=(240,1,1) block=(256,1,1) lds=65536
; @launch kernel=comb_kernel grid=(640,1,1) block=(256,1,1) lds=0
.amdgcn_target "amdgcn-amd-amdhsa--gfx950"
.text
.globl ln_kernel
.type ln_kernel,@function
.p2align 8
ln_kernel:
    s_load_dwordx4 s[16:19], s[0:1], 0
    s_load_dwordx2 s[20:21], s[0:1], 104
    s_cmp_ge_u32 s2, 512
    s_cbranch_scc1 LN_done_1
    s_cmp_ge_u32 s2, 256
    s_cbranch_scc1 LN_ckv_2
    v_and_b32 v1, 63, v0
    v_lshrrev_b32 v2, 6, v0
    s_lshl_b32 s3, s2, 3
    v_add_u32 v3, s3, v2
    v_mul_u32_u24 v4, 1280, v3
    v_lshl_add_u32 v4, v1, 2, v4
    v_lshrrev_b32 v5, 3, v1
    v_lshlrev_b32 v5, 16, v5
    v_lshl_add_u32 v5, v3, 5, v5
    v_bfe_u32 v6, v1, 2, 1
    v_bfe_u32 v7, v3, 3, 1
    v_xor_b32 v6, v6, v7
    v_lshl_add_u32 v5, v6, 4, v5
    v_and_b32 v6, 3, v1
    v_lshl_add_u32 v5, v6, 2, v5
    s_waitcnt lgkmcnt(0)
    s_mov_b32 s4, s16
    s_and_b32 s5, s17, 0xffff
    s_mov_b32 s6, 0x280000
    s_mov_b32 s7, 0x00020000
    s_mov_b32 s8, s20
    s_and_b32 s9, s21, 0xffff
    s_mov_b32 s10, 0x280000
    s_mov_b32 s11, 0x00020000
    s_add_u32 s12, s20, 0x280000
    s_addc_u32 s13, s21, 0
    s_and_b32 s13, s13, 0xffff
    s_mov_b32 s14, 0x300000
    s_mov_b32 s15, 0x00020000
    buffer_load_dword v10, v4, s[4:7], 0 offen offset:0
    buffer_load_dword v11, v4, s[4:7], 0 offen offset:256
    buffer_load_dword v12, v4, s[4:7], 0 offen offset:512
    buffer_load_dword v13, v4, s[4:7], 0 offen offset:768
    buffer_load_dword v14, v4, s[4:7], 0 offen offset:1024
    s_waitcnt vmcnt(0)
    v_lshlrev_b32 v16, 16, v10
    v_and_b32 v17, 0xffff0000, v10
    v_lshlrev_b32 v18, 16, v11
    v_and_b32 v19, 0xffff0000, v11
    v_lshlrev_b32 v20, 16, v12
    v_and_b32 v21, 0xffff0000, v12
    v_lshlrev_b32 v22, 16, v13
    v_and_b32 v23, 0xffff0000, v13
    v_lshlrev_b32 v24, 16, v14
    v_and_b32 v25, 0xffff0000, v14
    v_add_f32 v26, v16, v17
    v_add_f32 v26, v26, v18
    v_add_f32 v26, v26, v19
    v_add_f32 v26, v26, v20
    v_add_f32 v26, v26, v21
    v_add_f32 v26, v26, v22
    v_add_f32 v26, v26, v23
    v_add_f32 v26, v26, v24
    v_add_f32 v26, v26, v25
    ds_swizzle_b32 v28, v26 offset:0x41f
    s_waitcnt lgkmcnt(0)
    v_add_f32 v26, v26, v28
    ds_swizzle_b32 v28, v26 offset:0x81f
    s_waitcnt lgkmcnt(0)
    v_add_f32 v26, v26, v28
    ds_swizzle_b32 v28, v26 offset:0x101f
    s_waitcnt lgkmcnt(0)
    v_add_f32 v26, v26, v28
    ds_swizzle_b32 v28, v26 offset:0x201f
    s_waitcnt lgkmcnt(0)
    v_add_f32 v26, v26, v28
    ds_swizzle_b32 v28, v26 offset:0x401f
    s_waitcnt lgkmcnt(0)
    v_add_f32 v26, v26, v28
    v_mov_b32 v28, v26
    s_nop 1
    v_permlane32_swap_b32 v28, v26
    v_add_f32 v26, v26, v28
    v_mul_f32 v27, 0x3acccccd, v26
    v_sub_f32 v28, v16, v27
    v_mul_f32 v26, v28, v28
    v_sub_f32 v28, v17, v27
    v_fmac_f32 v26, v28, v28
    v_sub_f32 v28, v18, v27
    v_fmac_f32 v26, v28, v28
    v_sub_f32 v28, v19, v27
    v_fmac_f32 v26, v28, v28
    v_sub_f32 v28, v20, v27
    v_fmac_f32 v26, v28, v28
    v_sub_f32 v28, v21, v27
    v_fmac_f32 v26, v28, v28
    v_sub_f32 v28, v22, v27
    v_fmac_f32 v26, v28, v28
    v_sub_f32 v28, v23, v27
    v_fmac_f32 v26, v28, v28
    v_sub_f32 v28, v24, v27
    v_fmac_f32 v26, v28, v28
    v_sub_f32 v28, v25, v27
    v_fmac_f32 v26, v28, v28
    ds_swizzle_b32 v28, v26 offset:0x41f
    s_waitcnt lgkmcnt(0)
    v_add_f32 v26, v26, v28
    ds_swizzle_b32 v28, v26 offset:0x81f
    s_waitcnt lgkmcnt(0)
    v_add_f32 v26, v26, v28
    ds_swizzle_b32 v28, v26 offset:0x101f
    s_waitcnt lgkmcnt(0)
    v_add_f32 v26, v26, v28
    ds_swizzle_b32 v28, v26 offset:0x201f
    s_waitcnt lgkmcnt(0)
    v_add_f32 v26, v26, v28
    ds_swizzle_b32 v28, v26 offset:0x401f
    s_waitcnt lgkmcnt(0)
    v_add_f32 v26, v26, v28
    v_mov_b32 v28, v26
    s_nop 1
    v_permlane32_swap_b32 v28, v26
    v_add_f32 v26, v26, v28
    v_mul_f32 v26, 0x3acccccd, v26
    v_cvt_pk_bf16_f32 v26, v26, v26
    v_lshlrev_b32 v26, 16, v26
    v_add_f32 v26, 0x3727c5ac, v26
    v_cvt_pk_bf16_f32 v26, v26, v26
    v_lshlrev_b32 v26, 16, v26
    v_sqrt_f32 v26, v26
    s_nop 0
    v_cvt_pk_bf16_f32 v26, v26, v26
    v_lshlrev_b32 v26, 16, v26
    v_rcp_f32 v26, v26
    v_cvt_pk_bf16_f32 v27, v27, v27
    v_lshlrev_b32 v27, 16, v27
    v_sub_f32 v16, v16, v27
    v_cvt_pk_bf16_f32 v16, v16, v16
    v_lshlrev_b32 v16, 16, v16
    v_mul_f32 v16, v16, v26
    v_cvt_pk_bf16_f32 v16, v16, v16
    v_lshlrev_b32 v16, 16, v16
    v_sub_f32 v17, v17, v27
    v_cvt_pk_bf16_f32 v17, v17, v17
    v_lshlrev_b32 v17, 16, v17
    v_mul_f32 v17, v17, v26
    v_cvt_pk_bf16_f32 v17, v17, v17
    v_lshlrev_b32 v17, 16, v17
    v_sub_f32 v18, v18, v27
    v_cvt_pk_bf16_f32 v18, v18, v18
    v_lshlrev_b32 v18, 16, v18
    v_mul_f32 v18, v18, v26
    v_cvt_pk_bf16_f32 v18, v18, v18
    v_lshlrev_b32 v18, 16, v18
    v_sub_f32 v19, v19, v27
    v_cvt_pk_bf16_f32 v19, v19, v19
    v_lshlrev_b32 v19, 16, v19
    v_mul_f32 v19, v19, v26
    v_cvt_pk_bf16_f32 v19, v19, v19
    v_lshlrev_b32 v19, 16, v19
    v_sub_f32 v20, v20, v27
    v_cvt_pk_bf16_f32 v20, v20, v20
    v_lshlrev_b32 v20, 16, v20
    v_mul_f32 v20, v20, v26
    v_cvt_pk_bf16_f32 v20, v20, v20
    v_lshlrev_b32 v20, 16, v20
    v_sub_f32 v21, v21, v27
    v_cvt_pk_bf16_f32 v21, v21, v21
    v_lshlrev_b32 v21, 16, v21
    v_mul_f32 v21, v21, v26
    v_cvt_pk_bf16_f32 v21, v21, v21
    v_lshlrev_b32 v21, 16, v21
    v_sub_f32 v22, v22, v27
    v_cvt_pk_bf16_f32 v22, v22, v22
    v_lshlrev_b32 v22, 16, v22
    v_mul_f32 v22, v22, v26
    v_cvt_pk_bf16_f32 v22, v22, v22
    v_lshlrev_b32 v22, 16, v22
    v_sub_f32 v23, v23, v27
    v_cvt_pk_bf16_f32 v23, v23, v23
    v_lshlrev_b32 v23, 16, v23
    v_mul_f32 v23, v23, v26
    v_cvt_pk_bf16_f32 v23, v23, v23
    v_lshlrev_b32 v23, 16, v23
    v_sub_f32 v24, v24, v27
    v_cvt_pk_bf16_f32 v24, v24, v24
    v_lshlrev_b32 v24, 16, v24
    v_mul_f32 v24, v24, v26
    v_cvt_pk_bf16_f32 v24, v24, v24
    v_lshlrev_b32 v24, 16, v24
    v_sub_f32 v25, v25, v27
    v_cvt_pk_bf16_f32 v25, v25, v25
    v_lshlrev_b32 v25, 16, v25
    v_mul_f32 v25, v25, v26
    v_cvt_pk_bf16_f32 v25, v25, v25
    v_lshlrev_b32 v25, 16, v25
    v_cvt_pk_bf16_f32 v10, v16, v17
    v_cvt_pk_bf16_f32 v11, v18, v19
    v_cvt_pk_bf16_f32 v12, v20, v21
    v_cvt_pk_bf16_f32 v13, v22, v23
    v_cvt_pk_bf16_f32 v14, v24, v25
    s_mov_b32 s22, 0
    buffer_store_dword v10, v5, s[8:11], s22 offen
    s_mov_b32 s22, 524288
    buffer_store_dword v11, v5, s[8:11], s22 offen
    s_mov_b32 s22, 1048576
    buffer_store_dword v12, v5, s[8:11], s22 offen
    s_mov_b32 s22, 1572864
    buffer_store_dword v13, v5, s[8:11], s22 offen
    s_mov_b32 s22, 2097152
    buffer_store_dword v14, v5, s[8:11], s22 offen
    v_add_f32 v26, v16, v17
    v_add_f32 v26, v26, v18
    v_add_f32 v26, v26, v19
    v_add_f32 v26, v26, v20
    v_add_f32 v26, v26, v21
    v_add_f32 v26, v26, v22
    v_add_f32 v26, v26, v23
    v_add_f32 v26, v26, v24
    v_add_f32 v26, v26, v25
    ds_swizzle_b32 v28, v26 offset:0x41f
    s_waitcnt lgkmcnt(0)
    v_add_f32 v26, v26, v28
    ds_swizzle_b32 v28, v26 offset:0x81f
    s_waitcnt lgkmcnt(0)
    v_add_f32 v26, v26, v28
    ds_swizzle_b32 v28, v26 offset:0x101f
    s_waitcnt lgkmcnt(0)
    v_add_f32 v26, v26, v28
    ds_swizzle_b32 v28, v26 offset:0x201f
    s_waitcnt lgkmcnt(0)
    v_add_f32 v26, v26, v28
    ds_swizzle_b32 v28, v26 offset:0x401f
    s_waitcnt lgkmcnt(0)
    v_add_f32 v26, v26, v28
    v_mov_b32 v28, v26
    s_nop 1
    v_permlane32_swap_b32 v28, v26
    v_add_f32 v26, v26, v28
    v_mul_f32 v27, 0x3acccccd, v26
    v_sub_f32 v28, v16, v27
    v_mul_f32 v26, v28, v28
    v_sub_f32 v28, v17, v27
    v_fmac_f32 v26, v28, v28
    v_sub_f32 v28, v18, v27
    v_fmac_f32 v26, v28, v28
    v_sub_f32 v28, v19, v27
    v_fmac_f32 v26, v28, v28
    v_sub_f32 v28, v20, v27
    v_fmac_f32 v26, v28, v28
    v_sub_f32 v28, v21, v27
    v_fmac_f32 v26, v28, v28
    v_sub_f32 v28, v22, v27
    v_fmac_f32 v26, v28, v28
    v_sub_f32 v28, v23, v27
    v_fmac_f32 v26, v28, v28
    v_sub_f32 v28, v24, v27
    v_fmac_f32 v26, v28, v28
    v_sub_f32 v28, v25, v27
    v_fmac_f32 v26, v28, v28
    ds_swizzle_b32 v28, v26 offset:0x41f
    s_waitcnt lgkmcnt(0)
    v_add_f32 v26, v26, v28
    ds_swizzle_b32 v28, v26 offset:0x81f
    s_waitcnt lgkmcnt(0)
    v_add_f32 v26, v26, v28
    ds_swizzle_b32 v28, v26 offset:0x101f
    s_waitcnt lgkmcnt(0)
    v_add_f32 v26, v26, v28
    ds_swizzle_b32 v28, v26 offset:0x201f
    s_waitcnt lgkmcnt(0)
    v_add_f32 v26, v26, v28
    ds_swizzle_b32 v28, v26 offset:0x401f
    s_waitcnt lgkmcnt(0)
    v_add_f32 v26, v26, v28
    v_mov_b32 v28, v26
    s_nop 1
    v_permlane32_swap_b32 v28, v26
    v_add_f32 v26, v26, v28
    v_mul_f32 v26, 0x3acccccd, v26
    v_cvt_pk_bf16_f32 v26, v26, v26
    v_lshlrev_b32 v26, 16, v26
    v_add_f32 v26, 0x3727c5ac, v26
    v_cvt_pk_bf16_f32 v26, v26, v26
    v_lshlrev_b32 v26, 16, v26
    v_sqrt_f32 v26, v26
    s_nop 0
    v_cvt_pk_bf16_f32 v26, v26, v26
    v_lshlrev_b32 v26, 16, v26
    v_rcp_f32 v26, v26
    v_cvt_pk_bf16_f32 v27, v27, v27
    v_lshlrev_b32 v27, 16, v27
    v_sub_f32 v16, v16, v27
    v_cvt_pk_bf16_f32 v16, v16, v16
    v_lshlrev_b32 v16, 16, v16
    v_mul_f32 v16, v16, v26
    v_cvt_pk_bf16_f32 v16, v16, v16
    v_lshlrev_b32 v16, 16, v16
    v_sub_f32 v17, v17, v27
    v_cvt_pk_bf16_f32 v17, v17, v17
    v_lshlrev_b32 v17, 16, v17
    v_mul_f32 v17, v17, v26
    v_cvt_pk_bf16_f32 v17, v17, v17
    v_lshlrev_b32 v17, 16, v17
    v_sub_f32 v18, v18, v27
    v_cvt_pk_bf16_f32 v18, v18, v18
    v_lshlrev_b32 v18, 16, v18
    v_mul_f32 v18, v18, v26
    v_cvt_pk_bf16_f32 v18, v18, v18
    v_lshlrev_b32 v18, 16, v18
    v_sub_f32 v19, v19, v27
    v_cvt_pk_bf16_f32 v19, v19, v19
    v_lshlrev_b32 v19, 16, v19
    v_mul_f32 v19, v19, v26
    v_cvt_pk_bf16_f32 v19, v19, v19
    v_lshlrev_b32 v19, 16, v19
    v_sub_f32 v20, v20, v27
    v_cvt_pk_bf16_f32 v20, v20, v20
    v_lshlrev_b32 v20, 16, v20
    v_mul_f32 v20, v20, v26
    v_cvt_pk_bf16_f32 v20, v20, v20
    v_lshlrev_b32 v20, 16, v20
    v_sub_f32 v21, v21, v27
    v_cvt_pk_bf16_f32 v21, v21, v21
    v_lshlrev_b32 v21, 16, v21
    v_mul_f32 v21, v21, v26
    v_cvt_pk_bf16_f32 v21, v21, v21
    v_lshlrev_b32 v21, 16, v21
    v_sub_f32 v22, v22, v27
    v_cvt_pk_bf16_f32 v22, v22, v22
    v_lshlrev_b32 v22, 16, v22
    v_mul_f32 v22, v22, v26
    v_cvt_pk_bf16_f32 v22, v22, v22
    v_lshlrev_b32 v22, 16, v22
    v_sub_f32 v23, v23, v27
    v_cvt_pk_bf16_f32 v23, v23, v23
    v_lshlrev_b32 v23, 16, v23
    v_mul_f32 v23, v23, v26
    v_cvt_pk_bf16_f32 v23, v23, v23
    v_lshlrev_b32 v23, 16, v23
    v_sub_f32 v24, v24, v27
    v_cvt_pk_bf16_f32 v24, v24, v24
    v_lshlrev_b32 v24, 16, v24
    v_mul_f32 v24, v24, v26
    v_cvt_pk_bf16_f32 v24, v24, v24
    v_lshlrev_b32 v24, 16, v24
    v_sub_f32 v25, v25, v27
    v_cvt_pk_bf16_f32 v25, v25, v25
    v_lshlrev_b32 v25, 16, v25
    v_mul_f32 v25, v25, v26
    v_cvt_pk_bf16_f32 v25, v25, v25
    v_lshlrev_b32 v25, 16, v25
    v_lshlrev_b32 v6, 5, v1
    v_lshl_add_u32 v6, v2, 1, v6
    ds_write_b16_d16_hi v6, v16 offset:0
    ds_write_b16_d16_hi v6, v17 offset:16
    ds_write_b16_d16_hi v6, v18 offset:2048
    ds_write_b16_d16_hi v6, v19 offset:2064
    ds_write_b16_d16_hi v6, v20 offset:4096
    ds_write_b16_d16_hi v6, v21 offset:4112
    ds_write_b16_d16_hi v6, v22 offset:6144
    ds_write_b16_d16_hi v6, v23 offset:6160
    ds_write_b16_d16_hi v6, v24 offset:8192
    ds_write_b16_d16_hi v6, v25 offset:8208
    s_waitcnt lgkmcnt(0)
    s_barrier
    v_lshlrev_b32 v6, 4, v0
    ds_read_b128 v[8:11], v6
    ds_read_b128 v[12:15], v6 offset:8192
    s_lshr_b32 s22, s3, 4
    s_mul_i32 s22, s22, 20480
    s_bfe_u32 s23, s3, 0x10003
    v_bfe_u32 v6, v0, 3, 1
    v_xor_b32 v6, s23, v6
    v_lshlrev_b32 v7, 5, v0
    v_lshl_add_u32 v7, v6, 4, v7
    v_add_u32 v7, s22, v7
    v_add_u32 v6, 16384, v7
    s_waitcnt lgkmcnt(0)
    buffer_store_dwordx4 v[8:11], v7, s[12:15], 0 offen
    v_cmp_gt_u32 vcc, 128, v0
    s_and_saveexec_b64 s[24:25], vcc
    buffer_store_dwordx4 v[12:15], v6, s[12:15], 0 offen
    s_mov_b64 exec, s[24:25]
    s_endpgm
LN_ckv_2:
    s_sub_u32 s3, s2, 256
    s_lshl_b32 s3, s3, 9
    v_add_u32 v1, s3, v0
    v_lshlrev_b32 v2, 4, v1
    v_lshrrev_b32 v3, 6, v1
    v_bfe_u32 v4, v1, 1, 5
    v_lshlrev_b32 v4, 16, v4
    v_lshl_add_u32 v4, v3, 5, v4
    v_and_b32 v5, 1, v1
    v_bfe_u32 v6, v3, 3, 1
    v_xor_b32 v5, v5, v6
    v_lshl_add_u32 v4, v5, 4, v4
    s_waitcnt lgkmcnt(0)
    s_mov_b32 s4, s18
    s_and_b32 s5, s19, 0xffff
    s_mov_b32 s6, 0x200000
    s_mov_b32 s7, 0x00020000
    s_add_u32 s8, s20, 0x600000
    s_addc_u32 s9, s21, 0
    s_and_b32 s9, s9, 0xffff
    s_mov_b32 s10, 0x200000
    s_mov_b32 s11, 0x00020000
    buffer_load_dwordx4 v[8:11], v2, s[4:7], 0 offen
    s_waitcnt vmcnt(0)
    buffer_store_dwordx4 v[8:11], v4, s[8:11], 0 offen
LN_done_1:
    s_endpgm
.globl gemm1_kernel
.type gemm1_kernel,@function
.p2align 8
gemm1_kernel:
    s_load_dwordx4 s[40:43], s[0:1], 8
    s_load_dwordx4 s[44:47], s[0:1], 24
    s_load_dwordx4 s[48:51], s[0:1], 56
    s_load_dwordx2 s[52:53], s[0:1], 104
    s_cmp_ge_u32 s2, 424
    s_cbranch_scc1 G1_done_3
    s_waitcnt lgkmcnt(0)
    s_cmp_ge_u32 s2, 40
    s_cbranch_scc1 G1_Q_4
    s_cmp_ge_u32 s2, 35
    s_cbranch_scc1 G1_done_3
    s_mul_hi_u32 s20, s2, 0x33333334
    s_mul_i32 s21, s20, 5
    s_sub_u32 s21, s2, s21
    s_lshl_b32 s22, s21, 7
    s_lshl_b32 s23, s20, 8
    s_add_u32 s4, s52, 0x280000
    s_addc_u32 s5, s53, 0
    s_and_b32 s5, s5, 0xffff
    s_mov_b32 s6, 0x300000
    s_mov_b32 s7, 0x00020000
    s_mov_b32 s8, s48
    s_and_b32 s9, s49, 0xffff
    s_mov_b32 s10, 0x6c0000
    s_mov_b32 s11, 0x00020000
    s_add_u32 s12, s52, 0x4000000
    s_addc_u32 s13, s53, 0
    s_and_b32 s13, s13, 0xffff
    s_mov_b32 s14, 0x21c000
    s_mov_b32 s15, 0x00020000
    s_mov_b32 s16, s50
    s_and_b32 s17, s51, 0xffff
    s_mov_b32 s18, 0xd80
    s_mov_b32 s19, 0x00020000
    v_mov_b32 v140, v0
    v_and_b32 v111, 63, v140
    v_lshrrev_b32 v112, 6, v140
    s_nop 0
    v_readfirstlane_b32 s24, v112
    s_lshr_b32 s27, s24, 2
    s_and_b32 s28, s24, 3
    v_and_b32 v113, 31, v111
    s_mul_i32 s25, s27, 64
    v_add_u32 v113, s25, v113
    v_lshlrev_b32 v113, 5, v113
    v_lshrrev_b32 v114, 5, v111
    v_bfe_u32 v115, v111, 3, 1
    v_xor_b32 v115, v114, v115
    v_lshl_add_u32 v96, v115, 4, v113
    v_add_u32 v97, 24576, v96
    v_add_u32 v98, 49152, v96
    v_add_u32 v99, 73728, v96
    v_bfe_u32 v116, v111, 2, 2
    v_lshl_add_u32 v117, v114, 3, v116
    v_mul_u32_u24 v117, 512, v117
    v_bfe_u32 v118, v111, 4, 1
    v_lshlrev_b32 v118, 1, v118
    v_bfe_u32 v119, v111, 1, 1
    v_add_u32 v118, v118, v119
    s_mul_i32 s25, s28, 8
    v_add_u32 v118, s25, v118
    v_lshlrev_b32 v119, 2, v116
    v_and_b32 v120, 1, v111
    v_lshlrev_b32 v120, 3, v120
    v_add_u32 v117, v117, v120
    v_add_u32 v117, 8192, v117
    v_add_u32 v120, 0, v118
    v_xor_b32 v120, v120, v119
    v_lshl_add_u32 v100, v120, 4, v117
    v_add_u32 v102, 24576, v100
    v_add_u32 v104, 49152, v100
    v_add_u32 v106, 73728, v100
    v_add_u32 v120, 4, v118
    v_xor_b32 v120, v120, v119
    v_lshl_add_u32 v101, v120, 4, v117
    v_add_u32 v103, 24576, v101
    v_add_u32 v105, 49152, v101
    v_add_u32 v107, 73728, v101
    s_mul_i32 s30, s24, 1024
    s_mul_i32 s31, s24, 2048
    s_add_u32 s31, s31, 8192
    v_lshlrev_b32 v115, 4, v111
    s_mul_i32 s25, s24, 1
    s_add_u32 s25, s25, 0
    s_lshr_b32 s26, s25, 2
    s_and_b32 s25, s25, 3
    s_mul_i32 s26, s26, 640
    s_lshl_b32 s25, s25, 5
    s_add_u32 s25, s25, s26
    s_add_u32 s25, s25, s22
    s_lshl_b32 s25, s25, 5
    v_add_u32 v108, s25, v115
    s_mov_b32 s26, 3456
    s_lshl_b32 s29, s23, 1
    s_mul_i32 s25, s24, 4
    s_add_u32 s25, s25, 0
    v_lshrrev_b32 v115, 5, v111
    v_add_u32 v115, s25, v115
    v_and_b32 v116, 3, v115
    v_lshlrev_b32 v116, 2, v116
    v_and_b32 v117, 31, v111
    v_xor_b32 v116, v116, v117
    v_mul_lo_u32 v115, v115, s26
    v_lshl_add_u32 v115, v116, 4, v115
    v_add_u32 v109, s29, v115
    s_mul_i32 s25, s24, 4
    s_add_u32 s25, s25, 2
    v_lshrrev_b32 v115, 5, v111
    v_add_u32 v115, s25, v115
    v_and_b32 v116, 3, v115
    v_lshlrev_b32 v116, 2, v116
    v_and_b32 v117, 31, v111
    v_xor_b32 v116, v116, v117
    v_mul_lo_u32 v115, v115, s26
    v_lshl_add_u32 v115, v116, 4, v115
    v_add_u32 v110, s29, v115
    v_mov_b32 v0, 0
    v_mov_b32 v1, 0
    v_mov_b32 v2, 0
    v_mov_b32 v3, 0
    v_mov_b32 v4, 0
    v_mov_b32 v5, 0
    v_mov_b32 v6, 0
    v_mov_b32 v7, 0
    v_mov_b32 v8, 0
    v_mov_b32 v9, 0
    v_mov_b32 v10, 0
    v_mov_b32 v11, 0
    v_mov_b32 v12, 0
    v_mov_b32 v13, 0
    v_mov_b32 v14, 0
    v_mov_b32 v15, 0
    v_mov_b32 v16, 0
    v_mov_b32 v17, 0
    v_mov_b32 v18, 0
    v_mov_b32 v19, 0
    v_mov_b32 v20, 0
    v_mov_b32 v21, 0
    v_mov_b32 v22, 0
    v_mov_b32 v23, 0
    v_mov_b32 v24, 0
    v_mov_b32 v25, 0
    v_mov_b32 v26, 0
    v_mov_b32 v27, 0
    v_mov_b32 v28, 0
    v_mov_b32 v29, 0
    v_mov_b32 v30, 0
    v_mov_b32 v31, 0
    v_mov_b32 v32, 0
    v_mov_b32 v33, 0
    v_mov_b32 v34, 0
    v_mov_b32 v35, 0
    v_mov_b32 v36, 0
    v_mov_b32 v37, 0
    v_mov_b32 v38, 0
    v_mov_b32 v39, 0
    v_mov_b32 v40, 0
    v_mov_b32 v41, 0
    v_mov_b32 v42, 0
    v_mov_b32 v43, 0
    v_mov_b32 v44, 0
    v_mov_b32 v45, 0
    v_mov_b32 v46, 0
    v_mov_b32 v47, 0
    v_mov_b32 v48, 0
    v_mov_b32 v49, 0
    v_mov_b32 v50, 0
    v_mov_b32 v51, 0
    v_mov_b32 v52, 0
    v_mov_b32 v53, 0
    v_mov_b32 v54, 0
    v_mov_b32 v55, 0
    v_mov_b32 v56, 0
    v_mov_b32 v57, 0
    v_mov_b32 v58, 0
    v_mov_b32 v59, 0
    v_mov_b32 v60, 0
    v_mov_b32 v61, 0
    v_mov_b32 v62, 0
    v_mov_b32 v63, 0
    s_mov_b32 s32, 0
    s_mov_b32 s33, 0
    s_add_u32 m0, s30, 0
    s_nop 0
    buffer_load_dwordx4 v108, s[4:7], s32 offen lds
    s_add_u32 m0, s31, 0
    s_nop 0
    buffer_load_dwordx4 v109, s[8:11], s33 offen lds
    s_add_u32 m0, s31, 1024
    s_nop 0
    buffer_load_dwordx4 v110, s[8:11], s33 offen lds
    s_add_u32 s32, s32, 40960
    s_add_u32 s33, s33, 110592
    s_add_u32 m0, s30, 24576
    s_nop 0
    buffer_load_dwordx4 v108, s[4:7], s32 offen lds
    s_add_u32 m0, s31, 24576
    s_nop 0
    buffer_load_dwordx4 v109, s[8:11], s33 offen lds
    s_add_u32 m0, s31, 25600
    s_nop 0
    buffer_load_dwordx4 v110, s[8:11], s33 offen lds
    s_add_u32 s32, s32, 40960
    s_add_u32 s33, s33, 110592
    s_add_u32 m0, s30, 49152
    s_nop 0
    buffer_load_dwordx4 v108, s[4:7], s32 offen lds
    s_add_u32 m0, s31, 49152
    s_nop 0
    buffer_load_dwordx4 v109, s[8:11], s33 offen lds
    s_add_u32 m0, s31, 50176
    s_nop 0
    buffer_load_dwordx4 v110, s[8:11], s33 offen lds
    s_add_u32 s32, s32, 40960
    s_add_u32 s33, s33, 110592
    s_add_u32 m0, s30, 73728
    s_nop 0
    buffer_load_dwordx4 v108, s[4:7], s32 offen lds
    s_add_u32 m0, s31, 73728
    s_nop 0
    buffer_load_dwordx4 v109, s[8:11], s33 offen lds
    s_add_u32 m0, s31, 74752
    s_nop 0
    buffer_load_dwordx4 v110, s[8:11], s33 offen lds
    s_add_u32 s32, s32, 40960
    s_add_u32 s33, s33, 110592
    s_waitcnt vmcnt(9)
    s_barrier
    ds_read_b64_tr_b16 v[72:73], v100 offset:0
    ds_read_b64_tr_b16 v[74:75], v100 offset:2048
    ds_read_b64_tr_b16 v[76:77], v101 offset:0
    ds_read_b64_tr_b16 v[78:79], v101 offset:2048
    ds_read_b128 v[64:67], v96 offset:0
    ds_read_b128 v[68:71], v96 offset:1024
    s_mov_b32 s34, 0
G_loop_7:
    s_waitcnt lgkmcnt(0)
    v_mfma_f32_32x32x16_bf16 v[0:15], v[72:75], v[64:67], v[0:15]
    ds_read_b64_tr_b16 v[88:89], v100 offset:8192
    ds_read_b64_tr_b16 v[90:91], v100 offset:10240
    ds_read_b64_tr_b16 v[92:93], v101 offset:8192
    v_mfma_f32_32x32x16_bf16 v[16:31], v[76:79], v[64:67], v[16:31]
    ds_read_b64_tr_b16 v[94:95], v101 offset:10240
    ds_read_b128 v[80:83], v96 offset:4096
    ds_read_b128 v[84:87], v96 offset:5120
    v_mfma_f32_32x32x16_bf16 v[32:47], v[72:75], v[68:71], v[32:47]
    v_mfma_f32_32x32x16_bf16 v[48:63], v[76:79], v[68:71], v[48:63]
    s_add_u32 s35, s34, 4
    s_cmp_ge_u32 s35, 64
    s_cbranch_scc1 G_tail_9
    s_waitcnt vmcnt(6) lgkmcnt(0)
    s_barrier
    v_mfma_f32_32x32x16_bf16 v[0:15], v[88:91], v[80:83], v[0:15]
    ds_read_b64_tr_b16 v[72:73], v102 offset:0
    s_add_u32 m0, s30, 0
    s_nop 0
    buffer_load_dwordx4 v108, s[4:7], s32 offen lds
    ds_read_b64_tr_b16 v[74:75], v102 offset:2048
    s_add_u32 m0, s31, 0
    s_nop 0
    buffer_load_dwordx4 v109, s[8:11], s33 offen lds
    ds_read_b64_tr_b16 v[76:77], v103 offset:0
    v_mfma_f32_32x32x16_bf16 v[16:31], v[92:95], v[80:83], v[16:31]
    s_add_u32 m0, s31, 1024
    s_nop 0
    buffer_load_dwordx4 v110, s[8:11], s33 offen lds
    s_add_u32 s32, s32, 40960
    s_add_u32 s33, s33, 110592
    ds_read_b64_tr_b16 v[78:79], v103 offset:2048
    ds_read_b128 v[64:67], v97 offset:0
    ds_read_b128 v[68:71], v97 offset:1024
    v_mfma_f32_32x32x16_bf16 v[32:47], v[88:91], v[84:87], v[32:47]
    v_mfma_f32_32x32x16_bf16 v[48:63], v[92:95], v[84:87], v[48:63]
    s_branch G_cont_10
G_tail_9:
    s_waitcnt vmcnt(0) lgkmcnt(0)
    s_barrier
    v_mfma_f32_32x32x16_bf16 v[0:15], v[88:91], v[80:83], v[0:15]
    ds_read_b64_tr_b16 v[72:73], v102 offset:0
    ds_read_b64_tr_b16 v[74:75], v102 offset:2048
    ds_read_b64_tr_b16 v[76:77], v103 offset:0
    v_mfma_f32_32x32x16_bf16 v[16:31], v[92:95], v[80:83], v[16:31]
    ds_read_b64_tr_b16 v[78:79], v103 offset:2048
    ds_read_b128 v[64:67], v97 offset:0
    ds_read_b128 v[68:71], v97 offset:1024
    v_mfma_f32_32x32x16_bf16 v[32:47], v[88:91], v[84:87], v[32:47]
    v_mfma_f32_32x32x16_bf16 v[48:63], v[92:95], v[84:87], v[48:63]
G_cont_10:
    s_add_u32 s34, s34, 1
    s_cmp_ge_u32 s34, 64
    s_cbranch_scc1 G_end_8
    s_waitcnt lgkmcnt(0)
    v_mfma_f32_32x32x16_bf16 v[0:15], v[72:75], v[64:67], v[0:15]
    ds_read_b64_tr_b16 v[88:89], v102 offset:8192
    ds_read_b64_tr_b16 v[90:91], v102 offset:10240
    ds_read_b64_tr_b16 v[92:93], v103 offset:8192
    v_mfma_f32_32x32x16_bf16 v[16:31], v[76:79], v[64:67], v[16:31]
    ds_read_b64_tr_b16 v[94:95], v103 offset:10240
    ds_read_b128 v[80:83], v97 offset:4096
    ds_read_b128 v[84:87], v97 offset:5120
    v_mfma_f32_32x32x16_bf16 v[32:47], v[72:75], v[68:71], v[32:47]
    v_mfma_f32_32x32x16_bf16 v[48:63], v[76:79], v[68:71], v[48:63]
    s_add_u32 s35, s34, 4
    s_cmp_ge_u32 s35, 64
    s_cbranch_scc1 G_tail_11
    s_waitcnt vmcnt(6) lgkmcnt(0)
    s_barrier
    v_mfma_f32_32x32x16_bf16 v[0:15], v[88:91], v[80:83], v[0:15]
    ds_read_b64_tr_b16 v[72:73], v104 offset:0
    s_add_u32 m0, s30, 24576
    s_nop 0
    buffer_load_dwordx4 v108, s[4:7], s32 offen lds
    ds_read_b64_tr_b16 v[74:75], v104 offset:2048
    s_add_u32 m0, s31, 24576
    s_nop 0
    buffer_load_dwordx4 v109, s[8:11], s33 offen lds
    ds_read_b64_tr_b16 v[76:77], v105 offset:0
    v_mfma_f32_32x32x16_bf16 v[16:31], v[92:95], v[80:83], v[16:31]
    s_add_u32 m0, s31, 25600
    s_nop 0
    buffer_load_dwordx4 v110, s[8:11], s33 offen lds
    s_add_u32 s32, s32, 40960
    s_add_u32 s33, s33, 110592
    ds_read_b64_tr_b16 v[78:79], v105 offset:2048
    ds_read_b128 v[64:67], v98 offset:0
    ds_read_b128 v[68:71], v98 offset:1024
    v_mfma_f32_32x32x16_bf16 v[32:47], v[88:91], v[84:87], v[32:47]
    v_mfma_f32_32x32x16_bf16 v[48:63], v[92:95], v[84:87], v[48:63]
    s_branch G_cont_12
G_tail_11:
    s_waitcnt vmcnt(0) lgkmcnt(0)
    s_barrier
    v_mfma_f32_32x32x16_bf16 v[0:15], v[88:91], v[80:83], v[0:15]
    ds_read_b64_tr_b16 v[72:73], v104 offset:0
    ds_read_b64_tr_b16 v[74:75], v104 offset:2048
    ds_read_b64_tr_b16 v[76:77], v105 offset:0
    v_mfma_f32_32x32x16_bf16 v[16:31], v[92:95], v[80:83], v[16:31]
    ds_read_b64_tr_b16 v[78:79], v105 offset:2048
    ds_read_b128 v[64:67], v98 offset:0
    ds_read_b128 v[68:71], v98 offset:1024
    v_mfma_f32_32x32x16_bf16 v[32:47], v[88:91], v[84:87], v[32:47]
    v_mfma_f32_32x32x16_bf16 v[48:63], v[92:95], v[84:87], v[48:63]
G_cont_12:
    s_add_u32 s34, s34, 1
    s_cmp_ge_u32 s34, 64
    s_cbranch_scc1 G_end_8
    s_waitcnt lgkmcnt(0)
    v_mfma_f32_32x32x16_bf16 v[0:15], v[72:75], v[64:67], v[0:15]
    ds_read_b64_tr_b16 v[88:89], v104 offset:8192
    ds_read_b64_tr_b16 v[90:91], v104 offset:10240
    ds_read_b64_tr_b16 v[92:93], v105 offset:8192
    v_mfma_f32_32x32x16_bf16 v[16:31], v[76:79], v[64:67], v[16:31]
    ds_read_b64_tr_b16 v[94:95], v105 offset:10240
    ds_read_b128 v[80:83], v98 offset:4096
    ds_read_b128 v[84:87], v98 offset:5120
    v_mfma_f32_32x32x16_bf16 v[32:47], v[72:75], v[68:71], v[32:47]
    v_mfma_f32_32x32x16_bf16 v[48:63], v[76:79], v[68:71], v[48:63]
    s_add_u32 s35, s34, 4
    s_cmp_ge_u32 s35, 64
    s_cbranch_scc1 G_tail_13
    s_waitcnt vmcnt(6) lgkmcnt(0)
    s_barrier
    v_mfma_f32_32x32x16_bf16 v[0:15], v[88:91], v[80:83], v[0:15]
    ds_read_b64_tr_b16 v[72:73], v106 offset:0
    s_add_u32 m0, s30, 49152
    s_nop 0
    buffer_load_dwordx4 v108, s[4:7], s32 offen lds
    ds_read_b64_tr_b16 v[74:75], v106 offset:2048
    s_add_u32 m0, s31, 49152
    s_nop 0
    buffer_load_dwordx4 v109, s[8:11], s33 offen lds
    ds_read_b64_tr_b16 v[76:77], v107 offset:0
    v_mfma_f32_32x32x16_bf16 v[16:31], v[92:95], v[80:83], v[16:31]
    s_add_u32 m0, s31, 50176
    s_nop 0
    buffer_load_dwordx4 v110, s[8:11], s33 offen lds
    s_add_u32 s32, s32, 40960
    s_add_u32 s33, s33, 110592
    ds_read_b64_tr_b16 v[78:79], v107 offset:2048
    ds_read_b128 v[64:67], v99 offset:0
    ds_read_b128 v[68:71], v99 offset:1024
    v_mfma_f32_32x32x16_bf16 v[32:47], v[88:91], v[84:87], v[32:47]
    v_mfma_f32_32x32x16_bf16 v[48:63], v[92:95], v[84:87], v[48:63]
    s_branch G_cont_14
G_tail_13:
    s_waitcnt vmcnt(0) lgkmcnt(0)
    s_barrier
    v_mfma_f32_32x32x16_bf16 v[0:15], v[88:91], v[80:83], v[0:15]
    ds_read_b64_tr_b16 v[72:73], v106 offset:0
    ds_read_b64_tr_b16 v[74:75], v106 offset:2048
    ds_read_b64_tr_b16 v[76:77], v107 offset:0
    v_mfma_f32_32x32x16_bf16 v[16:31], v[92:95], v[80:83], v[16:31]
    ds_read_b64_tr_b16 v[78:79], v107 offset:2048
    ds_read_b128 v[64:67], v99 offset:0
    ds_read_b128 v[68:71], v99 offset:1024
    v_mfma_f32_32x32x16_bf16 v[32:47], v[88:91], v[84:87], v[32:47]
    v_mfma_f32_32x32x16_bf16 v[48:63], v[92:95], v[84:87], v[48:63]
G_cont_14:
    s_add_u32 s34, s34, 1
    s_cmp_ge_u32 s34, 64
    s_cbranch_scc1 G_end_8
    s_waitcnt lgkmcnt(0)
    v_mfma_f32_32x32x16_bf16 v[0:15], v[72:75], v[64:67], v[0:15]
    ds_read_b64_tr_b16 v[88:89], v106 offset:8192
    ds_read_b64_tr_b16 v[90:91], v106 offset:10240
    ds_read_b64_tr_b16 v[92:93], v107 offset:8192
    v_mfma_f32_32x32x16_bf16 v[16:31], v[76:79], v[64:67], v[16:31]
    ds_read_b64_tr_b16 v[94:95], v107 offset:10240
    ds_read_b128 v[80:83], v99 offset:4096
    ds_read_b128 v[84:87], v99 offset:5120
    v_mfma_f32_32x32x16_bf16 v[32:47], v[72:75], v[68:71], v[32:47]
    v_mfma_f32_32x32x16_bf16 v[48:63], v[76:79], v[68:71], v[48:63]
    s_add_u32 s35, s34, 4
    s_cmp_ge_u32 s35, 64
    s_cbranch_scc1 G_tail_15
    s_waitcnt vmcnt(6) lgkmcnt(0)
    s_barrier
    v_mfma_f32_32x32x16_bf16 v[0:15], v[88:91], v[80:83], v[0:15]
    ds_read_b64_tr_b16 v[72:73], v100 offset:0
    s_add_u32 m0, s30, 73728
    s_nop 0
    buffer_load_dwordx4 v108, s[4:7], s32 offen lds
    ds_read_b64_tr_b16 v[74:75], v100 offset:2048
    s_add_u32 m0, s31, 73728
    s_nop 0
    buffer_load_dwordx4 v109, s[8:11], s33 offen lds
    ds_read_b64_tr_b16 v[76:77], v101 offset:0
    v_mfma_f32_32x32x16_bf16 v[16:31], v[92:95], v[80:83], v[16:31]
    s_add_u32 m0, s31, 74752
    s_nop 0
    buffer_load_dwordx4 v110, s[8:11], s33 offen lds
    s_add_u32 s32, s32, 40960
    s_add_u32 s33, s33, 110592
    ds_read_b64_tr_b16 v[78:79], v101 offset:2048
    ds_read_b128 v[64:67], v96 offset:0
    ds_read_b128 v[68:71], v96 offset:1024
    v_mfma_f32_32x32x16_bf16 v[32:47], v[88:91], v[84:87], v[32:47]
    v_mfma_f32_32x32x16_bf16 v[48:63], v[92:95], v[84:87], v[48:63]
    s_branch G_cont_16
G_tail_15:
    s_waitcnt vmcnt(0) lgkmcnt(0)
    s_barrier
    v_mfma_f32_32x32x16_bf16 v[0:15], v[88:91], v[80:83], v[0:15]
    ds_read_b64_tr_b16 v[72:73], v100 offset:0
    ds_read_b64_tr_b16 v[74:75], v100 offset:2048
    ds_read_b64_tr_b16 v[76:77], v101 offset:0
    v_mfma_f32_32x32x16_bf16 v[16:31], v[92:95], v[80:83], v[16:31]
    ds_read_b64_tr_b16 v[78:79], v101 offset:2048
    ds_read_b128 v[64:67], v96 offset:0
    ds_read_b128 v[68:71], v96 offset:1024
    v_mfma_f32_32x32x16_bf16 v[32:47], v[88:91], v[84:87], v[32:47]
    v_mfma_f32_32x32x16_bf16 v[48:63], v[92:95], v[84:87], v[48:63]
G_cont_16:
    s_add_u32 s34, s34, 1
    s_cmp_ge_u32 s34, 64
    s_cbranch_scc1 G_end_8
    s_branch G_loop_7
G_end_8:
    s_waitcnt lgkmcnt(0)
    s_nop 15
    s_lshl_b32 s25, s28, 6
    s_add_u32 s25, s25, s23
    s_cmp_ge_u32 s25, 1728
    s_cbranch_scc1 G1_done_3
    v_and_b32 v113, 31, v111
    s_mul_i32 s25, s27, 64
    s_add_u32 s25, s25, s22
    v_add_u32 v113, s25, v113
    v_lshlrev_b32 v113, 5, v113
    v_lshrrev_b32 v114, 5, v111
    v_bfe_u32 v119, v111, 3, 1
    v_xor_b32 v119, v114, v119
    v_lshl_add_u32 v113, v119, 4, v113
    s_mul_i32 s25, s28, 64
    s_add_u32 s25, s25, s23
    s_lshr_b32 s26, s25, 4
    s_mul_i32 s26, s26, 20480
    v_add_u32 v113, s26, v113
    s_lshl_b32 s25, s25, 1
    v_lshlrev_b32 v119, 3, v114
    v_add_u32 v119, s25, v119
    buffer_load_dwordx2 v[124:125], v119, s[16:19], 0 offen offset:0
    buffer_load_dwordx2 v[126:127], v119, s[16:19], 0 offen offset:16
    buffer_load_dwordx2 v[128:129], v119, s[16:19], 0 offen offset:32
    buffer_load_dwordx2 v[130:131], v119, s[16:19], 0 offen offset:48
    buffer_load_dwordx2 v[132:133], v119, s[16:19], 0 offen offset:64
    buffer_load_dwordx2 v[134:135], v119, s[16:19], 0 offen offset:80
    buffer_load_dwordx2 v[136:137], v119, s[16:19], 0 offen offset:96
    buffer_load_dwordx2 v[138:139], v119, s[16:19], 0 offen offset:112
    s_waitcnt vmcnt(0)
    v_lshlrev_b32 v64, 16, v124
    v_and_b32 v65, 0xffff0000, v124
    v_lshlrev_b32 v66, 16, v125
    v_and_b32 v67, 0xffff0000, v125
    v_lshlrev_b32 v68, 16, v126
    v_and_b32 v69, 0xffff0000, v126
    v_lshlrev_b32 v70, 16, v127
    v_and_b32 v71, 0xffff0000, v127
    v_lshlrev_b32 v72, 16, v128
    v_and_b32 v73, 0xffff0000, v128
    v_lshlrev_b32 v74, 16, v129
    v_and_b32 v75, 0xffff0000, v129
    v_lshlrev_b32 v76, 16, v130
    v_and_b32 v77, 0xffff0000, v130
    v_lshlrev_b32 v78, 16, v131
    v_and_b32 v79, 0xffff0000, v131
    v_lshlrev_b32 v80, 16, v132
    v_and_b32 v81, 0xffff0000, v132
    v_lshlrev_b32 v82, 16, v133
    v_and_b32 v83, 0xffff0000, v133
    v_lshlrev_b32 v84, 16, v134
    v_and_b32 v85, 0xffff0000, v134
    v_lshlrev_b32 v86, 16, v135
    v_and_b32 v87, 0xffff0000, v135
    v_lshlrev_b32 v88, 16, v136
    v_and_b32 v89, 0xffff0000, v136
    v_lshlrev_b32 v90, 16, v137
    v_and_b32 v91, 0xffff0000, v137
    v_lshlrev_b32 v92, 16, v138
    v_and_b32 v93, 0xffff0000, v138
    v_lshlrev_b32 v94, 16, v139
    v_and_b32 v95, 0xffff0000, v139
    s_mov_b32 s36, 0x3d122279
    s_mov_b32 s37, 0x3f4c422a
    s_mov_b32 s38, 0xc038aa3b
    v_cvt_pk_bf16_f32 v0, v0, v0
    v_lshlrev_b32 v0, 16, v0
    v_add_f32 v0, v0, v64
    v_cvt_pk_bf16_f32 v0, v0, v0
    v_lshlrev_b32 v0, 16, v0
    v_mul_f32 v115, v0, v0
    v_mul_f32 v115, s36, v115
    v_add_f32 v115, s37, v115
    v_mul_f32 v115, v115, v0
    v_mul_f32 v115, s38, v115
    v_exp_f32 v115, v115
    s_nop 0
    v_add_f32 v115, 1.0, v115
    v_rcp_f32 v115, v115
    s_nop 0
    v_mul_f32 v0, v0, v115
    v_cvt_pk_bf16_f32 v1, v1, v1
    v_lshlrev_b32 v1, 16, v1
    v_add_f32 v1, v1, v65
    v_cvt_pk_bf16_f32 v1, v1, v1
    v_lshlrev_b32 v1, 16, v1
    v_mul_f32 v116, v1, v1
    v_mul_f32 v116, s36, v116
    v_add_f32 v116, s37, v116
    v_mul_f32 v116, v116, v1
    v_mul_f32 v116, s38, v116
    v_exp_f32 v116, v116
    s_nop 0
    v_add_f32 v116, 1.0, v116
    v_rcp_f32 v116, v116
    s_nop 0
    v_mul_f32 v1, v1, v116
    v_cvt_pk_bf16_f32 v2, v2, v2
    v_lshlrev_b32 v2, 16, v2
    v_add_f32 v2, v2, v66
    v_cvt_pk_bf16_f32 v2, v2, v2
    v_lshlrev_b32 v2, 16, v2
    v_mul_f32 v117, v2, v2
    v_mul_f32 v117, s36, v117
    v_add_f32 v117, s37, v117
    v_mul_f32 v117, v117, v2
    v_mul_f32 v117, s38, v117
    v_exp_f32 v117, v117
    s_nop 0
    v_add_f32 v117, 1.0, v117
    v_rcp_f32 v117, v117
    s_nop 0
    v_mul_f32 v2, v2, v117
    v_cvt_pk_bf16_f32 v3, v3, v3
    v_lshlrev_b32 v3, 16, v3
    v_add_f32 v3, v3, v67
    v_cvt_pk_bf16_f32 v3, v3, v3
    v_lshlrev_b32 v3, 16, v3
    v_mul_f32 v118, v3, v3
    v_mul_f32 v118, s36, v118
    v_add_f32 v118, s37, v118
    v_mul_f32 v118, v118, v3
    v_mul_f32 v118, s38, v118
    v_exp_f32 v118, v118
    s_nop 0
    v_add_f32 v118, 1.0, v118
    v_rcp_f32 v118, v118
    s_nop 0
    v_mul_f32 v3, v3, v118
    v_cvt_pk_bf16_f32 v4, v4, v4
    v_lshlrev_b32 v4, 16, v4
    v_add_f32 v4, v4, v68
    v_cvt_pk_bf16_f32 v4, v4, v4
    v_lshlrev_b32 v4, 16, v4
    v_mul_f32 v115, v4, v4
    v_mul_f32 v115, s36, v115
    v_add_f32 v115, s37, v115
    v_mul_f32 v115, v115, v4
    v_mul_f32 v115, s38, v115
    v_exp_f32 v115, v115
    s_nop 0
    v_add_f32 v115, 1.0, v115
    v_rcp_f32 v115, v115
    s_nop 0
    v_mul_f32 v4, v4, v115
    v_cvt_pk_bf16_f32 v5, v5, v5
    v_lshlrev_b32 v5, 16, v5
    v_add_f32 v5, v5, v69
    v_cvt_pk_bf16_f32 v5, v5, v5
    v_lshlrev_b32 v5, 16, v5
    v_mul_f32 v116, v5, v5
    v_mul_f32 v116, s36, v116
    v_add_f32 v116, s37, v116
    v_mul_f32 v116, v116, v5
    v_mul_f32 v116, s38, v116
    v_exp_f32 v116, v116
    s_nop 0
    v_add_f32 v116, 1.0, v116
    v_rcp_f32 v116, v116
    s_nop 0
    v_mul_f32 v5, v5, v116
    v_cvt_pk_bf16_f32 v6, v6, v6
    v_lshlrev_b32 v6, 16, v6
    v_add_f32 v6, v6, v70
    v_cvt_pk_bf16_f32 v6, v6, v6
    v_lshlrev_b32 v6, 16, v6
    v_mul_f32 v117, v6, v6
    v_mul_f32 v117, s36, v117
    v_add_f32 v117, s37, v117
    v_mul_f32 v117, v117, v6
    v_mul_f32 v117, s38, v117
    v_exp_f32 v117, v117
    s_nop 0
    v_add_f32 v117, 1.0, v117
    v_rcp_f32 v117, v117
    s_nop 0
    v_mul_f32 v6, v6, v117
    v_cvt_pk_bf16_f32 v7, v7, v7
    v_lshlrev_b32 v7, 16, v7
    v_add_f32 v7, v7, v71
    v_cvt_pk_bf16_f32 v7, v7, v7
    v_lshlrev_b32 v7, 16, v7
    v_mul_f32 v118, v7, v7
    v_mul_f32 v118, s36, v118
    v_add_f32 v118, s37, v118
    v_mul_f32 v118, v118, v7
    v_mul_f32 v118, s38, v118
    v_exp_f32 v118, v118
    s_nop 0
    v_add_f32 v118, 1.0, v118
    v_rcp_f32 v118, v118
    s_nop 0
    v_mul_f32 v7, v7, v118
    v_cvt_pk_bf16_f32 v8, v8, v8
    v_lshlrev_b32 v8, 16, v8
    v_add_f32 v8, v8, v72
    v_cvt_pk_bf16_f32 v8, v8, v8
    v_lshlrev_b32 v8, 16, v8
    v_mul_f32 v115, v8, v8
    v_mul_f32 v115, s36, v115
    v_add_f32 v115, s37, v115
    v_mul_f32 v115, v115, v8
    v_mul_f32 v115, s38, v115
    v_exp_f32 v115, v115
    s_nop 0
    v_add_f32 v115, 1.0, v115
    v_rcp_f32 v115, v115
    s_nop 0
    v_mul_f32 v8, v8, v115
    v_cvt_pk_bf16_f32 v9, v9, v9
    v_lshlrev_b32 v9, 16, v9
    v_add_f32 v9, v9, v73
    v_cvt_pk_bf16_f32 v9, v9, v9
    v_lshlrev_b32 v9, 16, v9
    v_mul_f32 v116, v9, v9
    v_mul_f32 v116, s36, v116
    v_add_f32 v116, s37, v116
    v_mul_f32 v116, v116, v9
    v_mul_f32 v116, s38, v116
    v_exp_f32 v116, v116
    s_nop 0
    v_add_f32 v116, 1.0, v116
    v_rcp_f32 v116, v116
    s_nop 0
    v_mul_f32 v9, v9, v116
    v_cvt_pk_bf16_f32 v10, v10, v10
    v_lshlrev_b32 v10, 16, v10
    v_add_f32 v10, v10, v74
    v_cvt_pk_bf16_f32 v10, v10, v10
    v_lshlrev_b32 v10, 16, v10
    v_mul_f32 v117, v10, v10
    v_mul_f32 v117, s36, v117
    v_add_f32 v117, s37, v117
    v_mul_f32 v117, v117, v10
    v_mul_f32 v117, s38, v117
    v_exp_f32 v117, v117
    s_nop 0
    v_add_f32 v117, 1.0, v117
    v_rcp_f32 v117, v117
    s_nop 0
    v_mul_f32 v10, v10, v117
    v_cvt_pk_bf16_f32 v11, v11, v11
    v_lshlrev_b32 v11, 16, v11
    v_add_f32 v11, v11, v75
    v_cvt_pk_bf16_f32 v11, v11, v11
    v_lshlrev_b32 v11, 16, v11
    v_mul_f32 v118, v11, v11
    v_mul_f32 v118, s36, v118
    v_add_f32 v118, s37, v118
    v_mul_f32 v118, v118, v11
    v_mul_f32 v118, s38, v118
    v_exp_f32 v118, v118
    s_nop 0
    v_add_f32 v118, 1.0, v118
    v_rcp_f32 v118, v118
    s_nop 0
    v_mul_f32 v11, v11, v118
    v_cvt_pk_bf16_f32 v12, v12, v12
    v_lshlrev_b32 v12, 16, v12
    v_add_f32 v12, v12, v76
    v_cvt_pk_bf16_f32 v12, v12, v12
    v_lshlrev_b32 v12, 16, v12
    v_mul_f32 v115, v12, v12
    v_mul_f32 v115, s36, v115
    v_add_f32 v115, s37, v115
    v_mul_f32 v115, v115, v12
    v_mul_f32 v115, s38, v115
    v_exp_f32 v115, v115
    s_nop 0
    v_add_f32 v115, 1.0, v115
    v_rcp_f32 v115, v115
    s_nop 0
    v_mul_f32 v12, v12, v115
    v_cvt_pk_bf16_f32 v13, v13, v13
    v_lshlrev_b32 v13, 16, v13
    v_add_f32 v13, v13, v77
    v_cvt_pk_bf16_f32 v13, v13, v13
    v_lshlrev_b32 v13, 16, v13
    v_mul_f32 v116, v13, v13
    v_mul_f32 v116, s36, v116
    v_add_f32 v116, s37, v116
    v_mul_f32 v116, v116, v13
    v_mul_f32 v116, s38, v116
    v_exp_f32 v116, v116
    s_nop 0
    v_add_f32 v116, 1.0, v116
    v_rcp_f32 v116, v116
    s_nop 0
    v_mul_f32 v13, v13, v116
    v_cvt_pk_bf16_f32 v14, v14, v14
    v_lshlrev_b32 v14, 16, v14
    v_add_f32 v14, v14, v78
    v_cvt_pk_bf16_f32 v14, v14, v14
    v_lshlrev_b32 v14, 16, v14
    v_mul_f32 v117, v14, v14
    v_mul_f32 v117, s36, v117
    v_add_f32 v117, s37, v117
    v_mul_f32 v117, v117, v14
    v_mul_f32 v117, s38, v117
    v_exp_f32 v117, v117
    s_nop 0
    v_add_f32 v117, 1.0, v117
    v_rcp_f32 v117, v117
    s_nop 0
    v_mul_f32 v14, v14, v117
    v_cvt_pk_bf16_f32 v15, v15, v15
    v_lshlrev_b32 v15, 16, v15
    v_add_f32 v15, v15, v79
    v_cvt_pk_bf16_f32 v15, v15, v15
    v_lshlrev_b32 v15, 16, v15
    v_mul_f32 v118, v15, v15
    v_mul_f32 v118, s36, v118
    v_add_f32 v118, s37, v118
    v_mul_f32 v118, v118, v15
    v_mul_f32 v118, s38, v118
    v_exp_f32 v118, v118
    s_nop 0
    v_add_f32 v118, 1.0, v118
    v_rcp_f32 v118, v118
    s_nop 0
    v_mul_f32 v15, v15, v118
    v_cvt_pk_bf16_f32 v124, v0, v1
    v_cvt_pk_bf16_f32 v125, v2, v3
    v_cvt_pk_bf16_f32 v126, v4, v5
    v_cvt_pk_bf16_f32 v127, v6, v7
    s_mov_b32 s39, 0
    buffer_store_dwordx4 v[124:127], v113, s[12:15], s39 offen offset:0
    v_cvt_pk_bf16_f32 v128, v8, v9
    v_cvt_pk_bf16_f32 v129, v10, v11
    v_cvt_pk_bf16_f32 v130, v12, v13
    v_cvt_pk_bf16_f32 v131, v14, v15
    s_mov_b32 s39, 20480
    buffer_store_dwordx4 v[128:131], v113, s[12:15], s39 offen offset:0
    v_cvt_pk_bf16_f32 v16, v16, v16
    v_lshlrev_b32 v16, 16, v16
    v_add_f32 v16, v16, v80
    v_cvt_pk_bf16_f32 v16, v16, v16
    v_lshlrev_b32 v16, 16, v16
    v_mul_f32 v115, v16, v16
    v_mul_f32 v115, s36, v115
    v_add_f32 v115, s37, v115
    v_mul_f32 v115, v115, v16
    v_mul_f32 v115, s38, v115
    v_exp_f32 v115, v115
    s_nop 0
    v_add_f32 v115, 1.0, v115
    v_rcp_f32 v115, v115
    s_nop 0
    v_mul_f32 v16, v16, v115
    v_cvt_pk_bf16_f32 v17, v17, v17
    v_lshlrev_b32 v17, 16, v17
    v_add_f32 v17, v17, v81
    v_cvt_pk_bf16_f32 v17, v17, v17
    v_lshlrev_b32 v17, 16, v17
    v_mul_f32 v116, v17, v17
    v_mul_f32 v116, s36, v116
    v_add_f32 v116, s37, v116
    v_mul_f32 v116, v116, v17
    v_mul_f32 v116, s38, v116
    v_exp_f32 v116, v116
    s_nop 0
    v_add_f32 v116, 1.0, v116
    v_rcp_f32 v116, v116
    s_nop 0
    v_mul_f32 v17, v17, v116
    v_cvt_pk_bf16_f32 v18, v18, v18
    v_lshlrev_b32 v18, 16, v18
    v_add_f32 v18, v18, v82
    v_cvt_pk_bf16_f32 v18, v18, v18
    v_lshlrev_b32 v18, 16, v18
    v_mul_f32 v117, v18, v18
    v_mul_f32 v117, s36, v117
    v_add_f32 v117, s37, v117
    v_mul_f32 v117, v117, v18
    v_mul_f32 v117, s38, v117
    v_exp_f32 v117, v117
    s_nop 0
    v_add_f32 v117, 1.0, v117
    v_rcp_f32 v117, v117
    s_nop 0
    v_mul_f32 v18, v18, v117
    v_cvt_pk_bf16_f32 v19, v19, v19
    v_lshlrev_b32 v19, 16, v19
    v_add_f32 v19, v19, v83
    v_cvt_pk_bf16_f32 v19, v19, v19
    v_lshlrev_b32 v19, 16, v19
    v_mul_f32 v118, v19, v19
    v_mul_f32 v118, s36, v118
    v_add_f32 v118, s37, v118
    v_mul_f32 v118, v118, v19
    v_mul_f32 v118, s38, v118
    v_exp_f32 v118, v118
    s_nop 0
    v_add_f32 v118, 1.0, v118
    v_rcp_f32 v118, v118
    s_nop 0
    v_mul_f32 v19, v19, v118
    v_cvt_pk_bf16_f32 v20, v20, v20
    v_lshlrev_b32 v20, 16, v20
    v_add_f32 v20, v20, v84
    v_cvt_pk_bf16_f32 v20, v20, v20
    v_lshlrev_b32 v20, 16, v20
    v_mul_f32 v115, v20, v20
    v_mul_f32 v115, s36, v115
    v_add_f32 v115, s37, v115
    v_mul_f32 v115, v115, v20
    v_mul_f32 v115, s38, v115
    v_exp_f32 v115, v115
    s_nop 0
    v_add_f32 v115, 1.0, v115
    v_rcp_f32 v115, v115
    s_nop 0
    v_mul_f32 v20, v20, v115
    v_cvt_pk_bf16_f32 v21, v21, v21
    v_lshlrev_b32 v21, 16, v21
    v_add_f32 v21, v21, v85
    v_cvt_pk_bf16_f32 v21, v21, v21
    v_lshlrev_b32 v21, 16, v21
    v_mul_f32 v116, v21, v21
    v_mul_f32 v116, s36, v116
    v_add_f32 v116, s37, v116
    v_mul_f32 v116, v116, v21
    v_mul_f32 v116, s38, v116
    v_exp_f32 v116, v116
    s_nop 0
    v_add_f32 v116, 1.0, v116
    v_rcp_f32 v116, v116
    s_nop 0
    v_mul_f32 v21, v21, v116
    v_cvt_pk_bf16_f32 v22, v22, v22
    v_lshlrev_b32 v22, 16, v22
    v_add_f32 v22, v22, v86
    v_cvt_pk_bf16_f32 v22, v22, v22
    v_lshlrev_b32 v22, 16, v22
    v_mul_f32 v117, v22, v22
    v_mul_f32 v117, s36, v117
    v_add_f32 v117, s37, v117
    v_mul_f32 v117, v117, v22
    v_mul_f32 v117, s38, v117
    v_exp_f32 v117, v117
    s_nop 0
    v_add_f32 v117, 1.0, v117
    v_rcp_f32 v117, v117
    s_nop 0
    v_mul_f32 v22, v22, v117
    v_cvt_pk_bf16_f32 v23, v23, v23
    v_lshlrev_b32 v23, 16, v23
    v_add_f32 v23, v23, v87
    v_cvt_pk_bf16_f32 v23, v23, v23
    v_lshlrev_b32 v23, 16, v23
    v_mul_f32 v118, v23, v23
    v_mul_f32 v118, s36, v118
    v_add_f32 v118, s37, v118
    v_mul_f32 v118, v118, v23
    v_mul_f32 v118, s38, v118
    v_exp_f32 v118, v118
    s_nop 0
    v_add_f32 v118, 1.0, v118
    v_rcp_f32 v118, v118
    s_nop 0
    v_mul_f32 v23, v23, v118
    v_cvt_pk_bf16_f32 v24, v24, v24
    v_lshlrev_b32 v24, 16, v24
    v_add_f32 v24, v24, v88
    v_cvt_pk_bf16_f32 v24, v24, v24
    v_lshlrev_b32 v24, 16, v24
    v_mul_f32 v115, v24, v24
    v_mul_f32 v115, s36, v115
    v_add_f32 v115, s37, v115
    v_mul_f32 v115, v115, v24
    v_mul_f32 v115, s38, v115
    v_exp_f32 v115, v115
    s_nop 0
    v_add_f32 v115, 1.0, v115
    v_rcp_f32 v115, v115
    s_nop 0
    v_mul_f32 v24, v24, v115
    v_cvt_pk_bf16_f32 v25, v25, v25
    v_lshlrev_b32 v25, 16, v25
    v_add_f32 v25, v25, v89
    v_cvt_pk_bf16_f32 v25, v25, v25
    v_lshlrev_b32 v25, 16, v25
    v_mul_f32 v116, v25, v25
    v_mul_f32 v116, s36, v116
    v_add_f32 v116, s37, v116
    v_mul_f32 v116, v116, v25
    v_mul_f32 v116, s38, v116
    v_exp_f32 v116, v116
    s_nop 0
    v_add_f32 v116, 1.0, v116
    v_rcp_f32 v116, v116
    s_nop 0
    v_mul_f32 v25, v25, v116
    v_cvt_pk_bf16_f32 v26, v26, v26
    v_lshlrev_b32 v26, 16, v26
    v_add_f32 v26, v26, v90
    v_cvt_pk_bf16_f32 v26, v26, v26
    v_lshlrev_b32 v26, 16, v26
    v_mul_f32 v117, v26, v26
    v_mul_f32 v117, s36, v117
    v_add_f32 v117, s37, v117
    v_mul_f32 v117, v117, v26
    v_mul_f32 v117, s38, v117
    v_exp_f32 v117, v117
    s_nop 0
    v_add_f32 v117, 1.0, v117
    v_rcp_f32 v117, v117
    s_nop 0
    v_mul_f32 v26, v26, v117
    v_cvt_pk_bf16_f32 v27, v27, v27
    v_lshlrev_b32 v27, 16, v27
    v_add_f32 v27, v27, v91
    v_cvt_pk_bf16_f32 v27, v27, v27
    v_lshlrev_b32 v27, 16, v27
    v_mul_f32 v118, v27, v27
    v_mul_f32 v118, s36, v118
    v_add_f32 v118, s37, v118
    v_mul_f32 v118, v118, v27
    v_mul_f32 v118, s38, v118
    v_exp_f32 v118, v118
    s_nop 0
    v_add_f32 v118, 1.0, v118
    v_rcp_f32 v118, v118
    s_nop 0
    v_mul_f32 v27, v27, v118
    v_cvt_pk_bf16_f32 v28, v28, v28
    v_lshlrev_b32 v28, 16, v28
    v_add_f32 v28, v28, v92
    v_cvt_pk_bf16_f32 v28, v28, v28
    v_lshlrev_b32 v28, 16, v28
    v_mul_f32 v115, v28, v28
    v_mul_f32 v115, s36, v115
    v_add_f32 v115, s37, v115
    v_mul_f32 v115, v115, v28
    v_mul_f32 v115, s38, v115
    v_exp_f32 v115, v115
    s_nop 0
    v_add_f32 v115, 1.0, v115
    v_rcp_f32 v115, v115
    s_nop 0
    v_mul_f32 v28, v28, v115
    v_cvt_pk_bf16_f32 v29, v29, v29
    v_lshlrev_b32 v29, 16, v29
    v_add_f32 v29, v29, v93
    v_cvt_pk_bf16_f32 v29, v29, v29
    v_lshlrev_b32 v29, 16, v29
    v_mul_f32 v116, v29, v29
    v_mul_f32 v116, s36, v116
    v_add_f32 v116, s37, v116
    v_mul_f32 v116, v116, v29
    v_mul_f32 v116, s38, v116
    v_exp_f32 v116, v116
    s_nop 0
    v_add_f32 v116, 1.0, v116
    v_rcp_f32 v116, v116
    s_nop 0
    v_mul_f32 v29, v29, v116
    v_cvt_pk_bf16_f32 v30, v30, v30
    v_lshlrev_b32 v30, 16, v30
    v_add_f32 v30, v30, v94
    v_cvt_pk_bf16_f32 v30, v30, v30
    v_lshlrev_b32 v30, 16, v30
    v_mul_f32 v117, v30, v30
    v_mul_f32 v117, s36, v117
    v_add_f32 v117, s37, v117
    v_mul_f32 v117, v117, v30
    v_mul_f32 v117, s38, v117
    v_exp_f32 v117, v117
    s_nop 0
    v_add_f32 v117, 1.0, v117
    v_rcp_f32 v117, v117
    s_nop 0
    v_mul_f32 v30, v30, v117
    v_cvt_pk_bf16_f32 v31, v31, v31
    v_lshlrev_b32 v31, 16, v31
    v_add_f32 v31, v31, v95
    v_cvt_pk_bf16_f32 v31, v31, v31
    v_lshlrev_b32 v31, 16, v31
    v_mul_f32 v118, v31, v31
    v_mul_f32 v118, s36, v118
    v_add_f32 v118, s37, v118
    v_mul_f32 v118, v118, v31
    v_mul_f32 v118, s38, v118
    v_exp_f32 v118, v118
    s_nop 0
    v_add_f32 v118, 1.0, v118
    v_rcp_f32 v118, v118
    s_nop 0
    v_mul_f32 v31, v31, v118
    v_cvt_pk_bf16_f32 v132, v16, v17
    v_cvt_pk_bf16_f32 v133, v18, v19
    v_cvt_pk_bf16_f32 v134, v20, v21
    v_cvt_pk_bf16_f32 v135, v22, v23
    s_mov_b32 s39, 40960
    buffer_store_dwordx4 v[132:135], v113, s[12:15], s39 offen offset:0
    v_cvt_pk_bf16_f32 v136, v24, v25
    v_cvt_pk_bf16_f32 v137, v26, v27
    v_cvt_pk_bf16_f32 v138, v28, v29
    v_cvt_pk_bf16_f32 v139, v30, v31
    s_mov_b32 s39, 61440
    buffer_store_dwordx4 v[136:139], v113, s[12:15], s39 offen offset:0
    v_cvt_pk_bf16_f32 v32, v32, v32
    v_lshlrev_b32 v32, 16, v32
    v_add_f32 v32, v32, v64
    v_cvt_pk_bf16_f32 v32, v32, v32
    v_lshlrev_b32 v32, 16, v32
    v_mul_f32 v115, v32, v32
    v_mul_f32 v115, s36, v115
    v_add_f32 v115, s37, v115
    v_mul_f32 v115, v115, v32
    v_mul_f32 v115, s38, v115
    v_exp_f32 v115, v115
    s_nop 0
    v_add_f32 v115, 1.0, v115
    v_rcp_f32 v115, v115
    s_nop 0
    v_mul_f32 v32, v32, v115
    v_cvt_pk_bf16_f32 v33, v33, v33
    v_lshlrev_b32 v33, 16, v33
    v_add_f32 v33, v33, v65
    v_cvt_pk_bf16_f32 v33, v33, v33
    v_lshlrev_b32 v33, 16, v33
    v_mul_f32 v116, v33, v33
    v_mul_f32 v116, s36, v116
    v_add_f32 v116, s37, v116
    v_mul_f32 v116, v116, v33
    v_mul_f32 v116, s38, v116
    v_exp_f32 v116, v116
    s_nop 0
    v_add_f32 v116, 1.0, v116
    v_rcp_f32 v116, v116
    s_nop 0
    v_mul_f32 v33, v33, v116
    v_cvt_pk_bf16_f32 v34, v34, v34
    v_lshlrev_b32 v34, 16, v34
    v_add_f32 v34, v34, v66
    v_cvt_pk_bf16_f32 v34, v34, v34
    v_lshlrev_b32 v34, 16, v34
    v_mul_f32 v117, v34, v34
    v_mul_f32 v117, s36, v117
    v_add_f32 v117, s37, v117
    v_mul_f32 v117, v117, v34
    v_mul_f32 v117, s38, v117
    v_exp_f32 v117, v117
    s_nop 0
    v_add_f32 v117, 1.0, v117
    v_rcp_f32 v117, v117
    s_nop 0
    v_mul_f32 v34, v34, v117
    v_cvt_pk_bf16_f32 v35, v35, v35
    v_lshlrev_b32 v35, 16, v35
    v_add_f32 v35, v35, v67
    v_cvt_pk_bf16_f32 v35, v35, v35
    v_lshlrev_b32 v35, 16, v35
    v_mul_f32 v118, v35, v35
    v_mul_f32 v118, s36, v118
    v_add_f32 v118, s37, v118
    v_mul_f32 v118, v118, v35
    v_mul_f32 v118, s38, v118
    v_exp_f32 v118, v118
    s_nop 0
    v_add_f32 v118, 1.0, v118
    v_rcp_f32 v118, v118
    s_nop 0
    v_mul_f32 v35, v35, v118
    v_cvt_pk_bf16_f32 v36, v36, v36
    v_lshlrev_b32 v36, 16, v36
    v_add_f32 v36, v36, v68
    v_cvt_pk_bf16_f32 v36, v36, v36
    v_lshlrev_b32 v36, 16, v36
    v_mul_f32 v115, v36, v36
    v_mul_f32 v115, s36, v115
    v_add_f32 v115, s37, v115
    v_mul_f32 v115, v115, v36
    v_mul_f32 v115, s38, v115
    v_exp_f32 v115, v115
    s_nop 0
    v_add_f32 v115, 1.0, v115
    v_rcp_f32 v115, v115
    s_nop 0
    v_mul_f32 v36, v36, v115
    v_cvt_pk_bf16_f32 v37, v37, v37
    v_lshlrev_b32 v37, 16, v37
    v_add_f32 v37, v37, v69
    v_cvt_pk_bf16_f32 v37, v37, v37
    v_lshlrev_b32 v37, 16, v37
    v_mul_f32 v116, v37, v37
    v_mul_f32 v116, s36, v116
    v_add_f32 v116, s37, v116
    v_mul_f32 v116, v116, v37
    v_mul_f32 v116, s38, v116
    v_exp_f32 v116, v116
    s_nop 0
    v_add_f32 v116, 1.0, v116
    v_rcp_f32 v116, v116
    s_nop 0
    v_mul_f32 v37, v37, v116
    v_cvt_pk_bf16_f32 v38, v38, v38
    v_lshlrev_b32 v38, 16, v38
    v_add_f32 v38, v38, v70
    v_cvt_pk_bf16_f32 v38, v38, v38
    v_lshlrev_b32 v38, 16, v38
    v_mul_f32 v117, v38, v38
    v_mul_f32 v117, s36, v117
    v_add_f32 v117, s37, v117
    v_mul_f32 v117, v117, v38
    v_mul_f32 v117, s38, v117
    v_exp_f32 v117, v117
    s_nop 0
    v_add_f32 v117, 1.0, v117
    v_rcp_f32 v117, v117
    s_nop 0
    v_mul_f32 v38, v38, v117
    v_cvt_pk_bf16_f32 v39, v39, v39
    v_lshlrev_b32 v39, 16, v39
    v_add_f32 v39, v39, v71
    v_cvt_pk_bf16_f32 v39, v39, v39
    v_lshlrev_b32 v39, 16, v39
    v_mul_f32 v118, v39, v39
    v_mul_f32 v118, s36, v118
    v_add_f32 v118, s37, v118
    v_mul_f32 v118, v118, v39
    v_mul_f32 v118, s38, v118
    v_exp_f32 v118, v118
    s_nop 0
    v_add_f32 v118, 1.0, v118
    v_rcp_f32 v118, v118
    s_nop 0
    v_mul_f32 v39, v39, v118
    v_cvt_pk_bf16_f32 v40, v40, v40
    v_lshlrev_b32 v40, 16, v40
    v_add_f32 v40, v40, v72
    v_cvt_pk_bf16_f32 v40, v40, v40
    v_lshlrev_b32 v40, 16, v40
    v_mul_f32 v115, v40, v40
    v_mul_f32 v115, s36, v115
    v_add_f32 v115, s37, v115
    v_mul_f32 v115, v115, v40
    v_mul_f32 v115, s38, v115
    v_exp_f32 v115, v115
    s_nop 0
    v_add_f32 v115, 1.0, v115
    v_rcp_f32 v115, v115
    s_nop 0
    v_mul_f32 v40, v40, v115
    v_cvt_pk_bf16_f32 v41, v41, v41
    v_lshlrev_b32 v41, 16, v41
    v_add_f32 v41, v41, v73
    v_cvt_pk_bf16_f32 v41, v41, v41
    v_lshlrev_b32 v41, 16, v41
    v_mul_f32 v116, v41, v41
    v_mul_f32 v116, s36, v116
    v_add_f32 v116, s37, v116
    v_mul_f32 v116, v116, v41
    v_mul_f32 v116, s38, v116
    v_exp_f32 v116, v116
    s_nop 0
    v_add_f32 v116, 1.0, v116
    v_rcp_f32 v116, v116
    s_nop 0
    v_mul_f32 v41, v41, v116
    v_cvt_pk_bf16_f32 v42, v42, v42
    v_lshlrev_b32 v42, 16, v42
    v_add_f32 v42, v42, v74
    v_cvt_pk_bf16_f32 v42, v42, v42
    v_lshlrev_b32 v42, 16, v42
    v_mul_f32 v117, v42, v42
    v_mul_f32 v117, s36, v117
    v_add_f32 v117, s37, v117
    v_mul_f32 v117, v117, v42
    v_mul_f32 v117, s38, v117
    v_exp_f32 v117, v117
    s_nop 0
    v_add_f32 v117, 1.0, v117
    v_rcp_f32 v117, v117
    s_nop 0
    v_mul_f32 v42, v42, v117
    v_cvt_pk_bf16_f32 v43, v43, v43
    v_lshlrev_b32 v43, 16, v43
    v_add_f32 v43, v43, v75
    v_cvt_pk_bf16_f32 v43, v43, v43
    v_lshlrev_b32 v43, 16, v43
    v_mul_f32 v118, v43, v43
    v_mul_f32 v118, s36, v118
    v_add_f32 v118, s37, v118
    v_mul_f32 v118, v118, v43
    v_mul_f32 v118, s38, v118
    v_exp_f32 v118, v118
    s_nop 0
    v_add_f32 v118, 1.0, v118
    v_rcp_f32 v118, v118
    s_nop 0
    v_mul_f32 v43, v43, v118
    v_cvt_pk_bf16_f32 v44, v44, v44
    v_lshlrev_b32 v44, 16, v44
    v_add_f32 v44, v44, v76
    v_cvt_pk_bf16_f32 v44, v44, v44
    v_lshlrev_b32 v44, 16, v44
    v_mul_f32 v115, v44, v44
    v_mul_f32 v115, s36, v115
    v_add_f32 v115, s37, v115
    v_mul_f32 v115, v115, v44
    v_mul_f32 v115, s38, v115
    v_exp_f32 v115, v115
    s_nop 0
    v_add_f32 v115, 1.0, v115
    v_rcp_f32 v115, v115
    s_nop 0
    v_mul_f32 v44, v44, v115
    v_cvt_pk_bf16_f32 v45, v45, v45
    v_lshlrev_b32 v45, 16, v45
    v_add_f32 v45, v45, v77
    v_cvt_pk_bf16_f32 v45, v45, v45
    v_lshlrev_b32 v45, 16, v45
    v_mul_f32 v116, v45, v45
    v_mul_f32 v116, s36, v116
    v_add_f32 v116, s37, v116
    v_mul_f32 v116, v116, v45
    v_mul_f32 v116, s38, v116
    v_exp_f32 v116, v116
    s_nop 0
    v_add_f32 v116, 1.0, v116
    v_rcp_f32 v116, v116
    s_nop 0
    v_mul_f32 v45, v45, v116
    v_cvt_pk_bf16_f32 v46, v46, v46
    v_lshlrev_b32 v46, 16, v46
    v_add_f32 v46, v46, v78
    v_cvt_pk_bf16_f32 v46, v46, v46
    v_lshlrev_b32 v46, 16, v46
    v_mul_f32 v117, v46, v46
    v_mul_f32 v117, s36, v117
    v_add_f32 v117, s37, v117
    v_mul_f32 v117, v117, v46
    v_mul_f32 v117, s38, v117
    v_exp_f32 v117, v117
    s_nop 0
    v_add_f32 v117, 1.0, v117
    v_rcp_f32 v117, v117
    s_nop 0
    v_mul_f32 v46, v46, v117
    v_cvt_pk_bf16_f32 v47, v47, v47
    v_lshlrev_b32 v47, 16, v47
    v_add_f32 v47, v47, v79
    v_cvt_pk_bf16_f32 v47, v47, v47
    v_lshlrev_b32 v47, 16, v47
    v_mul_f32 v118, v47, v47
    v_mul_f32 v118, s36, v118
    v_add_f32 v118, s37, v118
    v_mul_f32 v118, v118, v47
    v_mul_f32 v118, s38, v118
    v_exp_f32 v118, v118
    s_nop 0
    v_add_f32 v118, 1.0, v118
    v_rcp_f32 v118, v118
    s_nop 0
    v_mul_f32 v47, v47, v118
    v_cvt_pk_bf16_f32 v124, v32, v33
    v_cvt_pk_bf16_f32 v125, v34, v35
    v_cvt_pk_bf16_f32 v126, v36, v37
    v_cvt_pk_bf16_f32 v127, v38, v39
    s_mov_b32 s39, 0
    buffer_store_dwordx4 v[124:127], v113, s[12:15], s39 offen offset:1024
    v_cvt_pk_bf16_f32 v128, v40, v41
    v_cvt_pk_bf16_f32 v129, v42, v43
    v_cvt_pk_bf16_f32 v130, v44, v45
    v_cvt_pk_bf16_f32 v131, v46, v47
    s_mov_b32 s39, 20480
    buffer_store_dwordx4 v[128:131], v113, s[12:15], s39 offen offset:1024
    v_cvt_pk_bf16_f32 v48, v48, v48
    v_lshlrev_b32 v48, 16, v48
    v_add_f32 v48, v48, v80
    v_cvt_pk_bf16_f32 v48, v48, v48
    v_lshlrev_b32 v48, 16, v48
    v_mul_f32 v115, v48, v48
    v_mul_f32 v115, s36, v115
    v_add_f32 v115, s37, v115
    v_mul_f32 v115, v115, v48
    v_mul_f32 v115, s38, v115
    v_exp_f32 v115, v115
    s_nop 0
    v_add_f32 v115, 1.0, v115
    v_rcp_f32 v115, v115
    s_nop 0
    v_mul_f32 v48, v48, v115
    v_cvt_pk_bf16_f32 v49, v49, v49
    v_lshlrev_b32 v49, 16, v49
    v_add_f32 v49, v49, v81
    v_cvt_pk_bf16_f32 v49, v49, v49
    v_lshlrev_b32 v49, 16, v49
    v_mul_f32 v116, v49, v49
    v_mul_f32 v116, s36, v116
    v_add_f32 v116, s37, v116
    v_mul_f32 v116, v116, v49
    v_mul_f32 v116, s38, v116
    v_exp_f32 v116, v116
    s_nop 0
    v_add_f32 v116, 1.0, v116
    v_rcp_f32 v116, v116
    s_nop 0
    v_mul_f32 v49, v49, v116
    v_cvt_pk_bf16_f32 v50, v50, v50
    v_lshlrev_b32 v50, 16, v50
    v_add_f32 v50, v50, v82
    v_cvt_pk_bf16_f32 v50, v50, v50
    v_lshlrev_b32 v50, 16, v50
    v_mul_f32 v117, v50, v50
    v_mul_f32 v117, s36, v117
    v_add_f32 v117, s37, v117
    v_mul_f32 v117, v117, v50
    v_mul_f32 v117, s38, v117
    v_exp_f32 v117, v117
    s_nop 0
    v_add_f32 v117, 1.0, v117
    v_rcp_f32 v117, v117
    s_nop 0
    v_mul_f32 v50, v50, v117
    v_cvt_pk_bf16_f32 v51, v51, v51
    v_lshlrev_b32 v51, 16, v51
    v_add_f32 v51, v51, v83
    v_cvt_pk_bf16_f32 v51, v51, v51
    v_lshlrev_b32 v51, 16, v51
    v_mul_f32 v118, v51, v51
    v_mul_f32 v118, s36, v118
    v_add_f32 v118, s37, v118
    v_mul_f32 v118, v118, v51
    v_mul_f32 v118, s38, v118
    v_exp_f32 v118, v118
    s_nop 0
    v_add_f32 v118, 1.0, v118
    v_rcp_f32 v118, v118
    s_nop 0
    v_mul_f32 v51, v51, v118
    v_cvt_pk_bf16_f32 v52, v52, v52
    v_lshlrev_b32 v52, 16, v52
    v_add_f32 v52, v52, v84
    v_cvt_pk_bf16_f32 v52, v52, v52
    v_lshlrev_b32 v52, 16, v52
    v_mul_f32 v115, v52, v52
    v_mul_f32 v115, s36, v115
    v_add_f32 v115, s37, v115
    v_mul_f32 v115, v115, v52
    v_mul_f32 v115, s38, v115
    v_exp_f32 v115, v115
    s_nop 0
    v_add_f32 v115, 1.0, v115
    v_rcp_f32 v115, v115
    s_nop 0
    v_mul_f32 v52, v52, v115
    v_cvt_pk_bf16_f32 v53, v53, v53
    v_lshlrev_b32 v53, 16, v53
    v_add_f32 v53, v53, v85
    v_cvt_pk_bf16_f32 v53, v53, v53
    v_lshlrev_b32 v53, 16, v53
    v_mul_f32 v116, v53, v53
    v_mul_f32 v116, s36, v116
    v_add_f32 v116, s37, v116
    v_mul_f32 v116, v116, v53
    v_mul_f32 v116, s38, v116
    v_exp_f32 v116, v116
    s_nop 0
    v_add_f32 v116, 1.0, v116
    v_rcp_f32 v116, v116
    s_nop 0
    v_mul_f32 v53, v53, v116
    v_cvt_pk_bf16_f32 v54, v54, v54
    v_lshlrev_b32 v54, 16, v54
    v_add_f32 v54, v54, v86
    v_cvt_pk_bf16_f32 v54, v54, v54
    v_lshlrev_b32 v54, 16, v54
    v_mul_f32 v117, v54, v54
    v_mul_f32 v117, s36, v117
    v_add_f32 v117, s37, v117
    v_mul_f32 v117, v117, v54
    v_mul_f32 v117, s38, v117
    v_exp_f32 v117, v117
    s_nop 0
    v_add_f32 v117, 1.0, v117
    v_rcp_f32 v117, v117
    s_nop 0
    v_mul_f32 v54, v54, v117
    v_cvt_pk_bf16_f32 v55, v55, v55
    v_lshlrev_b32 v55, 16, v55
    v_add_f32 v55, v55, v87
    v_cvt_pk_bf16_f32 v55, v55, v55
    v_lshlrev_b32 v55, 16, v55
    v_mul_f32 v118, v55, v55
    v_mul_f32 v118, s36, v118
    v_add_f32 v118, s37, v118
    v_mul_f32 v118, v118, v55
    v_mul_f32 v118, s38, v118
    v_exp_f32 v118, v118
    s_nop 0
    v_add_f32 v118, 1.0, v118
    v_rcp_f32 v118, v118
    s_nop 0
    v_mul_f32 v55, v55, v118
    v_cvt_pk_bf16_f32 v56, v56, v56
    v_lshlrev_b32 v56, 16, v56
    v_add_f32 v56, v56, v88
    v_cvt_pk_bf16_f32 v56, v56, v56
    v_lshlrev_b32 v56, 16, v56
    v_mul_f32 v115, v56, v56
    v_mul_f32 v115, s36, v115
    v_add_f32 v115, s37, v115
    v_mul_f32 v115, v115, v56
    v_mul_f32 v115, s38, v115
    v_exp_f32 v115, v115
    s_nop 0
    v_add_f32 v115, 1.0, v115
    v_rcp_f32 v115, v115
    s_nop 0
    v_mul_f32 v56, v56, v115
    v_cvt_pk_bf16_f32 v57, v57, v57
    v_lshlrev_b32 v57, 16, v57
    v_add_f32 v57, v57, v89
    v_cvt_pk_bf16_f32 v57, v57, v57
    v_lshlrev_b32 v57, 16, v57
    v_mul_f32 v116, v57, v57
    v_mul_f32 v116, s36, v116
    v_add_f32 v116, s37, v116
    v_mul_f32 v116, v116, v57
    v_mul_f32 v116, s38, v116
    v_exp_f32 v116, v116
    s_nop 0
    v_add_f32 v116, 1.0, v116
    v_rcp_f32 v116, v116
    s_nop 0
    v_mul_f32 v57, v57, v116
    v_cvt_pk_bf16_f32 v58, v58, v58
    v_lshlrev_b32 v58, 16, v58
    v_add_f32 v58, v58, v90
    v_cvt_pk_bf16_f32 v58, v58, v58
    v_lshlrev_b32 v58, 16, v58
    v_mul_f32 v117, v58, v58
    v_mul_f32 v117, s36, v117
    v_add_f32 v117, s37, v117
    v_mul_f32 v117, v117, v58
    v_mul_f32 v117, s38, v117
    v_exp_f32 v117, v117
    s_nop 0
    v_add_f32 v117, 1.0, v117
    v_rcp_f32 v117, v117
    s_nop 0
    v_mul_f32 v58, v58, v117
    v_cvt_pk_bf16_f32 v59, v59, v59
    v_lshlrev_b32 v59, 16, v59
    v_add_f32 v59, v59, v91
    v_cvt_pk_bf16_f32 v59, v59, v59
    v_lshlrev_b32 v59, 16, v59
    v_mul_f32 v118, v59, v59
    v_mul_f32 v118, s36, v118
    v_add_f32 v118, s37, v118
    v_mul_f32 v118, v118, v59
    v_mul_f32 v118, s38, v118
    v_exp_f32 v118, v118
    s_nop 0
    v_add_f32 v118, 1.0, v118
    v_rcp_f32 v118, v118
    s_nop 0
    v_mul_f32 v59, v59, v118
    v_cvt_pk_bf16_f32 v60, v60, v60
    v_lshlrev_b32 v60, 16, v60
    v_add_f32 v60, v60, v92
    v_cvt_pk_bf16_f32 v60, v60, v60
    v_lshlrev_b32 v60, 16, v60
    v_mul_f32 v115, v60, v60
    v_mul_f32 v115, s36, v115
    v_add_f32 v115, s37, v115
    v_mul_f32 v115, v115, v60
    v_mul_f32 v115, s38, v115
    v_exp_f32 v115, v115
    s_nop 0
    v_add_f32 v115, 1.0, v115
    v_rcp_f32 v115, v115
    s_nop 0
    v_mul_f32 v60, v60, v115
    v_cvt_pk_bf16_f32 v61, v61, v61
    v_lshlrev_b32 v61, 16, v61
    v_add_f32 v61, v61, v93
    v_cvt_pk_bf16_f32 v61, v61, v61
    v_lshlrev_b32 v61, 16, v61
    v_mul_f32 v116, v61, v61
    v_mul_f32 v116, s36, v116
    v_add_f32 v116, s37, v116
    v_mul_f32 v116, v116, v61
    v_mul_f32 v116, s38, v116
    v_exp_f32 v116, v116
    s_nop 0
    v_add_f32 v116, 1.0, v116
    v_rcp_f32 v116, v116
    s_nop 0
    v_mul_f32 v61, v61, v116
    v_cvt_pk_bf16_f32 v62, v62, v62
    v_lshlrev_b32 v62, 16, v62
    v_add_f32 v62, v62, v94
    v_cvt_pk_bf16_f32 v62, v62, v62
    v_lshlrev_b32 v62, 16, v62
    v_mul_f32 v117, v62, v62
    v_mul_f32 v117, s36, v117
    v_add_f32 v117, s37, v117
    v_mul_f32 v117, v117, v62
    v_mul_f32 v117, s38, v117
    v_exp_f32 v117, v117
    s_nop 0
    v_add_f32 v117, 1.0, v117
    v_rcp_f32 v117, v117
    s_nop 0
    v_mul_f32 v62, v62, v117
    v_cvt_pk_bf16_f32 v63, v63, v63
    v_lshlrev_b32 v63, 16, v63
    v_add_f32 v63, v63, v95
    v_cvt_pk_bf16_f32 v63, v63, v63
    v_lshlrev_b32 v63, 16, v63
    v_mul_f32 v118, v63, v63
    v_mul_f32 v118, s36, v118
    v_add_f32 v118, s37, v118
    v_mul_f32 v118, v118, v63
    v_mul_f32 v118, s38, v118
    v_exp_f32 v118, v118
    s_nop 0
    v_add_f32 v118, 1.0, v118
    v_rcp_f32 v118, v118
    s_nop 0
    v_mul_f32 v63, v63, v118
    v_cvt_pk_bf16_f32 v132, v48, v49
    v_cvt_pk_bf16_f32 v133, v50, v51
    v_cvt_pk_bf16_f32 v134, v52, v53
    v_cvt_pk_bf16_f32 v135, v54, v55
    s_mov_b32 s39, 40960
    buffer_store_dwordx4 v[132:135], v113, s[12:15], s39 offen offset:1024
    v_cvt_pk_bf16_f32 v136, v56, v57
    v_cvt_pk_bf16_f32 v137, v58, v59
    v_cvt_pk_bf16_f32 v138, v60, v61
    v_cvt_pk_bf16_f32 v139, v62, v63
    s_mov_b32 s39, 61440
    buffer_store_dwordx4 v[136:139], v113, s[12:15], s39 offen offset:1024
    s_endpgm
G1_Q_4:
    s_cmp_ge_u32 s2, 168
    s_cbranch_scc1 G1_K_5
    s_sub_u32 s20, s2, 40
    s_and_b32 s21, s20, 7
    s_lshr_b32 s20, s20, 3
    s_and_b32 s22, s21, 3
    s_lshl_b32 s22, s22, 1
    s_and_b32 s25, s20, 1
    s_add_u32 s22, s22, s25
    s_lshl_b32 s22, s22, 8
    s_lshr_b32 s23, s21, 2
    s_lshl_b32 s23, s23, 3
    s_lshr_b32 s25, s20, 1
    s_add_u32 s23, s23, s25
    s_lshl_b32 s23, s23, 8
    s_mov_b32 s4, s52
    s_and_b32 s5, s53, 0xffff
    s_mov_b32 s6, 0x280000
    s_mov_b32 s7, 0x00020000
    s_mov_b32 s8, s42
    s_and_b32 s9, s43, 0xffff
    s_mov_b32 s10, 0x500000
    s_mov_b32 s11, 0x00020000
    s_add_u32 s12, s52, 0x1000000
    s_addc_u32 s13, s53, 0
    s_and_b32 s13, s13, 0xffff
    s_mov_b32 s14, 0x1000000
    s_mov_b32 s15, 0x00020000
    v_mov_b32 v220, v0
    v_and_b32 v192, 63, v220
    v_lshrrev_b32 v193, 6, v220
    s_nop 0
    v_readfirstlane_b32 s24, v193
    s_lshr_b32 s27, s24, 2
    s_and_b32 s28, s24, 3
    v_and_b32 v194, 31, v192
    s_mul_i32 s25, s27, 128
    v_add_u32 v194, s25, v194
    v_lshlrev_b32 v194, 5, v194
    v_lshrrev_b32 v195, 5, v192
    v_bfe_u32 v196, v192, 3, 1
    v_xor_b32 v196, v195, v196
    v_lshl_add_u32 v176, v196, 4, v194
    v_add_u32 v177, 32768, v176
    v_add_u32 v178, 65536, v176
    v_add_u32 v179, 98304, v176
    v_bfe_u32 v197, v192, 2, 2
    v_lshl_add_u32 v198, v195, 3, v197
    v_mul_u32_u24 v198, 512, v198
    v_bfe_u32 v199, v192, 4, 1
    v_lshlrev_b32 v199, 1, v199
    v_bfe_u32 v200, v192, 1, 1
    v_add_u32 v199, v199, v200
    s_mul_i32 s25, s28, 8
    v_add_u32 v199, s25, v199
    v_lshlrev_b32 v200, 2, v197
    v_and_b32 v201, 1, v192
    v_lshlrev_b32 v201, 3, v201
    v_add_u32 v198, v198, v201
    v_add_u32 v198, 16384, v198
    v_add_u32 v201, 0, v199
    v_xor_b32 v201, v201, v200
    v_lshl_add_u32 v180, v201, 4, v198
    v_add_u32 v182, 32768, v180
    v_add_u32 v184, 65536, v180
    v_add_u32 v186, 98304, v180
    v_add_u32 v201, 4, v199
    v_xor_b32 v201, v201, v200
    v_lshl_add_u32 v181, v201, 4, v198
    v_add_u32 v183, 32768, v181
    v_add_u32 v185, 65536, v181
    v_add_u32 v187, 98304, v181
    s_mul_i32 s30, s24, 2048
    s_mul_i32 s31, s24, 2048
    s_add_u32 s31, s31, 16384
    v_lshlrev_b32 v196, 4, v192
    s_mul_i32 s25, s24, 2
    s_add_u32 s25, s25, 0
    s_lshr_b32 s26, s25, 3
    s_and_b32 s25, s25, 7
    s_mul_i32 s26, s26, 2048
    s_lshl_b32 s25, s25, 5
    s_add_u32 s25, s25, s26
    s_add_u32 s25, s25, s22
    s_lshl_b32 s25, s25, 5
    v_add_u32 v188, s25, v196
    s_mul_i32 s25, s24, 2
    s_add_u32 s25, s25, 1
    s_lshr_b32 s26, s25, 3
    s_and_b32 s25, s25, 7
    s_mul_i32 s26, s26, 2048
    s_lshl_b32 s25, s25, 5
    s_add_u32 s25, s25, s26
    s_add_u32 s25, s25, s22
    s_lshl_b32 s25, s25, 5
    v_add_u32 v189, s25, v196
    s_mov_b32 s26, 8192
    s_lshl_b32 s29, s23, 1
    s_mul_i32 s25, s24, 4
    s_add_u32 s25, s25, 0
    v_lshrrev_b32 v196, 5, v192
    v_add_u32 v196, s25, v196
    v_and_b32 v197, 3, v196
    v_lshlrev_b32 v197, 2, v197
    v_and_b32 v198, 31, v192
    v_xor_b32 v197, v197, v198
    v_mul_lo_u32 v196, v196, s26
    v_lshl_add_u32 v196, v197, 4, v196
    v_add_u32 v190, s29, v196
    s_mul_i32 s25, s24, 4
    s_add_u32 s25, s25, 2
    v_lshrrev_b32 v196, 5, v192
    v_add_u32 v196, s25, v196
    v_and_b32 v197, 3, v196
    v_lshlrev_b32 v197, 2, v197
    v_and_b32 v198, 31, v192
    v_xor_b32 v197, v197, v198
    v_mul_lo_u32 v196, v196, s26
    v_lshl_add_u32 v196, v197, 4, v196
    v_add_u32 v191, s29, v196
    v_mov_b32 v0, 0
    v_mov_b32 v1, 0
    v_mov_b32 v2, 0
    v_mov_b32 v3, 0
    v_mov_b32 v4, 0
    v_mov_b32 v5, 0
    v_mov_b32 v6, 0
    v_mov_b32 v7, 0
    v_mov_b32 v8, 0
    v_mov_b32 v9, 0
    v_mov_b32 v10, 0
    v_mov_b32 v11, 0
    v_mov_b32 v12, 0
    v_mov_b32 v13, 0
    v_mov_b32 v14, 0
    v_mov_b32 v15, 0
    v_mov_b32 v16, 0
    v_mov_b32 v17, 0
    v_mov_b32 v18, 0
    v_mov_b32 v19, 0
    v_mov_b32 v20, 0
    v_mov_b32 v21, 0
    v_mov_b32 v22, 0
    v_mov_b32 v23, 0
    v_mov_b32 v24, 0
    v_mov_b32 v25, 0
    v_mov_b32 v26, 0
    v_mov_b32 v27, 0
    v_mov_b32 v28, 0
    v_mov_b32 v29, 0
    v_mov_b32 v30, 0
    v_mov_b32 v31, 0
    v_mov_b32 v32, 0
    v_mov_b32 v33, 0
    v_mov_b32 v34, 0
    v_mov_b32 v35, 0
    v_mov_b32 v36, 0
    v_mov_b32 v37, 0
    v_mov_b32 v38, 0
    v_mov_b32 v39, 0
    v_mov_b32 v40, 0
    v_mov_b32 v41, 0
    v_mov_b32 v42, 0
    v_mov_b32 v43, 0
    v_mov_b32 v44, 0
    v_mov_b32 v45, 0
    v_mov_b32 v46, 0
    v_mov_b32 v47, 0
    v_mov_b32 v48, 0
    v_mov_b32 v49, 0
    v_mov_b32 v50, 0
    v_mov_b32 v51, 0
    v_mov_b32 v52, 0
    v_mov_b32 v53, 0
    v_mov_b32 v54, 0
    v_mov_b32 v55, 0
    v_mov_b32 v56, 0
    v_mov_b32 v57, 0
    v_mov_b32 v58, 0
    v_mov_b32 v59, 0
    v_mov_b32 v60, 0
    v_mov_b32 v61, 0
    v_mov_b32 v62, 0
    v_mov_b32 v63, 0
    v_mov_b32 v64, 0
    v_mov_b32 v65, 0
    v_mov_b32 v66, 0
    v_mov_b32 v67, 0
    v_mov_b32 v68, 0
    v_mov_b32 v69, 0
    v_mov_b32 v70, 0
    v_mov_b32 v71, 0
    v_mov_b32 v72, 0
    v_mov_b32 v73, 0
    v_mov_b32 v74, 0
    v_mov_b32 v75, 0
    v_mov_b32 v76, 0
    v_mov_b32 v77, 0
    v_mov_b32 v78, 0
    v_mov_b32 v79, 0
    v_mov_b32 v80, 0
    v_mov_b32 v81, 0
    v_mov_b32 v82, 0
    v_mov_b32 v83, 0
    v_mov_b32 v84, 0
    v_mov_b32 v85, 0
    v_mov_b32 v86, 0
    v_mov_b32 v87, 0
    v_mov_b32 v88, 0
    v_mov_b32 v89, 0
    v_mov_b32 v90, 0
    v_mov_b32 v91, 0
    v_mov_b32 v92, 0
    v_mov_b32 v93, 0
    v_mov_b32 v94, 0
    v_mov_b32 v95, 0
    v_mov_b32 v96, 0
    v_mov_b32 v97, 0
    v_mov_b32 v98, 0
    v_mov_b32 v99, 0
    v_mov_b32 v100, 0
    v_mov_b32 v101, 0
    v_mov_b32 v102, 0
    v_mov_b32 v103, 0
    v_mov_b32 v104, 0
    v_mov_b32 v105, 0
    v_mov_b32 v106, 0
    v_mov_b32 v107, 0
    v_mov_b32 v108, 0
    v_mov_b32 v109, 0
    v_mov_b32 v110, 0
    v_mov_b32 v111, 0
    v_mov_b32 v112, 0
    v_mov_b32 v113, 0
    v_mov_b32 v114, 0
    v_mov_b32 v115, 0
    v_mov_b32 v116, 0
    v_mov_b32 v117, 0
    v_mov_b32 v118, 0
    v_mov_b32 v119, 0
    v_mov_b32 v120, 0
    v_mov_b32 v121, 0
    v_mov_b32 v122, 0
    v_mov_b32 v123, 0
    v_mov_b32 v124, 0
    v_mov_b32 v125, 0
    v_mov_b32 v126, 0
    v_mov_b32 v127, 0
    s_mov_b32 s32, 0
    s_mov_b32 s33, 0
    s_add_u32 m0, s30, 0
    s_nop 0
    buffer_load_dwordx4 v188, s[4:7], s32 offen lds
    s_add_u32 m0, s30, 1024
    s_nop 0
    buffer_load_dwordx4 v189, s[4:7], s32 offen lds
    s_add_u32 m0, s31, 0
    s_nop 0
    buffer_load_dwordx4 v190, s[8:11], s33 offen lds
    s_add_u32 m0, s31, 1024
    s_nop 0
    buffer_load_dwordx4 v191, s[8:11], s33 offen lds
    s_add_u32 s32, s32, 131072
    s_add_u32 s33, s33, 262144
    s_add_u32 m0, s30, 32768
    s_nop 0
    buffer_load_dwordx4 v188, s[4:7], s32 offen lds
    s_add_u32 m0, s30, 33792
    s_nop 0
    buffer_load_dwordx4 v189, s[4:7], s32 offen lds
    s_add_u32 m0, s31, 32768
    s_nop 0
    buffer_load_dwordx4 v190, s[8:11], s33 offen lds
    s_add_u32 m0, s31, 33792
    s_nop 0
    buffer_load_dwordx4 v191, s[8:11], s33 offen lds
    s_add_u32 s32, s32, 131072
    s_add_u32 s33, s33, 262144
    s_add_u32 m0, s30, 65536
    s_nop 0
    buffer_load_dwordx4 v188, s[4:7], s32 offen lds
    s_add_u32 m0, s30, 66560
    s_nop 0
    buffer_load_dwordx4 v189, s[4:7], s32 offen lds
    s_add_u32 m0, s31, 65536
    s_nop 0
    buffer_load_dwordx4 v190, s[8:11], s33 offen lds
    s_add_u32 m0, s31, 66560
    s_nop 0
    buffer_load_dwordx4 v191, s[8:11], s33 offen lds
    s_add_u32 s32, s32, 131072
    s_add_u32 s33, s33, 262144
    s_add_u32 m0, s30, 98304
    s_nop 0
    buffer_load_dwordx4 v188, s[4:7], s32 offen lds
    s_add_u32 m0, s30, 99328
    s_nop 0
    buffer_load_dwordx4 v189, s[4:7], s32 offen lds
    s_add_u32 m0, s31, 98304
    s_nop 0
    buffer_load_dwordx4 v190, s[8:11], s33 offen lds
    s_add_u32 m0, s31, 99328
    s_nop 0
    buffer_load_dwordx4 v191, s[8:11], s33 offen lds
    s_add_u32 s32, s32, 131072
    s_add_u32 s33, s33, 262144
    s_waitcnt vmcnt(12)
    s_barrier
    ds_read_b64_tr_b16 v[144:145], v180 offset:0
    ds_read_b64_tr_b16 v[146:147], v180 offset:2048
    ds_read_b64_tr_b16 v[148:149], v181 offset:0
    ds_read_b64_tr_b16 v[150:151], v181 offset:2048
    ds_read_b128 v[128:131], v176 offset:0
    ds_read_b128 v[132:135], v176 offset:1024
    ds_read_b128 v[136:139], v176 offset:2048
    ds_read_b128 v[140:143], v176 offset:3072
    s_mov_b32 s34, 0
G_loop_17:
    s_waitcnt lgkmcnt(0)
    v_mfma_f32_32x32x16_bf16 v[0:15], v[144:147], v[128:131], v[0:15]
    ds_read_b64_tr_b16 v[168:169], v180 offset:8192
    ds_read_b64_tr_b16 v[170:171], v180 offset:10240
    v_mfma_f32_32x32x16_bf16 v[16:31], v[148:151], v[128:131], v[16:31]
    ds_read_b64_tr_b16 v[172:173], v181 offset:8192
    ds_read_b64_tr_b16 v[174:175], v181 offset:10240
    v_mfma_f32_32x32x16_bf16 v[32:47], v[144:147], v[132:135], v[32:47]
    ds_read_b128 v[152:155], v176 offset:8192
    ds_read_b128 v[156:159], v176 offset:9216
    v_mfma_f32_32x32x16_bf16 v[48:63], v[148:151], v[132:135], v[48:63]
    ds_read_b128 v[160:163], v176 offset:10240
    ds_read_b128 v[164:167], v176 offset:11264
    v_mfma_f32_32x32x16_bf16 v[64:79], v[144:147], v[136:139], v[64:79]
    v_mfma_f32_32x32x16_bf16 v[80:95], v[148:151], v[136:139], v[80:95]
    v_mfma_f32_32x32x16_bf16 v[96:111], v[144:147], v[140:143], v[96:111]
    v_mfma_f32_32x32x16_bf16 v[112:127], v[148:151], v[140:143], v[112:127]
    s_add_u32 s35, s34, 4
    s_cmp_ge_u32 s35, 20
    s_cbranch_scc1 G_tail_19
    s_waitcnt vmcnt(8) lgkmcnt(0)
    s_barrier
    v_mfma_f32_32x32x16_bf16 v[0:15], v[168:171], v[152:155], v[0:15]
    ds_read_b64_tr_b16 v[144:145], v182 offset:0
    s_add_u32 m0, s30, 0
    s_nop 0
    buffer_load_dwordx4 v188, s[4:7], s32 offen lds
    ds_read_b64_tr_b16 v[146:147], v182 offset:2048
    v_mfma_f32_32x32x16_bf16 v[16:31], v[172:175], v[152:155], v[16:31]
    s_add_u32 m0, s30, 1024
    s_nop 0
    buffer_load_dwordx4 v189, s[4:7], s32 offen lds
    ds_read_b64_tr_b16 v[148:149], v183 offset:0
    s_add_u32 m0, s31, 0
    s_nop 0
    buffer_load_dwordx4 v190, s[8:11], s33 offen lds
    v_mfma_f32_32x32x16_bf16 v[32:47], v[168:171], v[156:159], v[32:47]
    ds_read_b64_tr_b16 v[150:151], v183 offset:2048
    s_add_u32 m0, s31, 1024
    s_nop 0
    buffer_load_dwordx4 v191, s[8:11], s33 offen lds
    s_add_u32 s32, s32, 131072
    s_add_u32 s33, s33, 262144
    ds_read_b128 v[128:131], v177 offset:0
    v_mfma_f32_32x32x16_bf16 v[48:63], v[172:175], v[156:159], v[48:63]
    ds_read_b128 v[132:135], v177 offset:1024
    ds_read_b128 v[136:139], v177 offset:2048
    ds_read_b128 v[140:143], v177 offset:3072
    v_mfma_f32_32x32x16_bf16 v[64:79], v[168:171], v[160:163], v[64:79]
    v_mfma_f32_32x32x16_bf16 v[80:95], v[172:175], v[160:163], v[80:95]
    v_mfma_f32_32x32x16_bf16 v[96:111], v[168:171], v[164:167], v[96:111]
    v_mfma_f32_32x32x16_bf16 v[112:127], v[172:175], v[164:167], v[112:127]
    s_branch G_cont_20
G_tail_19:
    s_waitcnt vmcnt(0) lgkmcnt(0)
    s_barrier
    v_mfma_f32_32x32x16_bf16 v[0:15], v[168:171], v[152:155], v[0:15]
    ds_read_b64_tr_b16 v[144:145], v182 offset:0
    ds_read_b64_tr_b16 v[146:147], v182 offset:2048
    v_mfma_f32_32x32x16_bf16 v[16:31], v[172:175], v[152:155], v[16:31]
    ds_read_b64_tr_b16 v[148:149], v183 offset:0
    ds_read_b64_tr_b16 v[150:151], v183 offset:2048
    v_mfma_f32_32x32x16_bf16 v[32:47], v[168:171], v[156:159], v[32:47]
    ds_read_b128 v[128:131], v177 offset:0
    ds_read_b128 v[132:135], v177 offset:1024
    v_mfma_f32_32x32x16_bf16 v[48:63], v[172:175], v[156:159], v[48:63]
    ds_read_b128 v[136:139], v177 offset:2048
    ds_read_b128 v[140:143], v177 offset:3072
    v_mfma_f32_32x32x16_bf16 v[64:79], v[168:171], v[160:163], v[64:79]
    v_mfma_f32_32x32x16_bf16 v[80:95], v[172:175], v[160:163], v[80:95]
    v_mfma_f32_32x32x16_bf16 v[96:111], v[168:171], v[164:167], v[96:111]
    v_mfma_f32_32x32x16_bf16 v[112:127], v[172:175], v[164:167], v[112:127]
G_cont_20:
    s_add_u32 s34, s34, 1
    s_cmp_ge_u32 s34, 20
    s_cbranch_scc1 G_end_18
    s_waitcnt lgkmcnt(0)
    v_mfma_f32_32x32x16_bf16 v[0:15], v[144:147], v[128:131], v[0:15]
    ds_read_b64_tr_b16 v[168:169], v182 offset:8192
    ds_read_b64_tr_b16 v[170:171], v182 offset:10240
    v_mfma_f32_32x32x16_bf16 v[16:31], v[148:151], v[128:131], v[16:31]
    ds_read_b64_tr_b16 v[172:173], v183 offset:8192
    ds_read_b64_tr_b16 v[174:175], v183 offset:10240
    v_mfma_f32_32x32x16_bf16 v[32:47], v[144:147], v[132:135], v[32:47]
    ds_read_b128 v[152:155], v177 offset:8192
    ds_read_b128 v[156:159], v177 offset:9216
    v_mfma_f32_32x32x16_bf16 v[48:63], v[148:151], v[132:135], v[48:63]
    ds_read_b128 v[160:163], v177 offset:10240
    ds_read_b128 v[164:167], v177 offset:11264
    v_mfma_f32_32x32x16_bf16 v[64:79], v[144:147], v[136:139], v[64:79]
    v_mfma_f32_32x32x16_bf16 v[80:95], v[148:151], v[136:139], v[80:95]
    v_mfma_f32_32x32x16_bf16 v[96:111], v[144:147], v[140:143], v[96:111]
    v_mfma_f32_32x32x16_bf16 v[112:127], v[148:151], v[140:143], v[112:127]
    s_add_u32 s35, s34, 4
    s_cmp_ge_u32 s35, 20
    s_cbranch_scc1 G_tail_21
    s_waitcnt vmcnt(8) lgkmcnt(0)
    s_barrier
    v_mfma_f32_32x32x16_bf16 v[0:15], v[168:171], v[152:155], v[0:15]
    ds_read_b64_tr_b16 v[144:145], v184 offset:0
    s_add_u32 m0, s30, 32768
    s_nop 0
    buffer_load_dwordx4 v188, s[4:7], s32 offen lds
    ds_read_b64_tr_b16 v[146:147], v184 offset:2048
    v_mfma_f32_32x32x16_bf16 v[16:31], v[172:175], v[152:155], v[16:31]
    s_add_u32 m0, s30, 33792
    s_nop 0
    buffer_load_dwordx4 v189, s[4:7], s32 offen lds
    ds_read_b64_tr_b16 v[148:149], v185 offset:0
    s_add_u32 m0, s31, 32768
    s_nop 0
    buffer_load_dwordx4 v190, s[8:11], s33 offen lds
    v_mfma_f32_32x32x16_bf16 v[32:47], v[168:171], v[156:159], v[32:47]
    ds_read_b64_tr_b16 v[150:151], v185 offset:2048
    s_add_u32 m0, s31, 33792
    s_nop 0
    buffer_load_dwordx4 v191, s[8:11], s33 offen lds
    s_add_u32 s32, s32, 131072
    s_add_u32 s33, s33, 262144
    ds_read_b128 v[128:131], v178 offset:0
    v_mfma_f32_32x32x16_bf16 v[48:63], v[172:175], v[156:159], v[48:63]
    ds_read_b128 v[132:135], v178 offset:1024
    ds_read_b128 v[136:139], v178 offset:2048
    ds_read_b128 v[140:143], v178 offset:3072
    v_mfma_f32_32x32x16_bf16 v[64:79], v[168:171], v[160:163], v[64:79]
    v_mfma_f32_32x32x16_bf16 v[80:95], v[172:175], v[160:163], v[80:95]
    v_mfma_f32_32x32x16_bf16 v[96:111], v[168:171], v[164:167], v[96:111]
    v_mfma_f32_32x32x16_bf16 v[112:127], v[172:175], v[164:167], v[112:127]
    s_branch G_cont_22
G_tail_21:
    s_waitcnt vmcnt(0) lgkmcnt(0)
    s_barrier
    v_mfma_f32_32x32x16_bf16 v[0:15], v[168:171], v[152:155], v[0:15]
    ds_read_b64_tr_b16 v[144:145], v184 offset:0
    ds_read_b64_tr_b16 v[146:147], v184 offset:2048
    v_mfma_f32_32x32x16_bf16 v[16:31], v[172:175], v[152:155], v[16:31]
    ds_read_b64_tr_b16 v[148:149], v185 offset:0
    ds_read_b64_tr_b16 v[150:151], v185 offset:2048
    v_mfma_f32_32x32x16_bf16 v[32:47], v[168:171], v[156:159], v[32:47]
    ds_read_b128 v[128:131], v178 offset:0
    ds_read_b128 v[132:135], v178 offset:1024
    v_mfma_f32_32x32x16_bf16 v[48:63], v[172:175], v[156:159], v[48:63]
    ds_read_b128 v[136:139], v178 offset:2048
    ds_read_b128 v[140:143], v178 offset:3072
    v_mfma_f32_32x32x16_bf16 v[64:79], v[168:171], v[160:163], v[64:79]
    v_mfma_f32_32x32x16_bf16 v[80:95], v[172:175], v[160:163], v[80:95]
    v_mfma_f32_32x32x16_bf16 v[96:111], v[168:171], v[164:167], v[96:111]
    v_mfma_f32_32x32x16_bf16 v[112:127], v[172:175], v[164:167], v[112:127]
G_cont_22:
    s_add_u32 s34, s34, 1
    s_cmp_ge_u32 s34, 20
    s_cbranch_scc1 G_end_18
    s_waitcnt lgkmcnt(0)
    v_mfma_f32_32x32x16_bf16 v[0:15], v[144:147], v[128:131], v[0:15]
    ds_read_b64_tr_b16 v[168:169], v184 offset:8192
    ds_read_b64_tr_b16 v[170:171], v184 offset:10240
    v_mfma_f32_32x32x16_bf16 v[16:31], v[148:151], v[128:131], v[16:31]
    ds_read_b64_tr_b16 v[172:173], v185 offset:8192
    ds_read_b64_tr_b16 v[174:175], v185 offset:10240
    v_mfma_f32_32x32x16_bf16 v[32:47], v[144:147], v[132:135], v[32:47]
    ds_read_b128 v[152:155], v178 offset:8192
    ds_read_b128 v[156:159], v178 offset:9216
    v_mfma_f32_32x32x16_bf16 v[48:63], v[148:151], v[132:135], v[48:63]
    ds_read_b128 v[160:163], v178 offset:10240
    ds_read_b128 v[164:167], v178 offset:11264
    v_mfma_f32_32x32x16_bf16 v[64:79], v[144:147], v[136:139], v[64:79]
    v_mfma_f32_32x32x16_bf16 v[80:95], v[148:151], v[136:139], v[80:95]
    v_mfma_f32_32x32x16_bf16 v[96:111], v[144:147], v[140:143], v[96:111]
    v_mfma_f32_32x32x16_bf16 v[112:127], v[148:151], v[140:143], v[112:127]
    s_add_u32 s35, s34, 4
    s_cmp_ge_u32 s35, 20
    s_cbranch_scc1 G_tail_23
    s_waitcnt vmcnt(8) lgkmcnt(0)
    s_barrier
    v_mfma_f32_32x32x16_bf16 v[0:15], v[168:171], v[152:155], v[0:15]
    ds_read_b64_tr_b16 v[144:145], v186 offset:0
    s_add_u32 m0, s30, 65536
    s_nop 0
    buffer_load_dwordx4 v188, s[4:7], s32 offen lds
    ds_read_b64_tr_b16 v[146:147], v186 offset:2048
    v_mfma_f32_32x32x16_bf16 v[16:31], v[172:175], v[152:155], v[16:31]
    s_add_u32 m0, s30, 66560
    s_nop 0
    buffer_load_dwordx4 v189, s[4:7], s32 offen lds
    ds_read_b64_tr_b16 v[148:149], v187 offset:0
    s_add_u32 m0, s31, 65536
    s_nop 0
    buffer_load_dwordx4 v190, s[8:11], s33 offen lds
    v_mfma_f32_32x32x16_bf16 v[32:47], v[168:171], v[156:159], v[32:47]
    ds_read_b64_tr_b16 v[150:151], v187 offset:2048
    s_add_u32 m0, s31, 66560
    s_nop 0
    buffer_load_dwordx4 v191, s[8:11], s33 offen lds
    s_add_u32 s32, s32, 131072
    s_add_u32 s33, s33, 262144
    ds_read_b128 v[128:131], v179 offset:0
    v_mfma_f32_32x32x16_bf16 v[48:63], v[172:175], v[156:159], v[48:63]
    ds_read_b128 v[132:135], v179 offset:1024
    ds_read_b128 v[136:139], v179 offset:2048
    ds_read_b128 v[140:143], v179 offset:3072
    v_mfma_f32_32x32x16_bf16 v[64:79], v[168:171], v[160:163], v[64:79]
    v_mfma_f32_32x32x16_bf16 v[80:95], v[172:175], v[160:163], v[80:95]
    v_mfma_f32_32x32x16_bf16 v[96:111], v[168:171], v[164:167], v[96:111]
    v_mfma_f32_32x32x16_bf16 v[112:127], v[172:175], v[164:167], v[112:127]
    s_branch G_cont_24
G_tail_23:
    s_waitcnt vmcnt(0) lgkmcnt(0)
    s_barrier
    v_mfma_f32_32x32x16_bf16 v[0:15], v[168:171], v[152:155], v[0:15]
    ds_read_b64_tr_b16 v[144:145], v186 offset:0
    ds_read_b64_tr_b16 v[146:147], v186 offset:2048
    v_mfma_f32_32x32x16_bf16 v[16:31], v[172:175], v[152:155], v[16:31]
    ds_read_b64_tr_b16 v[148:149], v187 offset:0
    ds_read_b64_tr_b16 v[150:151], v187 offset:2048
    v_mfma_f32_32x32x16_bf16 v[32:47], v[168:171], v[156:159], v[32:47]
    ds_read_b128 v[128:131], v179 offset:0
    ds_read_b128 v[132:135], v179 offset:1024
    v_mfma_f32_32x32x16_bf16 v[48:63], v[172:175], v[156:159], v[48:63]
    ds_read_b128 v[136:139], v179 offset:2048
    ds_read_b128 v[140:143], v179 offset:3072
    v_mfma_f32_32x32x16_bf16 v[64:79], v[168:171], v[160:163], v[64:79]
    v_mfma_f32_32x32x16_bf16 v[80:95], v[172:175], v[160:163], v[80:95]
    v_mfma_f32_32x32x16_bf16 v[96:111], v[168:171], v[164:167], v[96:111]
    v_mfma_f32_32x32x16_bf16 v[112:127], v[172:175], v[164:167], v[112:127]
G_cont_24:
    s_add_u32 s34, s34, 1
    s_cmp_ge_u32 s34, 20
    s_cbranch_scc1 G_end_18
    s_waitcnt lgkmcnt(0)
    v_mfma_f32_32x32x16_bf16 v[0:15], v[144:147], v[128:131], v[0:15]
    ds_read_b64_tr_b16 v[168:169], v186 offset:8192
    ds_read_b64_tr_b16 v[170:171], v186 offset:10240
    v_mfma_f32_32x32x16_bf16 v[16:31], v[148:151], v[128:131], v[16:31]
    ds_read_b64_tr_b16 v[172:173], v187 offset:8192
    ds_read_b64_tr_b16 v[174:175], v187 offset:10240
    v_mfma_f32_32x32x16_bf16 v[32:47], v[144:147], v[132:135], v[32:47]
    ds_read_b128 v[152:155], v179 offset:8192
    ds_read_b128 v[156:159], v179 offset:9216
    v_mfma_f32_32x32x16_bf16 v[48:63], v[148:151], v[132:135], v[48:63]
    ds_read_b128 v[160:163], v179 offset:10240
    ds_read_b128 v[164:167], v179 offset:11264
    v_mfma_f32_32x32x16_bf16 v[64:79], v[144:147], v[136:139], v[64:79]
    v_mfma_f32_32x32x16_bf16 v[80:95], v[148:151], v[136:139], v[80:95]
    v_mfma_f32_32x32x16_bf16 v[96:111], v[144:147], v[140:143], v[96:111]
    v_mfma_f32_32x32x16_bf16 v[112:127], v[148:151], v[140:143], v[112:127]
    s_add_u32 s35, s34, 4
    s_cmp_ge_u32 s35, 20
    s_cbranch_scc1 G_tail_25
    s_waitcnt vmcnt(8) lgkmcnt(0)
    s_barrier
    v_mfma_f32_32x32x16_bf16 v[0:15], v[168:171], v[152:155], v[0:15]
    ds_read_b64_tr_b16 v[144:145], v180 offset:0
    s_add_u32 m0, s30, 98304
    s_nop 0
    buffer_load_dwordx4 v188, s[4:7], s32 offen lds
    ds_read_b64_tr_b16 v[146:147], v180 offset:2048
    v_mfma_f32_32x32x16_bf16 v[16:31], v[172:175], v[152:155], v[16:31]
    s_add_u32 m0, s30, 99328
    s_nop 0
    buffer_load_dwordx4 v189, s[4:7], s32 offen lds
    ds_read_b64_tr_b16 v[148:149], v181 offset:0
    s_add_u32 m0, s31, 98304
    s_nop 0
    buffer_load_dwordx4 v190, s[8:11], s33 offen lds
    v_mfma_f32_32x32x16_bf16 v[32:47], v[168:171], v[156:159], v[32:47]
    ds_read_b64_tr_b16 v[150:151], v181 offset:2048
    s_add_u32 m0, s31, 99328
    s_nop 0
    buffer_load_dwordx4 v191, s[8:11], s33 offen lds
    s_add_u32 s32, s32, 131072
    s_add_u32 s33, s33, 262144
    ds_read_b128 v[128:131], v176 offset:0
    v_mfma_f32_32x32x16_bf16 v[48:63], v[172:175], v[156:159], v[48:63]
    ds_read_b128 v[132:135], v176 offset:1024
    ds_read_b128 v[136:139], v176 offset:2048
    ds_read_b128 v[140:143], v176 offset:3072
    v_mfma_f32_32x32x16_bf16 v[64:79], v[168:171], v[160:163], v[64:79]
    v_mfma_f32_32x32x16_bf16 v[80:95], v[172:175], v[160:163], v[80:95]
    v_mfma_f32_32x32x16_bf16 v[96:111], v[168:171], v[164:167], v[96:111]
    v_mfma_f32_32x32x16_bf16 v[112:127], v[172:175], v[164:167], v[112:127]
    s_branch G_cont_26
G_tail_25:
    s_waitcnt vmcnt(0) lgkmcnt(0)
    s_barrier
    v_mfma_f32_32x32x16_bf16 v[0:15], v[168:171], v[152:155], v[0:15]
    ds_read_b64_tr_b16 v[144:145], v180 offset:0
    ds_read_b64_tr_b16 v[146:147], v180 offset:2048
    v_mfma_f32_32x32x16_bf16 v[16:31], v[172:175], v[152:155], v[16:31]
    ds_read_b64_tr_b16 v[148:149], v181 offset:0
    ds_read_b64_tr_b16 v[150:151], v181 offset:2048
    v_mfma_f32_32x32x16_bf16 v[32:47], v[168:171], v[156:159], v[32:47]
    ds_read_b128 v[128:131], v176 offset:0
    ds_read_b128 v[132:135], v176 offset:1024
    v_mfma_f32_32x32x16_bf16 v[48:63], v[172:175], v[156:159], v[48:63]
    ds_read_b128 v[136:139], v176 offset:2048
    ds_read_b128 v[140:143], v176 offset:3072
    v_mfma_f32_32x32x16_bf16 v[64:79], v[168:171], v[160:163], v[64:79]
    v_mfma_f32_32x32x16_bf16 v[80:95], v[172:175], v[160:163], v[80:95]
    v_mfma_f32_32x32x16_bf16 v[96:111], v[168:171], v[164:167], v[96:111]
    v_mfma_f32_32x32x16_bf16 v[112:127], v[172:175], v[164:167], v[112:127]
G_cont_26:
    s_add_u32 s34, s34, 1
    s_cmp_ge_u32 s34, 20
    s_cbranch_scc1 G_end_18
    s_branch G_loop_17
G_end_18:
    s_waitcnt lgkmcnt(0)
    s_nop 15
    v_and_b32 v194, 31, v192
    s_mul_i32 s25, s27, 128
    s_add_u32 s25, s25, s22
    v_add_u32 v194, s25, v194
    v_lshlrev_b32 v194, 5, v194
    v_lshrrev_b32 v195, 5, v192
    v_bfe_u32 v200, v192, 3, 1
    v_xor_b32 v200, v195, v200
    v_lshl_add_u32 v194, v200, 4, v194
    s_mul_i32 s25, s28, 64
    s_add_u32 s25, s25, s23
    s_lshr_b32 s26, s25, 4
    s_mul_i32 s26, s26, 65536
    v_add_u32 v194, s26, v194
    v_cvt_pk_bf16_f32 v204, v0, v1
    v_cvt_pk_bf16_f32 v205, v2, v3
    v_cvt_pk_bf16_f32 v206, v4, v5
    v_cvt_pk_bf16_f32 v207, v6, v7
    s_mov_b32 s39, 0
    buffer_store_dwordx4 v[204:207], v194, s[12:15], s39 offen offset:0
    v_cvt_pk_bf16_f32 v208, v8, v9
    v_cvt_pk_bf16_f32 v209, v10, v11
    v_cvt_pk_bf16_f32 v210, v12, v13
    v_cvt_pk_bf16_f32 v211, v14, v15
    s_mov_b32 s39, 65536
    buffer_store_dwordx4 v[208:211], v194, s[12:15], s39 offen offset:0
    v_cvt_pk_bf16_f32 v212, v16, v17
    v_cvt_pk_bf16_f32 v213, v18, v19
    v_cvt_pk_bf16_f32 v214, v20, v21
    v_cvt_pk_bf16_f32 v215, v22, v23
    s_mov_b32 s39, 131072
    buffer_store_dwordx4 v[212:215], v194, s[12:15], s39 offen offset:0
    v_cvt_pk_bf16_f32 v216, v24, v25
    v_cvt_pk_bf16_f32 v217, v26, v27
    v_cvt_pk_bf16_f32 v218, v28, v29
    v_cvt_pk_bf16_f32 v219, v30, v31
    s_mov_b32 s39, 196608
    buffer_store_dwordx4 v[216:219], v194, s[12:15], s39 offen offset:0
    v_cvt_pk_bf16_f32 v204, v32, v33
    v_cvt_pk_bf16_f32 v205, v34, v35
    v_cvt_pk_bf16_f32 v206, v36, v37
    v_cvt_pk_bf16_f32 v207, v38, v39
    s_mov_b32 s39, 0
    buffer_store_dwordx4 v[204:207], v194, s[12:15], s39 offen offset:1024
    v_cvt_pk_bf16_f32 v208, v40, v41
    v_cvt_pk_bf16_f32 v209, v42, v43
    v_cvt_pk_bf16_f32 v210, v44, v45
    v_cvt_pk_bf16_f32 v211, v46, v47
    s_mov_b32 s39, 65536
    buffer_store_dwordx4 v[208:211], v194, s[12:15], s39 offen offset:1024
    v_cvt_pk_bf16_f32 v212, v48, v49
    v_cvt_pk_bf16_f32 v213, v50, v51
    v_cvt_pk_bf16_f32 v214, v52, v53
    v_cvt_pk_bf16_f32 v215, v54, v55
    s_mov_b32 s39, 131072
    buffer_store_dwordx4 v[212:215], v194, s[12:15], s39 offen offset:1024
    v_cvt_pk_bf16_f32 v216, v56, v57
    v_cvt_pk_bf16_f32 v217, v58, v59
    v_cvt_pk_bf16_f32 v218, v60, v61
    v_cvt_pk_bf16_f32 v219, v62, v63
    s_mov_b32 s39, 196608
    buffer_store_dwordx4 v[216:219], v194, s[12:15], s39 offen offset:1024
    v_cvt_pk_bf16_f32 v204, v64, v65
    v_cvt_pk_bf16_f32 v205, v66, v67
    v_cvt_pk_bf16_f32 v206, v68, v69
    v_cvt_pk_bf16_f32 v207, v70, v71
    s_mov_b32 s39, 0
    buffer_store_dwordx4 v[204:207], v194, s[12:15], s39 offen offset:2048
    v_cvt_pk_bf16_f32 v208, v72, v73
    v_cvt_pk_bf16_f32 v209, v74, v75
    v_cvt_pk_bf16_f32 v210, v76, v77
    v_cvt_pk_bf16_f32 v211, v78, v79
    s_mov_b32 s39, 65536
    buffer_store_dwordx4 v[208:211], v194, s[12:15], s39 offen offset:2048
    v_cvt_pk_bf16_f32 v212, v80, v81
    v_cvt_pk_bf16_f32 v213, v82, v83
    v_cvt_pk_bf16_f32 v214, v84, v85
    v_cvt_pk_bf16_f32 v215, v86, v87
    s_mov_b32 s39, 131072
    buffer_store_dwordx4 v[212:215], v194, s[12:15], s39 offen offset:2048
    v_cvt_pk_bf16_f32 v216, v88, v89
    v_cvt_pk_bf16_f32 v217, v90, v91
    v_cvt_pk_bf16_f32 v218, v92, v93
    v_cvt_pk_bf16_f32 v219, v94, v95
    s_mov_b32 s39, 196608
    buffer_store_dwordx4 v[216:219], v194, s[12:15], s39 offen offset:2048
    v_cvt_pk_bf16_f32 v204, v96, v97
    v_cvt_pk_bf16_f32 v205, v98, v99
    v_cvt_pk_bf16_f32 v206, v100, v101
    v_cvt_pk_bf16_f32 v207, v102, v103
    s_mov_b32 s39, 0
    buffer_store_dwordx4 v[204:207], v194, s[12:15], s39 offen offset:3072
    v_cvt_pk_bf16_f32 v208, v104, v105
    v_cvt_pk_bf16_f32 v209, v106, v107
    v_cvt_pk_bf16_f32 v210, v108, v109
    v_cvt_pk_bf16_f32 v211, v110, v111
    s_mov_b32 s39, 65536
    buffer_store_dwordx4 v[208:211], v194, s[12:15], s39 offen offset:3072
    v_cvt_pk_bf16_f32 v212, v112, v113
    v_cvt_pk_bf16_f32 v213, v114, v115
    v_cvt_pk_bf16_f32 v214, v116, v117
    v_cvt_pk_bf16_f32 v215, v118, v119
    s_mov_b32 s39, 131072
    buffer_store_dwordx4 v[212:215], v194, s[12:15], s39 offen offset:3072
    v_cvt_pk_bf16_f32 v216, v120, v121
    v_cvt_pk_bf16_f32 v217, v122, v123
    v_cvt_pk_bf16_f32 v218, v124, v125
    v_cvt_pk_bf16_f32 v219, v126, v127
    s_mov_b32 s39, 196608
    buffer_store_dwordx4 v[216:219], v194, s[12:15], s39 offen offset:3072
    s_endpgm
G1_K_5:
    s_cmp_ge_u32 s2, 296
    s_cbranch_scc1 G1_V_6
    s_sub_u32 s20, s2, 168
    s_and_b32 s21, s20, 7
    s_lshr_b32 s20, s20, 3
    s_and_b32 s22, s21, 3
    s_lshl_b32 s22, s22, 1
    s_and_b32 s25, s20, 1
    s_add_u32 s22, s22, s25
    s_lshl_b32 s22, s22, 8
    s_lshr_b32 s23, s21, 2
    s_lshl_b32 s23, s23, 3
    s_lshr_b32 s25, s20, 1
    s_add_u32 s23, s23, s25
    s_lshl_b32 s23, s23, 8
    s_add_u32 s4, s52, 0x600000
    s_addc_u32 s5, s53, 0
    s_and_b32 s5, s5, 0xffff
    s_mov_b32 s6, 0x200000
    s_mov_b32 s7, 0x00020000
    s_mov_b32 s8, s44
    s_and_b32 s9, s45, 0xffff
    s_mov_b32 s10, 0x400000
    s_mov_b32 s11, 0x00020000
    s_add_u32 s12, s52, 0x2000000
    s_addc_u32 s13, s53, 0
    s_and_b32 s13, s13, 0xffff
    s_mov_b32 s14, 0x1000000
    s_mov_b32 s15, 0x00020000
    v_mov_b32 v220, v0
    v_and_b32 v192, 63, v220
    v_lshrrev_b32 v193, 6, v220
    s_nop 0
    v_readfirstlane_b32 s24, v193
    s_lshr_b32 s27, s24, 2
    s_and_b32 s28, s24, 3
    v_and_b32 v194, 31, v192
    s_mul_i32 s25, s27, 128
    v_add_u32 v194, s25, v194
    v_lshlrev_b32 v194, 5, v194
    v_lshrrev_b32 v195, 5, v192
    v_bfe_u32 v196, v192, 3, 1
    v_xor_b32 v196, v195, v196
    v_lshl_add_u32 v176, v196, 4, v194
    v_add_u32 v177, 32768, v176
    v_add_u32 v178, 65536, v176
    v_add_u32 v179, 98304, v176
    v_bfe_u32 v197, v192, 2, 2
    v_lshl_add_u32 v198, v195, 3, v197
    v_mul_u32_u24 v198, 512, v198
    v_bfe_u32 v199, v192, 4, 1
    v_lshlrev_b32 v199, 1, v199
    v_bfe_u32 v200, v192, 1, 1
    v_add_u32 v199, v199, v200
    s_mul_i32 s25, s28, 8
    v_add_u32 v199, s25, v199
    v_lshlrev_b32 v200, 2, v197
    v_and_b32 v201, 1, v192
    v_lshlrev_b32 v201, 3, v201
    v_add_u32 v198, v198, v201
    v_add_u32 v198, 16384, v198
    v_add_u32 v201, 0, v199
    v_xor_b32 v201, v201, v200
    v_lshl_add_u32 v180, v201, 4, v198
    v_add_u32 v182, 32768, v180
    v_add_u32 v184, 65536, v180
    v_add_u32 v186, 98304, v180
    v_add_u32 v201, 4, v199
    v_xor_b32 v201, v201, v200
    v_lshl_add_u32 v181, v201, 4, v198
    v_add_u32 v183, 32768, v181
    v_add_u32 v185, 65536, v181
    v_add_u32 v187, 98304, v181
    s_mul_i32 s30, s24, 2048
    s_mul_i32 s31, s24, 2048
    s_add_u32 s31, s31, 16384
    v_lshlrev_b32 v196, 4, v192
    s_mul_i32 s25, s24, 2
    s_add_u32 s25, s25, 0
    s_lshr_b32 s26, s25, 3
    s_and_b32 s25, s25, 7
    s_mul_i32 s26, s26, 2048
    s_lshl_b32 s25, s25, 5
    s_add_u32 s25, s25, s26
    s_add_u32 s25, s25, s22
    s_lshl_b32 s25, s25, 5
    v_add_u32 v188, s25, v196
    s_mul_i32 s25, s24, 2
    s_add_u32 s25, s25, 1
    s_lshr_b32 s26, s25, 3
    s_and_b32 s25, s25, 7
    s_mul_i32 s26, s26, 2048
    s_lshl_b32 s25, s25, 5
    s_add_u32 s25, s25, s26
    s_add_u32 s25, s25, s22
    s_lshl_b32 s25, s25, 5
    v_add_u32 v189, s25, v196
    s_mov_b32 s26, 8192
    s_lshl_b32 s29, s23, 1
    s_mul_i32 s25, s24, 4
    s_add_u32 s25, s25, 0
    v_lshrrev_b32 v196, 5, v192
    v_add_u32 v196, s25, v196
    v_and_b32 v197, 3, v196
    v_lshlrev_b32 v197, 2, v197
    v_and_b32 v198, 31, v192
    v_xor_b32 v197, v197, v198
    v_mul_lo_u32 v196, v196, s26
    v_lshl_add_u32 v196, v197, 4, v196
    v_add_u32 v190, s29, v196
    s_mul_i32 s25, s24, 4
    s_add_u32 s25, s25, 2
    v_lshrrev_b32 v196, 5, v192
    v_add_u32 v196, s25, v196
    v_and_b32 v197, 3, v196
    v_lshlrev_b32 v197, 2, v197
    v_and_b32 v198, 31, v192
    v_xor_b32 v197, v197, v198
    v_mul_lo_u32 v196, v196, s26
    v_lshl_add_u32 v196, v197, 4, v196
    v_add_u32 v191, s29, v196
    v_mov_b32 v0, 0
    v_mov_b32 v1, 0
    v_mov_b32 v2, 0
    v_mov_b32 v3, 0
    v_mov_b32 v4, 0
    v_mov_b32 v5, 0
    v_mov_b32 v6, 0
    v_mov_b32 v7, 0
    v_mov_b32 v8, 0
    v_mov_b32 v9, 0
    v_mov_b32 v10, 0
    v_mov_b32 v11, 0
    v_mov_b32 v12, 0
    v_mov_b32 v13, 0
    v_mov_b32 v14, 0
    v_mov_b32 v15, 0
    v_mov_b32 v16, 0
    v_mov_b32 v17, 0
    v_mov_b32 v18, 0
    v_mov_b32 v19, 0
    v_mov_b32 v20, 0
    v_mov_b32 v21, 0
    v_mov_b32 v22, 0
    v_mov_b32 v23, 0
    v_mov_b32 v24, 0
    v_mov_b32 v25, 0
    v_mov_b32 v26, 0
    v_mov_b32 v27, 0
    v_mov_b32 v28, 0
    v_mov_b32 v29, 0
    v_mov_b32 v30, 0
    v_mov_b32 v31, 0
    v_mov_b32 v32, 0
    v_mov_b32 v33, 0
    v_mov_b32 v34, 0
    v_mov_b32 v35, 0
    v_mov_b32 v36, 0
    v_mov_b32 v37, 0
    v_mov_b32 v38, 0
    v_mov_b32 v39, 0
    v_mov_b32 v40, 0
    v_mov_b32 v41, 0
    v_mov_b32 v42, 0
    v_mov_b32 v43, 0
    v_mov_b32 v44, 0
    v_mov_b32 v45, 0
    v_mov_b32 v46, 0
    v_mov_b32 v47, 0
    v_mov_b32 v48, 0
    v_mov_b32 v49, 0
    v_mov_b32 v50, 0
    v_mov_b32 v51, 0
    v_mov_b32 v52, 0
    v_mov_b32 v53, 0
    v_mov_b32 v54, 0
    v_mov_b32 v55, 0
    v_mov_b32 v56, 0
    v_mov_b32 v57, 0
    v_mov_b32 v58, 0
    v_mov_b32 v59, 0
    v_mov_b32 v60, 0
    v_mov_b32 v61, 0
    v_mov_b32 v62, 0
    v_mov_b32 v63, 0
    v_mov_b32 v64, 0
    v_mov_b32 v65, 0
    v_mov_b32 v66, 0
    v_mov_b32 v67, 0
    v_mov_b32 v68, 0
    v_mov_b32 v69, 0
    v_mov_b32 v70, 0
    v_mov_b32 v71, 0
    v_mov_b32 v72, 0
    v_mov_b32 v73, 0
    v_mov_b32 v74, 0
    v_mov_b32 v75, 0
    v_mov_b32 v76, 0
    v_mov_b32 v77, 0
    v_mov_b32 v78, 0
    v_mov_b32 v79, 0
    v_mov_b32 v80, 0
    v_mov_b32 v81, 0
    v_mov_b32 v82, 0
    v_mov_b32 v83, 0
    v_mov_b32 v84, 0
    v_mov_b32 v85, 0
    v_mov_b32 v86, 0
    v_mov_b32 v87, 0
    v_mov_b32 v88, 0
    v_mov_b32 v89, 0
    v_mov_b32 v90, 0
    v_mov_b32 v91, 0
    v_mov_b32 v92, 0
    v_mov_b32 v93, 0
    v_mov_b32 v94, 0
    v_mov_b32 v95, 0
    v_mov_b32 v96, 0
    v_mov_b32 v97, 0
    v_mov_b32 v98, 0
    v_mov_b32 v99, 0
    v_mov_b32 v100, 0
    v_mov_b32 v101, 0
    v_mov_b32 v102, 0
    v_mov_b32 v103, 0
    v_mov_b32 v104, 0
    v_mov_b32 v105, 0
    v_mov_b32 v106, 0
    v_mov_b32 v107, 0
    v_mov_b32 v108, 0
    v_mov_b32 v109, 0
    v_mov_b32 v110, 0
    v_mov_b32 v111, 0
    v_mov_b32 v112, 0
    v_mov_b32 v113, 0
    v_mov_b32 v114, 0
    v_mov_b32 v115, 0
    v_mov_b32 v116, 0
    v_mov_b32 v117, 0
    v_mov_b32 v118, 0
    v_mov_b32 v119, 0
    v_mov_b32 v120, 0
    v_mov_b32 v121, 0
    v_mov_b32 v122, 0
    v_mov_b32 v123, 0
    v_mov_b32 v124, 0
    v_mov_b32 v125, 0
    v_mov_b32 v126, 0
    v_mov_b32 v127, 0
    s_mov_b32 s32, 0
    s_mov_b32 s33, 0
    s_add_u32 m0, s30, 0
    s_nop 0
    buffer_load_dwordx4 v188, s[4:7], s32 offen lds
    s_add_u32 m0, s30, 1024
    s_nop 0
    buffer_load_dwordx4 v189, s[4:7], s32 offen lds
    s_add_u32 m0, s31, 0
    s_nop 0
    buffer_load_dwordx4 v190, s[8:11], s33 offen lds
    s_add_u32 m0, s31, 1024
    s_nop 0
    buffer_load_dwordx4 v191, s[8:11], s33 offen lds
    s_add_u32 s32, s32, 131072
    s_add_u32 s33, s33, 262144
    s_add_u32 m0, s30, 32768
    s_nop 0
    buffer_load_dwordx4 v188, s[4:7], s32 offen lds
    s_add_u32 m0, s30, 33792
    s_nop 0
    buffer_load_dwordx4 v189, s[4:7], s32 offen lds
    s_add_u32 m0, s31, 32768
    s_nop 0
    buffer_load_dwordx4 v190, s[8:11], s33 offen lds
    s_add_u32 m0, s31, 33792
    s_nop 0
    buffer_load_dwordx4 v191, s[8:11], s33 offen lds
    s_add_u32 s32, s32, 131072
    s_add_u32 s33, s33, 262144
    s_add_u32 m0, s30, 65536
    s_nop 0
    buffer_load_dwordx4 v188, s[4:7], s32 offen lds
    s_add_u32 m0, s30, 66560
    s_nop 0
    buffer_load_dwordx4 v189, s[4:7], s32 offen lds
    s_add_u32 m0, s31, 65536
    s_nop 0
    buffer_load_dwordx4 v190, s[8:11], s33 offen lds
    s_add_u32 m0, s31, 66560
    s_nop 0
    buffer_load_dwordx4 v191, s[8:11], s33 offen lds
    s_add_u32 s32, s32, 131072
    s_add_u32 s33, s33, 262144
    s_add_u32 m0, s30, 98304
    s_nop 0
    buffer_load_dwordx4 v188, s[4:7], s32 offen lds
    s_add_u32 m0, s30, 99328
    s_nop 0
    buffer_load_dwordx4 v189, s[4:7], s32 offen lds
    s_add_u32 m0, s31, 98304
    s_nop 0
    buffer_load_dwordx4 v190, s[8:11], s33 offen lds
    s_add_u32 m0, s31, 99328
    s_nop 0
    buffer_load_dwordx4 v191, s[8:11], s33 offen lds
    s_add_u32 s32, s32, 131072
    s_add_u32 s33, s33, 262144
    s_waitcnt vmcnt(12)
    s_barrier
    ds_read_b64_tr_b16 v[144:145], v180 offset:0
    ds_read_b64_tr_b16 v[146:147], v180 offset:2048
    ds_read_b64_tr_b16 v[148:149], v181 offset:0
    ds_read_b64_tr_b16 v[150:151], v181 offset:2048
    ds_read_b128 v[128:131], v176 offset:0
    ds_read_b128 v[132:135], v176 offset:1024
    ds_read_b128 v[136:139], v176 offset:2048
    ds_read_b128 v[140:143], v176 offset:3072
    s_mov_b32 s34, 0
G_loop_27:
    s_waitcnt lgkmcnt(0)
    v_mfma_f32_32x32x16_bf16 v[0:15], v[144:147], v[128:131], v[0:15]
    ds_read_b64_tr_b16 v[168:169], v180 offset:8192
    ds_read_b64_tr_b16 v[170:171], v180 offset:10240
    v_mfma_f32_32x32x16_bf16 v[16:31], v[148:151], v[128:131], v[16:31]
    ds_read_b64_tr_b16 v[172:173], v181 offset:8192
    ds_read_b64_tr_b16 v[174:175], v181 offset:10240
    v_mfma_f32_32x32x16_bf16 v[32:47], v[144:147], v[132:135], v[32:47]
    ds_read_b128 v[152:155], v176 offset:8192
    ds_read_b128 v[156:159], v176 offset:9216
    v_mfma_f32_32x32x16_bf16 v[48:63], v[148:151], v[132:135], v[48:63]
    ds_read_b128 v[160:163], v176 offset:10240
    ds_read_b128 v[164:167], v176 offset:11264
    v_mfma_f32_32x32x16_bf16 v[64:79], v[144:147], v[136:139], v[64:79]
    v_mfma_f32_32x32x16_bf16 v[80:95], v[148:151], v[136:139], v[80:95]
    v_mfma_f32_32x32x16_bf16 v[96:111], v[144:147], v[140:143], v[96:111]
    v_mfma_f32_32x32x16_bf16 v[112:127], v[148:151], v[140:143], v[112:127]
    s_add_u32 s35, s34, 4
    s_cmp_ge_u32 s35, 16
    s_cbranch_scc1 G_tail_29
    s_waitcnt vmcnt(8) lgkmcnt(0)
    s_barrier
    v_mfma_f32_32x32x16_bf16 v[0:15], v[168:171], v[152:155], v[0:15]
    ds_read_b64_tr_b16 v[144:145], v182 offset:0
    s_add_u32 m0, s30, 0
    s_nop 0
    buffer_load_dwordx4 v188, s[4:7], s32 offen lds
    ds_read_b64_tr_b16 v[146:147], v182 offset:2048
    v_mfma_f32_32x32x16_bf16 v[16:31], v[172:175], v[152:155], v[16:31]
    s_add_u32 m0, s30, 1024
    s_nop 0
    buffer_load_dwordx4 v189, s[4:7], s32 offen lds
    ds_read_b64_tr_b16 v[148:149], v183 offset:0
    s_add_u32 m0, s31, 0
    s_nop 0
    buffer_load_dwordx4 v190, s[8:11], s33 offen lds
    v_mfma_f32_32x32x16_bf16 v[32:47], v[168:171], v[156:159], v[32:47]
    ds_read_b64_tr_b16 v[150:151], v183 offset:2048
    s_add_u32 m0, s31, 1024
    s_nop 0
    buffer_load_dwordx4 v191, s[8:11], s33 offen lds
    s_add_u32 s32, s32, 131072
    s_add_u32 s33, s33, 262144
    ds_read_b128 v[128:131], v177 offset:0
    v_mfma_f32_32x32x16_bf16 v[48:63], v[172:175], v[156:159], v[48:63]
    ds_read_b128 v[132:135], v177 offset:1024
    ds_read_b128 v[136:139], v177 offset:2048
    ds_read_b128 v[140:143], v177 offset:3072
    v_mfma_f32_32x32x16_bf16 v[64:79], v[168:171], v[160:163], v[64:79]
    v_mfma_f32_32x32x16_bf16 v[80:95], v[172:175], v[160:163], v[80:95]
    v_mfma_f32_32x32x16_bf16 v[96:111], v[168:171], v[164:167], v[96:111]
    v_mfma_f32_32x32x16_bf16 v[112:127], v[172:175], v[164:167], v[112:127]
    s_branch G_cont_30
G_tail_29:
    s_waitcnt vmcnt(0) lgkmcnt(0)
    s_barrier
    v_mfma_f32_32x32x16_bf16 v[0:15], v[168:171], v[152:155], v[0:15]
    ds_read_b64_tr_b16 v[144:145], v182 offset:0
    ds_read_b64_tr_b16 v[146:147], v182 offset:2048
    v_mfma_f32_32x32x16_bf16 v[16:31], v[172:175], v[152:155], v[16:31]
    ds_read_b64_tr_b16 v[148:149], v183 offset:0
    ds_read_b64_tr_b16 v[150:151], v183 offset:2048
    v_mfma_f32_32x32x16_bf16 v[32:47], v[168:171], v[156:159], v[32:47]
    ds_read_b128 v[128:131], v177 offset:0
    ds_read_b128 v[132:135], v177 offset:1024
    v_mfma_f32_32x32x16_bf16 v[48:63], v[172:175], v[156:159], v[48:63]
    ds_read_b128 v[136:139], v177 offset:2048
    ds_read_b128 v[140:143], v177 offset:3072
    v_mfma_f32_32x32x16_bf16 v[64:79], v[168:171], v[160:163], v[64:79]
    v_mfma_f32_32x32x16_bf16 v[80:95], v[172:175], v[160:163], v[80:95]
    v_mfma_f32_32x32x16_bf16 v[96:111], v[168:171], v[164:167], v[96:111]
    v_mfma_f32_32x32x16_bf16 v[112:127], v[172:175], v[164:167], v[112:127]
G_cont_30:
    s_add_u32 s34, s34, 1
    s_cmp_ge_u32 s34, 16
    s_cbranch_scc1 G_end_28
    s_waitcnt lgkmcnt(0)
    v_mfma_f32_32x32x16_bf16 v[0:15], v[144:147], v[128:131], v[0:15]
    ds_read_b64_tr_b16 v[168:169], v182 offset:8192
    ds_read_b64_tr_b16 v[170:171], v182 offset:10240
    v_mfma_f32_32x32x16_bf16 v[16:31], v[148:151], v[128:131], v[16:31]
    ds_read_b64_tr_b16 v[172:173], v183 offset:8192
    ds_read_b64_tr_b16 v[174:175], v183 offset:10240
    v_mfma_f32_32x32x16_bf16 v[32:47], v[144:147], v[132:135], v[32:47]
    ds_read_b128 v[152:155], v177 offset:8192
    ds_read_b128 v[156:159], v177 offset:9216
    v_mfma_f32_32x32x16_bf16 v[48:63], v[148:151], v[132:135], v[48:63]
    ds_read_b128 v[160:163], v177 offset:10240
    ds_read_b128 v[164:167], v177 offset:11264
    v_mfma_f32_32x32x16_bf16 v[64:79], v[144:147], v[136:139], v[64:79]
    v_mfma_f32_32x32x16_bf16 v[80:95], v[148:151], v[136:139], v[80:95]
    v_mfma_f32_32x32x16_bf16 v[96:111], v[144:147], v[140:143], v[96:111]
    v_mfma_f32_32x32x16_bf16 v[112:127], v[148:151], v[140:143], v[112:127]
    s_add_u32 s35, s34, 4
    s_cmp_ge_u32 s35, 16
    s_cbranch_scc1 G_tail_31
    s_waitcnt vmcnt(8) lgkmcnt(0)
    s_barrier
    v_mfma_f32_32x32x16_bf16 v[0:15], v[168:171], v[152:155], v[0:15]
    ds_read_b64_tr_b16 v[144:145], v184 offset:0
    s_add_u32 m0, s30, 32768
    s_nop 0
    buffer_load_dwordx4 v188, s[4:7], s32 offen lds
    ds_read_b64_tr_b16 v[146:147], v184 offset:2048
    v_mfma_f32_32x32x16_bf16 v[16:31], v[172:175], v[152:155], v[16:31]
    s_add_u32 m0, s30, 33792
    s_nop 0
    buffer_load_dwordx4 v189, s[4:7], s32 offen lds
    ds_read_b64_tr_b16 v[148:149], v185 offset:0
    s_add_u32 m0, s31, 32768
    s_nop 0
    buffer_load_dwordx4 v190, s[8:11], s33 offen lds
    v_mfma_f32_32x32x16_bf16 v[32:47], v[168:171], v[156:159], v[32:47]
    ds_read_b64_tr_b16 v[150:151], v185 offset:2048
    s_add_u32 m0, s31, 33792
    s_nop 0
    buffer_load_dwordx4 v191, s[8:11], s33 offen lds
    s_add_u32 s32, s32, 131072
    s_add_u32 s33, s33, 262144
    ds_read_b128 v[128:131], v178 offset:0
    v_mfma_f32_32x32x16_bf16 v[48:63], v[172:175], v[156:159], v[48:63]
    ds_read_b128 v[132:135], v178 offset:1024
    ds_read_b128 v[136:139], v178 offset:2048
    ds_read_b128 v[140:143], v178 offset:3072
    v_mfma_f32_32x32x16_bf16 v[64:79], v[168:171], v[160:163], v[64:79]
    v_mfma_f32_32x32x16_bf16 v[80:95], v[172:175], v[160:163], v[80:95]
    v_mfma_f32_32x32x16_bf16 v[96:111], v[168:171], v[164:167], v[96:111]
    v_mfma_f32_32x32x16_bf16 v[112:127], v[172:175], v[164:167], v[112:127]
    s_branch G_cont_32
G_tail_31:
    s_waitcnt vmcnt(0) lgkmcnt(0)
    s_barrier
    v_mfma_f32_32x32x16_bf16 v[0:15], v[168:171], v[152:155], v[0:15]
    ds_read_b64_tr_b16 v[144:145], v184 offset:0
    ds_read_b64_tr_b16 v[146:147], v184 offset:2048
    v_mfma_f32_32x32x16_bf16 v[16:31], v[172:175], v[152:155], v[16:31]
    ds_read_b64_tr_b16 v[148:149], v185 offset:0
    ds_read_b64_tr_b16 v[150:151], v185 offset:2048
    v_mfma_f32_32x32x16_bf16 v[32:47], v[168:171], v[156:159], v[32:47]
    ds_read_b128 v[128:131], v178 offset:0
    ds_read_b128 v[132:135], v178 offset:1024
    v_mfma_f32_32x32x16_bf16 v[48:63], v[172:175], v[156:159], v[48:63]
    ds_read_b128 v[136:139], v178 offset:2048
    ds_read_b128 v[140:143], v178 offset:3072
    v_mfma_f32_32x32x16_bf16 v[64:79], v[168:171], v[160:163], v[64:79]
    v_mfma_f32_32x32x16_bf16 v[80:95], v[172:175], v[160:163], v[80:95]
    v_mfma_f32_32x32x16_bf16 v[96:111], v[168:171], v[164:167], v[96:111]
    v_mfma_f32_32x32x16_bf16 v[112:127], v[172:175], v[164:167], v[112:127]
G_cont_32:
    s_add_u32 s34, s34, 1
    s_cmp_ge_u32 s34, 16
    s_cbranch_scc1 G_end_28
    s_waitcnt lgkmcnt(0)
    v_mfma_f32_32x32x16_bf16 v[0:15], v[144:147], v[128:131], v[0:15]
    ds_read_b64_tr_b16 v[168:169], v184 offset:8192
    ds_read_b64_tr_b16 v[170:171], v184 offset:10240
    v_mfma_f32_32x32x16_bf16 v[16:31], v[148:151], v[128:131], v[16:31]
    ds_read_b64_tr_b16 v[172:173], v185 offset:8192
    ds_read_b64_tr_b16 v[174:175], v185 offset:10240
    v_mfma_f32_32x32x16_bf16 v[32:47], v[144:147], v[132:135], v[32:47]
    ds_read_b128 v[152:155], v178 offset:8192
    ds_read_b128 v[156:159], v178 offset:9216
    v_mfma_f32_32x32x16_bf16 v[48:63], v[148:151], v[132:135], v[48:63]
    ds_read_b128 v[160:163], v178 offset:10240
    ds_read_b128 v[164:167], v178 offset:11264
    v_mfma_f32_32x32x16_bf16 v[64:79], v[144:147], v[136:139], v[64:79]
    v_mfma_f32_32x32x16_bf16 v[80:95], v[148:151], v[136:139], v[80:95]
    v_mfma_f32_32x32x16_bf16 v[96:111], v[144:147], v[140:143], v[96:111]
    v_mfma_f32_32x32x16_bf16 v[112:127], v[148:151], v[140:143], v[112:127]
    s_add_u32 s35, s34, 4
    s_cmp_ge_u32 s35, 16
    s_cbranch_scc1 G_tail_33
    s_waitcnt vmcnt(8) lgkmcnt(0)
    s_barrier
    v_mfma_f32_32x32x16_bf16 v[0:15], v[168:171], v[152:155], v[0:15]
    ds_read_b64_tr_b16 v[144:145], v186 offset:0
    s_add_u32 m0, s30, 65536
    s_nop 0
    buffer_load_dwordx4 v188, s[4:7], s32 offen lds
    ds_read_b64_tr_b16 v[146:147], v186 offset:2048
    v_mfma_f32_32x32x16_bf16 v[16:31], v[172:175], v[152:155], v[16:31]
    s_add_u32 m0, s30, 66560
    s_nop 0
    buffer_load_dwordx4 v189, s[4:7], s32 offen lds
    ds_read_b64_tr_b16 v[148:149], v187 offset:0
    s_add_u32 m0, s31, 65536
    s_nop 0
    buffer_load_dwordx4 v190, s[8:11], s33 offen lds
    v_mfma_f32_32x32x16_bf16 v[32:47], v[168:171], v[156:159], v[32:47]
    ds_read_b64_tr_b16 v[150:151], v187 offset:2048
    s_add_u32 m0, s31, 66560
    s_nop 0
    buffer_load_dwordx4 v191, s[8:11], s33 offen lds
    s_add_u32 s32, s32, 131072
    s_add_u32 s33, s33, 262144
    ds_read_b128 v[128:131], v179 offset:0
    v_mfma_f32_32x32x16_bf16 v[48:63], v[172:175], v[156:159], v[48:63]
    ds_read_b128 v[132:135], v179 offset:1024
    ds_read_b128 v[136:139], v179 offset:2048
    ds_read_b128 v[140:143], v179 offset:3072
    v_mfma_f32_32x32x16_bf16 v[64:79], v[168:171], v[160:163], v[64:79]
    v_mfma_f32_32x32x16_bf16 v[80:95], v[172:175], v[160:163], v[80:95]
    v_mfma_f32_32x32x16_bf16 v[96:111], v[168:171], v[164:167], v[96:111]
    v_mfma_f32_32x32x16_bf16 v[112:127], v[172:175], v[164:167], v[112:127]
    s_branch G_cont_34
G_tail_33:
    s_waitcnt vmcnt(0) lgkmcnt(0)
    s_barrier
    v_mfma_f32_32x32x16_bf16 v[0:15], v[168:171], v[152:155], v[0:15]
    ds_read_b64_tr_b16 v[144:145], v186 offset:0
    ds_read_b64_tr_b16 v[146:147], v186 offset:2048
    v_mfma_f32_32x32x16_bf16 v[16:31], v[172:175], v[152:155], v[16:31]
    ds_read_b64_tr_b16 v[148:149], v187 offset:0
    ds_read_b64_tr_b16 v[150:151], v187 offset:2048
    v_mfma_f32_32x32x16_bf16 v[32:47], v[168:171], v[156:159], v[32:47]
    ds_read_b128 v[128:131], v179 offset:0
    ds_read_b128 v[132:135], v179 offset:1024
    v_mfma_f32_32x32x16_bf16 v[48:63], v[172:175], v[156:159], v[48:63]
    ds_read_b128 v[136:139], v179 offset:2048
    ds_read_b128 v[140:143], v179 offset:3072
    v_mfma_f32_32x32x16_bf16 v[64:79], v[168:171], v[160:163], v[64:79]
    v_mfma_f32_32x32x16_bf16 v[80:95], v[172:175], v[160:163], v[80:95]
    v_mfma_f32_32x32x16_bf16 v[96:111], v[168:171], v[164:167], v[96:111]
    v_mfma_f32_32x32x16_bf16 v[112:127], v[172:175], v[164:167], v[112:127]
G_cont_34:
    s_add_u32 s34, s34, 1
    s_cmp_ge_u32 s34, 16
    s_cbranch_scc1 G_end_28
    s_waitcnt lgkmcnt(0)
    v_mfma_f32_32x32x16_bf16 v[0:15], v[144:147], v[128:131], v[0:15]
    ds_read_b64_tr_b16 v[168:169], v186 offset:8192
    ds_read_b64_tr_b16 v[170:171], v186 offset:10240
    v_mfma_f32_32x32x16_bf16 v[16:31], v[148:151], v[128:131], v[16:31]
    ds_read_b64_tr_b16 v[172:173], v187 offset:8192
    ds_read_b64_tr_b16 v[174:175], v187 offset:10240
    v_mfma_f32_32x32x16_bf16 v[32:47], v[144:147], v[132:135], v[32:47]
    ds_read_b128 v[152:155], v179 offset:8192
    ds_read_b128 v[156:159], v179 offset:9216
    v_mfma_f32_32x32x16_bf16 v[48:63], v[148:151], v[132:135], v[48:63]
    ds_read_b128 v[160:163], v179 offset:10240
    ds_read_b128 v[164:167], v179 offset:11264
    v_mfma_f32_32x32x16_bf16 v[64:79], v[144:147], v[136:139], v[64:79]
    v_mfma_f32_32x32x16_bf16 v[80:95], v[148:151], v[136:139], v[80:95]
    v_mfma_f32_32x32x16_bf16 v[96:111], v[144:147], v[140:143], v[96:111]
    v_mfma_f32_32x32x16_bf16 v[112:127], v[148:151], v[140:143], v[112:127]
    s_add_u32 s35, s34, 4
    s_cmp_ge_u32 s35, 16
    s_cbranch_scc1 G_tail_35
    s_waitcnt vmcnt(8) lgkmcnt(0)
    s_barrier
    v_mfma_f32_32x32x16_bf16 v[0:15], v[168:171], v[152:155], v[0:15]
    ds_read_b64_tr_b16 v[144:145], v180 offset:0
    s_add_u32 m0, s30, 98304
    s_nop 0
    buffer_load_dwordx4 v188, s[4:7], s32 offen lds
    ds_read_b64_tr_b16 v[146:147], v180 offset:2048
    v_mfma_f32_32x32x16_bf16 v[16:31], v[172:175], v[152:155], v[16:31]
    s_add_u32 m0, s30, 99328
    s_nop 0
    buffer_load_dwordx4 v189, s[4:7], s32 offen lds
    ds_read_b64_tr_b16 v[148:149], v181 offset:0
    s_add_u32 m0, s31, 98304
    s_nop 0
    buffer_load_dwordx4 v190, s[8:11], s33 offen lds
    v_mfma_f32_32x32x16_bf16 v[32:47], v[168:171], v[156:159], v[32:47]
    ds_read_b64_tr_b16 v[150:151], v181 offset:2048
    s_add_u32 m0, s31, 99328
    s_nop 0
    buffer_load_dwordx4 v191, s[8:11], s33 offen lds
    s_add_u32 s32, s32, 131072
    s_add_u32 s33, s33, 262144
    ds_read_b128 v[128:131], v176 offset:0
    v_mfma_f32_32x32x16_bf16 v[48:63], v[172:175], v[156:159], v[48:63]
    ds_read_b128 v[132:135], v176 offset:1024
    ds_read_b128 v[136:139], v176 offset:2048
    ds_read_b128 v[140:143], v176 offset:3072
    v_mfma_f32_32x32x16_bf16 v[64:79], v[168:171], v[160:163], v[64:79]
    v_mfma_f32_32x32x16_bf16 v[80:95], v[172:175], v[160:163], v[80:95]
    v_mfma_f32_32x32x16_bf16 v[96:111], v[168:171], v[164:167], v[96:111]
    v_mfma_f32_32x32x16_bf16 v[112:127], v[172:175], v[164:167], v[112:127]
    s_branch G_cont_36
G_tail_35:
    s_waitcnt vmcnt(0) lgkmcnt(0)
    s_barrier
    v_mfma_f32_32x32x16_bf16 v[0:15], v[168:171], v[152:155], v[0:15]
    ds_read_b64_tr_b16 v[144:145], v180 offset:0
    ds_read_b64_tr_b16 v[146:147], v180 offset:2048
    v_mfma_f32_32x32x16_bf16 v[16:31], v[172:175], v[152:155], v[16:31]
    ds_read_b64_tr_b16 v[148:149], v181 offset:0
    ds_read_b64_tr_b16 v[150:151], v181 offset:2048
    v_mfma_f32_32x32x16_bf16 v[32:47], v[168:171], v[156:159], v[32:47]
    ds_read_b128 v[128:131], v176 offset:0
    ds_read_b128 v[132:135], v176 offset:1024
    v_mfma_f32_32x32x16_bf16 v[48:63], v[172:175], v[156:159], v[48:63]
    ds_read_b128 v[136:139], v176 offset:2048
    ds_read_b128 v[140:143], v176 offset:3072
    v_mfma_f32_32x32x16_bf16 v[64:79], v[168:171], v[160:163], v[64:79]
    v_mfma_f32_32x32x16_bf16 v[80:95], v[172:175], v[160:163], v[80:95]
    v_mfma_f32_32x32x16_bf16 v[96:111], v[168:171], v[164:167], v[96:111]
    v_mfma_f32_32x32x16_bf16 v[112:127], v[172:175], v[164:167], v[112:127]
G_cont_36:
    s_add_u32 s34, s34, 1
    s_cmp_ge_u32 s34, 16
    s_cbranch_scc1 G_end_28
    s_branch G_loop_27
G_end_28:
    s_waitcnt lgkmcnt(0)
    s_nop 15
    v_and_b32 v194, 31, v192
    s_mul_i32 s25, s27, 128
    s_add_u32 s25, s25, s22
    v_add_u32 v194, s25, v194
    v_lshlrev_b32 v194, 5, v194
    v_lshrrev_b32 v195, 5, v192
    v_bfe_u32 v200, v192, 3, 1
    v_xor_b32 v200, v195, v200
    v_lshl_add_u32 v194, v200, 4, v194
    s_mul_i32 s25, s28, 64
    s_add_u32 s25, s25, s23
    s_lshr_b32 s26, s25, 4
    s_mul_i32 s26, s26, 65536
    v_add_u32 v194, s26, v194
    v_cvt_pk_bf16_f32 v204, v0, v1
    v_cvt_pk_bf16_f32 v205, v2, v3
    v_cvt_pk_bf16_f32 v206, v4, v5
    v_cvt_pk_bf16_f32 v207, v6, v7
    s_mov_b32 s39, 0
    buffer_store_dwordx4 v[204:207], v194, s[12:15], s39 offen offset:0
    v_cvt_pk_bf16_f32 v208, v8, v9
    v_cvt_pk_bf16_f32 v209, v10, v11
    v_cvt_pk_bf16_f32 v210, v12, v13
    v_cvt_pk_bf16_f32 v211, v14, v15
    s_mov_b32 s39, 65536
    buffer_store_dwordx4 v[208:211], v194, s[12:15], s39 offen offset:0
    v_cvt_pk_bf16_f32 v212, v16, v17
    v_cvt_pk_bf16_f32 v213, v18, v19
    v_cvt_pk_bf16_f32 v214, v20, v21
    v_cvt_pk_bf16_f32 v215, v22, v23
    s_mov_b32 s39, 131072
    buffer_store_dwordx4 v[212:215], v194, s[12:15], s39 offen offset:0
    v_cvt_pk_bf16_f32 v216, v24, v25
    v_cvt_pk_bf16_f32 v217, v26, v27
    v_cvt_pk_bf16_f32 v218, v28, v29
    v_cvt_pk_bf16_f32 v219, v30, v31
    s_mov_b32 s39, 196608
    buffer_store_dwordx4 v[216:219], v194, s[12:15], s39 offen offset:0
    v_cvt_pk_bf16_f32 v204, v32, v33
    v_cvt_pk_bf16_f32 v205, v34, v35
    v_cvt_pk_bf16_f32 v206, v36, v37
    v_cvt_pk_bf16_f32 v207, v38, v39
    s_mov_b32 s39, 0
    buffer_store_dwordx4 v[204:207], v194, s[12:15], s39 offen offset:1024
    v_cvt_pk_bf16_f32 v208, v40, v41
    v_cvt_pk_bf16_f32 v209, v42, v43
    v_cvt_pk_bf16_f32 v210, v44, v45
    v_cvt_pk_bf16_f32 v211, v46, v47
    s_mov_b32 s39, 65536
    buffer_store_dwordx4 v[208:211], v194, s[12:15], s39 offen offset:1024
    v_cvt_pk_bf16_f32 v212, v48, v49
    v_cvt_pk_bf16_f32 v213, v50, v51
    v_cvt_pk_bf16_f32 v214, v52, v53
    v_cvt_pk_bf16_f32 v215, v54, v55
    s_mov_b32 s39, 131072
    buffer_store_dwordx4 v[212:215], v194, s[12:15], s39 offen offset:1024
    v_cvt_pk_bf16_f32 v216, v56, v57
    v_cvt_pk_bf16_f32 v217, v58, v59
    v_cvt_pk_bf16_f32 v218, v60, v61
    v_cvt_pk_bf16_f32 v219, v62, v63
    s_mov_b32 s39, 196608
    buffer_store_dwordx4 v[216:219], v194, s[12:15], s39 offen offset:1024
    v_cvt_pk_bf16_f32 v204, v64, v65
    v_cvt_pk_bf16_f32 v205, v66, v67
    v_cvt_pk_bf16_f32 v206, v68, v69
    v_cvt_pk_bf16_f32 v207, v70, v71
    s_mov_b32 s39, 0
    buffer_store_dwordx4 v[204:207], v194, s[12:15], s39 offen offset:2048
    v_cvt_pk_bf16_f32 v208, v72, v73
    v_cvt_pk_bf16_f32 v209, v74, v75
    v_cvt_pk_bf16_f32 v210, v76, v77
    v_cvt_pk_bf16_f32 v211, v78, v79
    s_mov_b32 s39, 65536
    buffer_store_dwordx4 v[208:211], v194, s[12:15], s39 offen offset:2048
    v_cvt_pk_bf16_f32 v212, v80, v81
    v_cvt_pk_bf16_f32 v213, v82, v83
    v_cvt_pk_bf16_f32 v214, v84, v85
    v_cvt_pk_bf16_f32 v215, v86, v87
    s_mov_b32 s39, 131072
    buffer_store_dwordx4 v[212:215], v194, s[12:15], s39 offen offset:2048
    v_cvt_pk_bf16_f32 v216, v88, v89
    v_cvt_pk_bf16_f32 v217, v90, v91
    v_cvt_pk_bf16_f32 v218, v92, v93
    v_cvt_pk_bf16_f32 v219, v94, v95
    s_mov_b32 s39, 196608
    buffer_store_dwordx4 v[216:219], v194, s[12:15], s39 offen offset:2048
    v_cvt_pk_bf16_f32 v204, v96, v97
    v_cvt_pk_bf16_f32 v205, v98, v99
    v_cvt_pk_bf16_f32 v206, v100, v101
    v_cvt_pk_bf16_f32 v207, v102, v103
    s_mov_b32 s39, 0
    buffer_store_dwordx4 v[204:207], v194, s[12:15], s39 offen offset:3072
    v_cvt_pk_bf16_f32 v208, v104, v105
    v_cvt_pk_bf16_f32 v209, v106, v107
    v_cvt_pk_bf16_f32 v210, v108, v109
    v_cvt_pk_bf16_f32 v211, v110, v111
    s_mov_b32 s39, 65536
    buffer_store_dwordx4 v[208:211], v194, s[12:15], s39 offen offset:3072
    v_cvt_pk_bf16_f32 v212, v112, v113
    v_cvt_pk_bf16_f32 v213, v114, v115
    v_cvt_pk_bf16_f32 v214, v116, v117
    v_cvt_pk_bf16_f32 v215, v118, v119
    s_mov_b32 s39, 131072
    buffer_store_dwordx4 v[212:215], v194, s[12:15], s39 offen offset:3072
    v_cvt_pk_bf16_f32 v216, v120, v121
    v_cvt_pk_bf16_f32 v217, v122, v123
    v_cvt_pk_bf16_f32 v218, v124, v125
    v_cvt_pk_bf16_f32 v219, v126, v127
    s_mov_b32 s39, 196608
    buffer_store_dwordx4 v[216:219], v194, s[12:15], s39 offen offset:3072
    s_endpgm
G1_V_6:
    s_sub_u32 s20, s2, 296
    s_and_b32 s21, s20, 7
    s_lshr_b32 s20, s20, 3
    s_and_b32 s22, s21, 3
    s_lshl_b32 s22, s22, 1
    s_and_b32 s25, s20, 1
    s_add_u32 s22, s22, s25
    s_lshl_b32 s22, s22, 8
    s_lshr_b32 s23, s21, 2
    s_lshl_b32 s23, s23, 3
    s_lshr_b32 s25, s20, 1
    s_add_u32 s23, s23, s25
    s_lshl_b32 s23, s23, 8
    s_add_u32 s4, s52, 0x600000
    s_addc_u32 s5, s53, 0
    s_and_b32 s5, s5, 0xffff
    s_mov_b32 s6, 0x200000
    s_mov_b32 s7, 0x00020000
    s_mov_b32 s8, s46
    s_and_b32 s9, s47, 0xffff
    s_mov_b32 s10, 0x400000
    s_mov_b32 s11, 0x00020000
    s_add_u32 s12, s52, 0x3000000
    s_addc_u32 s13, s53, 0
    s_and_b32 s13, s13, 0xffff
    s_mov_b32 s14, 0x1000000
    s_mov_b32 s15, 0x00020000
    v_mov_b32 v220, v0
    v_and_b32 v192, 63, v220
    v_lshrrev_b32 v193, 6, v220
    s_nop 0
    v_readfirstlane_b32 s24, v193
    s_lshr_b32 s27, s24, 2
    s_and_b32 s28, s24, 3
    v_and_b32 v194, 31, v192
    s_mul_i32 s25, s27, 128
    v_add_u32 v194, s25, v194
    v_lshlrev_b32 v194, 5, v194
    v_lshrrev_b32 v195, 5, v192
    v_bfe_u32 v196, v192, 3, 1
    v_xor_b32 v196, v195, v196
    v_lshl_add_u32 v176, v196, 4, v194
    v_add_u32 v177, 32768, v176
    v_add_u32 v178, 65536, v176
    v_add_u32 v179, 98304, v176
    v_bfe_u32 v197, v192, 2, 2
    v_lshl_add_u32 v198, v195, 3, v197
    v_mul_u32_u24 v198, 512, v198
    v_bfe_u32 v199, v192, 4, 1
    v_lshlrev_b32 v199, 1, v199
    v_bfe_u32 v200, v192, 1, 1
    v_add_u32 v199, v199, v200
    s_mul_i32 s25, s28, 8
    v_add_u32 v199, s25, v199
    v_lshlrev_b32 v200, 2, v197
    v_and_b32 v201, 1, v192
    v_lshlrev_b32 v201, 3, v201
    v_add_u32 v198, v198, v201
    v_add_u32 v198, 16384, v198
    v_add_u32 v201, 0, v199
    v_xor_b32 v201, v201, v200
    v_lshl_add_u32 v180, v201, 4, v198
    v_add_u32 v182, 32768, v180
    v_add_u32 v184, 65536, v180
    v_add_u32 v186, 98304, v180
    v_add_u32 v201, 4, v199
    v_xor_b32 v201, v201, v200
    v_lshl_add_u32 v181, v201, 4, v198
    v_add_u32 v183, 32768, v181
    v_add_u32 v185, 65536, v181
    v_add_u32 v187, 98304, v181
    s_mul_i32 s30, s24, 2048
    s_mul_i32 s31, s24, 2048
    s_add_u32 s31, s31, 16384
    v_lshlrev_b32 v196, 4, v192
    s_mul_i32 s25, s24, 2
    s_add_u32 s25, s25, 0
    s_lshr_b32 s26, s25, 3
    s_and_b32 s25, s25, 7
    s_mul_i32 s26, s26, 2048
    s_lshl_b32 s25, s25, 5
    s_add_u32 s25, s25, s26
    s_add_u32 s25, s25, s22
    s_lshl_b32 s25, s25, 5
    v_add_u32 v188, s25, v196
    s_mul_i32 s25, s24, 2
    s_add_u32 s25, s25, 1
    s_lshr_b32 s26, s25, 3
    s_and_b32 s25, s25, 7
    s_mul_i32 s26, s26, 2048
    s_lshl_b32 s25, s25, 5
    s_add_u32 s25, s25, s26
    s_add_u32 s25, s25, s22
    s_lshl_b32 s25, s25, 5
    v_add_u32 v189, s25, v196
    s_mov_b32 s26, 8192
    s_lshl_b32 s29, s23, 1
    s_mul_i32 s25, s24, 4
    s_add_u32 s25, s25, 0
    v_lshrrev_b32 v196, 5, v192
    v_add_u32 v196, s25, v196
    v_and_b32 v197, 3, v196
    v_lshlrev_b32 v197, 2, v197
    v_and_b32 v198, 31, v192
    v_xor_b32 v197, v197, v198
    v_mul_lo_u32 v196, v196, s26
    v_lshl_add_u32 v196, v197, 4, v196
    v_add_u32 v190, s29, v196
    s_mul_i32 s25, s24, 4
    s_add_u32 s25, s25, 2
    v_lshrrev_b32 v196, 5, v192
    v_add_u32 v196, s25, v196
    v_and_b32 v197, 3, v196
    v_lshlrev_b32 v197, 2, v197
    v_and_b32 v198, 31, v192
    v_xor_b32 v197, v197, v198
    v_mul_lo_u32 v196, v196, s26
    v_lshl_add_u32 v196, v197, 4, v196
    v_add_u32 v191, s29, v196
    v_mov_b32 v0, 0
    v_mov_b32 v1, 0
    v_mov_b32 v2, 0
    v_mov_b32 v3, 0
    v_mov_b32 v4, 0
    v_mov_b32 v5, 0
    v_mov_b32 v6, 0
    v_mov_b32 v7, 0
    v_mov_b32 v8, 0
    v_mov_b32 v9, 0
    v_mov_b32 v10, 0
    v_mov_b32 v11, 0
    v_mov_b32 v12, 0
    v_mov_b32 v13, 0
    v_mov_b32 v14, 0
    v_mov_b32 v15, 0
    v_mov_b32 v16, 0
    v_mov_b32 v17, 0
    v_mov_b32 v18, 0
    v_mov_b32 v19, 0
    v_mov_b32 v20, 0
    v_mov_b32 v21, 0
    v_mov_b32 v22, 0
    v_mov_b32 v23, 0
    v_mov_b32 v24, 0
    v_mov_b32 v25, 0
    v_mov_b32 v26, 0
    v_mov_b32 v27, 0
    v_mov_b32 v28, 0
    v_mov_b32 v29, 0
    v_mov_b32 v30, 0
    v_mov_b32 v31, 0
    v_mov_b32 v32, 0
    v_mov_b32 v33, 0
    v_mov_b32 v34, 0
    v_mov_b32 v35, 0
    v_mov_b32 v36, 0
    v_mov_b32 v37, 0
    v_mov_b32 v38, 0
    v_mov_b32 v39, 0
    v_mov_b32 v40, 0
    v_mov_b32 v41, 0
    v_mov_b32 v42, 0
    v_mov_b32 v43, 0
    v_mov_b32 v44, 0
    v_mov_b32 v45, 0
    v_mov_b32 v46, 0
    v_mov_b32 v47, 0
    v_mov_b32 v48, 0
    v_mov_b32 v49, 0
    v_mov_b32 v50, 0
    v_mov_b32 v51, 0
    v_mov_b32 v52, 0
    v_mov_b32 v53, 0
    v_mov_b32 v54, 0
    v_mov_b32 v55, 0
    v_mov_b32 v56, 0
    v_mov_b32 v57, 0
    v_mov_b32 v58, 0
    v_mov_b32 v59, 0
    v_mov_b32 v60, 0
    v_mov_b32 v61, 0
    v_mov_b32 v62, 0
    v_mov_b32 v63, 0
    v_mov_b32 v64, 0
    v_mov_b32 v65, 0
    v_mov_b32 v66, 0
    v_mov_b32 v67, 0
    v_mov_b32 v68, 0
    v_mov_b32 v69, 0
    v_mov_b32 v70, 0
    v_mov_b32 v71, 0
    v_mov_b32 v72, 0
    v_mov_b32 v73, 0
    v_mov_b32 v74, 0
    v_mov_b32 v75, 0
    v_mov_b32 v76, 0
    v_mov_b32 v77, 0
    v_mov_b32 v78, 0
    v_mov_b32 v79, 0
    v_mov_b32 v80, 0
    v_mov_b32 v81, 0
    v_mov_b32 v82, 0
    v_mov_b32 v83, 0
    v_mov_b32 v84, 0
    v_mov_b32 v85, 0
    v_mov_b32 v86, 0
    v_mov_b32 v87, 0
    v_mov_b32 v88, 0
    v_mov_b32 v89, 0
    v_mov_b32 v90, 0
    v_mov_b32 v91, 0
    v_mov_b32 v92, 0
    v_mov_b32 v93, 0
    v_mov_b32 v94, 0
    v_mov_b32 v95, 0
    v_mov_b32 v96, 0
    v_mov_b32 v97, 0
    v_mov_b32 v98, 0
    v_mov_b32 v99, 0
    v_mov_b32 v100, 0
    v_mov_b32 v101, 0
    v_mov_b32 v102, 0
    v_mov_b32 v103, 0
    v_mov_b32 v104, 0
    v_mov_b32 v105, 0
    v_mov_b32 v106, 0
    v_mov_b32 v107, 0
    v_mov_b32 v108, 0
    v_mov_b32 v109, 0
    v_mov_b32 v110, 0
    v_mov_b32 v111, 0
    v_mov_b32 v112, 0
    v_mov_b32 v113, 0
    v_mov_b32 v114, 0
    v_mov_b32 v115, 0
    v_mov_b32 v116, 0
    v_mov_b32 v117, 0
    v_mov_b32 v118, 0
    v_mov_b32 v119, 0
    v_mov_b32 v120, 0
    v_mov_b32 v121, 0
    v_mov_b32 v122, 0
    v_mov_b32 v123, 0
    v_mov_b32 v124, 0
    v_mov_b32 v125, 0
    v_mov_b32 v126, 0
    v_mov_b32 v127, 0
    s_mov_b32 s32, 0
    s_mov_b32 s33, 0
    s_add_u32 m0, s30, 0
    s_nop 0
    buffer_load_dwordx4 v188, s[4:7], s32 offen lds
    s_add_u32 m0, s30, 1024
    s_nop 0
    buffer_load_dwordx4 v189, s[4:7], s32 offen lds
    s_add_u32 m0, s31, 0
    s_nop 0
    buffer_load_dwordx4 v190, s[8:11], s33 offen lds
    s_add_u32 m0, s31, 1024
    s_nop 0
    buffer_load_dwordx4 v191, s[8:11], s33 offen lds
    s_add_u32 s32, s32, 131072
    s_add_u32 s33, s33, 262144
    s_add_u32 m0, s30, 32768
    s_nop 0
    buffer_load_dwordx4 v188, s[4:7], s32 offen lds
    s_add_u32 m0, s30, 33792
    s_nop 0
    buffer_load_dwordx4 v189, s[4:7], s32 offen lds
    s_add_u32 m0, s31, 32768
    s_nop 0
    buffer_load_dwordx4 v190, s[8:11], s33 offen lds
    s_add_u32 m0, s31, 33792
    s_nop 0
    buffer_load_dwordx4 v191, s[8:11], s33 offen lds
    s_add_u32 s32, s32, 131072
    s_add_u32 s33, s33, 262144
    s_add_u32 m0, s30, 65536
    s_nop 0
    buffer_load_dwordx4 v188, s[4:7], s32 offen lds
    s_add_u32 m0, s30, 66560
    s_nop 0
    buffer_load_dwordx4 v189, s[4:7], s32 offen lds
    s_add_u32 m0, s31, 65536
    s_nop 0
    buffer_load_dwordx4 v190, s[8:11], s33 offen lds
    s_add_u32 m0, s31, 66560
    s_nop 0
    buffer_load_dwordx4 v191, s[8:11], s33 offen lds
    s_add_u32 s32, s32, 131072
    s_add_u32 s33, s33, 262144
    s_add_u32 m0, s30, 98304
    s_nop 0
    buffer_load_dwordx4 v188, s[4:7], s32 offen lds
    s_add_u32 m0, s30, 99328
    s_nop 0
    buffer_load_dwordx4 v189, s[4:7], s32 offen lds
    s_add_u32 m0, s31, 98304
    s_nop 0
    buffer_load_dwordx4 v190, s[8:11], s33 offen lds
    s_add_u32 m0, s31, 99328
    s_nop 0
    buffer_load_dwordx4 v191, s[8:11], s33 offen lds
    s_add_u32 s32, s32, 131072
    s_add_u32 s33, s33, 262144
    s_waitcnt vmcnt(12)
    s_barrier
    ds_read_b64_tr_b16 v[144:145], v180 offset:0
    ds_read_b64_tr_b16 v[146:147], v180 offset:2048
    ds_read_b64_tr_b16 v[148:149], v181 offset:0
    ds_read_b64_tr_b16 v[150:151], v181 offset:2048
    ds_read_b128 v[128:131], v176 offset:0
    ds_read_b128 v[132:135], v176 offset:1024
    ds_read_b128 v[136:139], v176 offset:2048
    ds_read_b128 v[140:143], v176 offset:3072
    s_mov_b32 s34, 0
G_loop_37:
    s_waitcnt lgkmcnt(0)
    v_mfma_f32_32x32x16_bf16 v[0:15], v[128:131], v[144:147], v[0:15]
    ds_read_b64_tr_b16 v[168:169], v180 offset:8192
    ds_read_b64_tr_b16 v[170:171], v180 offset:10240
    v_mfma_f32_32x32x16_bf16 v[16:31], v[128:131], v[148:151], v[16:31]
    ds_read_b64_tr_b16 v[172:173], v181 offset:8192
    ds_read_b64_tr_b16 v[174:175], v181 offset:10240
    v_mfma_f32_32x32x16_bf16 v[32:47], v[132:135], v[144:147], v[32:47]
    ds_read_b128 v[152:155], v176 offset:8192
    ds_read_b128 v[156:159], v176 offset:9216
    v_mfma_f32_32x32x16_bf16 v[48:63], v[132:135], v[148:151], v[48:63]
    ds_read_b128 v[160:163], v176 offset:10240
    ds_read_b128 v[164:167], v176 offset:11264
    v_mfma_f32_32x32x16_bf16 v[64:79], v[136:139], v[144:147], v[64:79]
    v_mfma_f32_32x32x16_bf16 v[80:95], v[136:139], v[148:151], v[80:95]
    v_mfma_f32_32x32x16_bf16 v[96:111], v[140:143], v[144:147], v[96:111]
    v_mfma_f32_32x32x16_bf16 v[112:127], v[140:143], v[148:151], v[112:127]
    s_add_u32 s35, s34, 4
    s_cmp_ge_u32 s35, 16
    s_cbranch_scc1 G_tail_39
    s_waitcnt vmcnt(8) lgkmcnt(0)
    s_barrier
    v_mfma_f32_32x32x16_bf16 v[0:15], v[152:155], v[168:171], v[0:15]
    ds_read_b64_tr_b16 v[144:145], v182 offset:0
    s_add_u32 m0, s30, 0
    s_nop 0
    buffer_load_dwordx4 v188, s[4:7], s32 offen lds
    ds_read_b64_tr_b16 v[146:147], v182 offset:2048
    v_mfma_f32_32x32x16_bf16 v[16:31], v[152:155], v[172:175], v[16:31]
    s_add_u32 m0, s30, 1024
    s_nop 0
    buffer_load_dwordx4 v189, s[4:7], s32 offen lds
    ds_read_b64_tr_b16 v[148:149], v183 offset:0
    s_add_u32 m0, s31, 0
    s_nop 0
    buffer_load_dwordx4 v190, s[8:11], s33 offen lds
    v_mfma_f32_32x32x16_bf16 v[32:47], v[156:159], v[168:171], v[32:47]
    ds_read_b64_tr_b16 v[150:151], v183 offset:2048
    s_add_u32 m0, s31, 1024
    s_nop 0
    buffer_load_dwordx4 v191, s[8:11], s33 offen lds
    s_add_u32 s32, s32, 131072
    s_add_u32 s33, s33, 262144
    ds_read_b128 v[128:131], v177 offset:0
    v_mfma_f32_32x32x16_bf16 v[48:63], v[156:159], v[172:175], v[48:63]
    ds_read_b128 v[132:135], v177 offset:1024
    ds_read_b128 v[136:139], v177 offset:2048
    ds_read_b128 v[140:143], v177 offset:3072
    v_mfma_f32_32x32x16_bf16 v[64:79], v[160:163], v[168:171], v[64:79]
    v_mfma_f32_32x32x16_bf16 v[80:95], v[160:163], v[172:175], v[80:95]
    v_mfma_f32_32x32x16_bf16 v[96:111], v[164:167], v[168:171], v[96:111]
    v_mfma_f32_32x32x16_bf16 v[112:127], v[164:167], v[172:175], v[112:127]
    s_branch G_cont_40
G_tail_39:
    s_waitcnt vmcnt(0) lgkmcnt(0)
    s_barrier
    v_mfma_f32_32x32x16_bf16 v[0:15], v[152:155], v[168:171], v[0:15]
    ds_read_b64_tr_b16 v[144:145], v182 offset:0
    ds_read_b64_tr_b16 v[146:147], v182 offset:2048
    v_mfma_f32_32x32x16_bf16 v[16:31], v[152:155], v[172:175], v[16:31]
    ds_read_b64_tr_b16 v[148:149], v183 offset:0
    ds_read_b64_tr_b16 v[150:151], v183 offset:2048
    v_mfma_f32_32x32x16_bf16 v[32:47], v[156:159], v[168:171], v[32:47]
    ds_read_b128 v[128:131], v177 offset:0
    ds_read_b128 v[132:135], v177 offset:1024
    v_mfma_f32_32x32x16_bf16 v[48:63], v[156:159], v[172:175], v[48:63]
    ds_read_b128 v[136:139], v177 offset:2048
    ds_read_b128 v[140:143], v177 offset:3072
    v_mfma_f32_32x32x16_bf16 v[64:79], v[160:163], v[168:171], v[64:79]
    v_mfma_f32_32x32x16_bf16 v[80:95], v[160:163], v[172:175], v[80:95]
    v_mfma_f32_32x32x16_bf16 v[96:111], v[164:167], v[168:171], v[96:111]
    v_mfma_f32_32x32x16_bf16 v[112:127], v[164:167], v[172:175], v[112:127]
G_cont_40:
    s_add_u32 s34, s34, 1
    s_cmp_ge_u32 s34, 16
    s_cbranch_scc1 G_end_38
    s_waitcnt lgkmcnt(0)
    v_mfma_f32_32x32x16_bf16 v[0:15], v[128:131], v[144:147], v[0:15]
    ds_read_b64_tr_b16 v[168:169], v182 offset:8192
    ds_read_b64_tr_b16 v[170:171], v182 offset:10240
    v_mfma_f32_32x32x16_bf16 v[16:31], v[128:131], v[148:151], v[16:31]
    ds_read_b64_tr_b16 v[172:173], v183 offset:8192
    ds_read_b64_tr_b16 v[174:175], v183 offset:10240
    v_mfma_f32_32x32x16_bf16 v[32:47], v[132:135], v[144:147], v[32:47]
    ds_read_b128 v[152:155], v177 offset:8192
    ds_read_b128 v[156:159], v177 offset:9216
    v_mfma_f32_32x32x16_bf16 v[48:63], v[132:135], v[148:151], v[48:63]
    ds_read_b128 v[160:163], v177 offset:10240
    ds_read_b128 v[164:167], v177 offset:11264
    v_mfma_f32_32x32x16_bf16 v[64:79], v[136:139], v[144:147], v[64:79]
    v_mfma_f32_32x32x16_bf16 v[80:95], v[136:139], v[148:151], v[80:95]
    v_mfma_f32_32x32x16_bf16 v[96:111], v[140:143], v[144:147], v[96:111]
    v_mfma_f32_32x32x16_bf16 v[112:127], v[140:143], v[148:151], v[112:127]
    s_add_u32 s35, s34, 4
    s_cmp_ge_u32 s35, 16
    s_cbranch_scc1 G_tail_41
    s_waitcnt vmcnt(8) lgkmcnt(0)
    s_barrier
    v_mfma_f32_32x32x16_bf16 v[0:15], v[152:155], v[168:171], v[0:15]
    ds_read_b64_tr_b16 v[144:145], v184 offset:0
    s_add_u32 m0, s30, 32768
    s_nop 0
    buffer_load_dwordx4 v188, s[4:7], s32 offen lds
    ds_read_b64_tr_b16 v[146:147], v184 offset:2048
    v_mfma_f32_32x32x16_bf16 v[16:31], v[152:155], v[172:175], v[16:31]
    s_add_u32 m0, s30, 33792
    s_nop 0
    buffer_load_dwordx4 v189, s[4:7], s32 offen lds
    ds_read_b64_tr_b16 v[148:149], v185 offset:0
    s_add_u32 m0, s31, 32768
    s_nop 0
    buffer_load_dwordx4 v190, s[8:11], s33 offen lds
    v_mfma_f32_32x32x16_bf16 v[32:47], v[156:159], v[168:171], v[32:47]
    ds_read_b64_tr_b16 v[150:151], v185 offset:2048
    s_add_u32 m0, s31, 33792
    s_nop 0
    buffer_load_dwordx4 v191, s[8:11], s33 offen lds
    s_add_u32 s32, s32, 131072
    s_add_u32 s33, s33, 262144
    ds_read_b128 v[128:131], v178 offset:0
    v_mfma_f32_32x32x16_bf16 v[48:63], v[156:159], v[172:175], v[48:63]
    ds_read_b128 v[132:135], v178 offset:1024
    ds_read_b128 v[136:139], v178 offset:2048
    ds_read_b128 v[140:143], v178 offset:3072
    v_mfma_f32_32x32x16_bf16 v[64:79], v[160:163], v[168:171], v[64:79]
    v_mfma_f32_32x32x16_bf16 v[80:95], v[160:163], v[172:175], v[80:95]
    v_mfma_f32_32x32x16_bf16 v[96:111], v[164:167], v[168:171], v[96:111]
    v_mfma_f32_32x32x16_bf16 v[112:127], v[164:167], v[172:175], v[112:127]
    s_branch G_cont_42
G_tail_41:
    s_waitcnt vmcnt(0) lgkmcnt(0)
    s_barrier
    v_mfma_f32_32x32x16_bf16 v[0:15], v[152:155], v[168:171], v[0:15]
    ds_read_b64_tr_b16 v[144:145], v184 offset:0
    ds_read_b64_tr_b16 v[146:147], v184 offset:2048
    v_mfma_f32_32x32x16_bf16 v[16:31], v[152:155], v[172:175], v[16:31]
    ds_read_b64_tr_b16 v[148:149], v185 offset:0
    ds_read_b64_tr_b16 v[150:151], v185 offset:2048
    v_mfma_f32_32x32x16_bf16 v[32:47], v[156:159], v[168:171], v[32:47]
    ds_read_b128 v[128:131], v178 offset:0
    ds_read_b128 v[132:135], v178 offset:1024
    v_mfma_f32_32x32x16_bf16 v[48:63], v[156:159], v[172:175], v[48:63]
    ds_read_b128 v[136:139], v178 offset:2048
    ds_read_b128 v[140:143], v178 offset:3072
    v_mfma_f32_32x32x16_bf16 v[64:79], v[160:163], v[168:171], v[64:79]
    v_mfma_f32_32x32x16_bf16 v[80:95], v[160:163], v[172:175], v[80:95]
    v_mfma_f32_32x32x16_bf16 v[96:111], v[164:167], v[168:171], v[96:111]
    v_mfma_f32_32x32x16_bf16 v[112:127], v[164:167], v[172:175], v[112:127]
G_cont_42:
    s_add_u32 s34, s34, 1
    s_cmp_ge_u32 s34, 16
    s_cbranch_scc1 G_end_38
    s_waitcnt lgkmcnt(0)
    v_mfma_f32_32x32x16_bf16 v[0:15], v[128:131], v[144:147], v[0:15]
    ds_read_b64_tr_b16 v[168:169], v184 offset:8192
    ds_read_b64_tr_b16 v[170:171], v184 offset:10240
    v_mfma_f32_32x32x16_bf16 v[16:31], v[128:131], v[148:151], v[16:31]
    ds_read_b64_tr_b16 v[172:173], v185 offset:8192
    ds_read_b64_tr_b16 v[174:175], v185 offset:10240
    v_mfma_f32_32x32x16_bf16 v[32:47], v[132:135], v[144:147], v[32:47]
    ds_read_b128 v[152:155], v178 offset:8192
    ds_read_b128 v[156:159], v178 offset:9216
    v_mfma_f32_32x32x16_bf16 v[48:63], v[132:135], v[148:151], v[48:63]
    ds_read_b128 v[160:163], v178 offset:10240
    ds_read_b128 v[164:167], v178 offset:11264
    v_mfma_f32_32x32x16_bf16 v[64:79], v[136:139], v[144:147], v[64:79]
    v_mfma_f32_32x32x16_bf16 v[80:95], v[136:139], v[148:151], v[80:95]
    v_mfma_f32_32x32x16_bf16 v[96:111], v[140:143], v[144:147], v[96:111]
    v_mfma_f32_32x32x16_bf16 v[112:127], v[140:143], v[148:151], v[112:127]
    s_add_u32 s35, s34, 4
    s_cmp_ge_u32 s35, 16
    s_cbranch_scc1 G_tail_43
    s_waitcnt vmcnt(8) lgkmcnt(0)
    s_barrier
    v_mfma_f32_32x32x16_bf16 v[0:15], v[152:155], v[168:171], v[0:15]
    ds_read_b64_tr_b16 v[144:145], v186 offset:0
    s_add_u32 m0, s30, 65536
    s_nop 0
    buffer_load_dwordx4 v188, s[4:7], s32 offen lds
    ds_read_b64_tr_b16 v[146:147], v186 offset:2048
    v_mfma_f32_32x32x16_bf16 v[16:31], v[152:155], v[172:175], v[16:31]
    s_add_u32 m0, s30, 66560
    s_nop 0
    buffer_load_dwordx4 v189, s[4:7], s32 offen lds
    ds_read_b64_tr_b16 v[148:149], v187 offset:0
    s_add_u32 m0, s31, 65536
    s_nop 0
    buffer_load_dwordx4 v190, s[8:11], s33 offen lds
    v_mfma_f32_32x32x16_bf16 v[32:47], v[156:159], v[168:171], v[32:47]
    ds_read_b64_tr_b16 v[150:151], v187 offset:2048
    s_add_u32 m0, s31, 66560
    s_nop 0
    buffer_load_dwordx4 v191, s[8:11], s33 offen lds
    s_add_u32 s32, s32, 131072
    s_add_u32 s33, s33, 262144
    ds_read_b128 v[128:131], v179 offset:0
    v_mfma_f32_32x32x16_bf16 v[48:63], v[156:159], v[172:175], v[48:63]
    ds_read_b128 v[132:135], v179 offset:1024
    ds_read_b128 v[136:139], v179 offset:2048
    ds_read_b128 v[140:143], v179 offset:3072
    v_mfma_f32_32x32x16_bf16 v[64:79], v[160:163], v[168:171], v[64:79]
    v_mfma_f32_32x32x16_bf16 v[80:95], v[160:163], v[172:175], v[80:95]
    v_mfma_f32_32x32x16_bf16 v[96:111], v[164:167], v[168:171], v[96:111]
    v_mfma_f32_32x32x16_bf16 v[112:127], v[164:167], v[172:175], v[112:127]
    s_branch G_cont_44
G_tail_43:
    s_waitcnt vmcnt(0) lgkmcnt(0)
    s_barrier
    v_mfma_f32_32x32x16_bf16 v[0:15], v[152:155], v[168:171], v[0:15]
    ds_read_b64_tr_b16 v[144:145], v186 offset:0
    ds_read_b64_tr_b16 v[146:147], v186 offset:2048
    v_mfma_f32_32x32x16_bf16 v[16:31], v[152:155], v[172:175], v[16:31]
    ds_read_b64_tr_b16 v[148:149], v187 offset:0
    ds_read_b64_tr_b16 v[150:151], v187 offset:2048
    v_mfma_f32_32x32x16_bf16 v[32:47], v[156:159], v[168:171], v[32:47]
    ds_read_b128 v[128:131], v179 offset:0
    ds_read_b128 v[132:135], v179 offset:1024
    v_mfma_f32_32x32x16_bf16 v[48:63], v[156:159], v[172:175], v[48:63]
    ds_read_b128 v[136:139], v179 offset:2048
    ds_read_b128 v[140:143], v179 offset:3072
    v_mfma_f32_32x32x16_bf16 v[64:79], v[160:163], v[168:171], v[64:79]
    v_mfma_f32_32x32x16_bf16 v[80:95], v[160:163], v[172:175], v[80:95]
    v_mfma_f32_32x32x16_bf16 v[96:111], v[164:167], v[168:171], v[96:111]
    v_mfma_f32_32x32x16_bf16 v[112:127], v[164:167], v[172:175], v[112:127]
G_cont_44:
    s_add_u32 s34, s34, 1
    s_cmp_ge_u32 s34, 16
    s_cbranch_scc1 G_end_38
    s_waitcnt lgkmcnt(0)
    v_mfma_f32_32x32x16_bf16 v[0:15], v[128:131], v[144:147], v[0:15]
    ds_read_b64_tr_b16 v[168:169], v186 offset:8192
    ds_read_b64_tr_b16 v[170:171], v186 offset:10240
    v_mfma_f32_32x32x16_bf16 v[16:31], v[128:131], v[148:151], v[16:31]
    ds_read_b64_tr_b16 v[172:173], v187 offset:8192
    ds_read_b64_tr_b16 v[174:175], v187 offset:10240
    v_mfma_f32_32x32x16_bf16 v[32:47], v[132:135], v[144:147], v[32:47]
    ds_read_b128 v[152:155], v179 offset:8192
    ds_read_b128 v[156:159], v179 offset:9216
    v_mfma_f32_32x32x16_bf16 v[48:63], v[132:135], v[148:151], v[48:63]
    ds_read_b128 v[160:163], v179 offset:10240
    ds_read_b128 v[164:167], v179 offset:11264
    v_mfma_f32_32x32x16_bf16 v[64:79], v[136:139], v[144:147], v[64:79]
    v_mfma_f32_32x32x16_bf16 v[80:95], v[136:139], v[148:151], v[80:95]
    v_mfma_f32_32x32x16_bf16 v[96:111], v[140:143], v[144:147], v[96:111]
    v_mfma_f32_32x32x16_bf16 v[112:127], v[140:143], v[148:151], v[112:127]
    s_add_u32 s35, s34, 4
    s_cmp_ge_u32 s35, 16
    s_cbranch_scc1 G_tail_45
    s_waitcnt vmcnt(8) lgkmcnt(0)
    s_barrier
    v_mfma_f32_32x32x16_bf16 v[0:15], v[152:155], v[168:171], v[0:15]
    ds_read_b64_tr_b16 v[144:145], v180 offset:0
    s_add_u32 m0, s30, 98304
    s_nop 0
    buffer_load_dwordx4 v188, s[4:7], s32 offen lds
    ds_read_b64_tr_b16 v[146:147], v180 offset:2048
    v_mfma_f32_32x32x16_bf16 v[16:31], v[152:155], v[172:175], v[16:31]
    s_add_u32 m0, s30, 99328
    s_nop 0
    buffer_load_dwordx4 v189, s[4:7], s32 offen lds
    ds_read_b64_tr_b16 v[148:149], v181 offset:0
    s_add_u32 m0, s31, 98304
    s_nop 0
    buffer_load_dwordx4 v190, s[8:11], s33 offen lds
    v_mfma_f32_32x32x16_bf16 v[32:47], v[156:159], v[168:171], v[32:47]
    ds_read_b64_tr_b16 v[150:151], v181 offset:2048
    s_add_u32 m0, s31, 99328
    s_nop 0
    buffer_load_dwordx4 v191, s[8:11], s33 offen lds
    s_add_u32 s32, s32, 131072
    s_add_u32 s33, s33, 262144
    ds_read_b128 v[128:131], v176 offset:0
    v_mfma_f32_32x32x16_bf16 v[48:63], v[156:159], v[172:175], v[48:63]
    ds_read_b128 v[132:135], v176 offset:1024
    ds_read_b128 v[136:139], v176 offset:2048
    ds_read_b128 v[140:143], v176 offset:3072
    v_mfma_f32_32x32x16_bf16 v[64:79], v[160:163], v[168:171], v[64:79]
    v_mfma_f32_32x32x16_bf16 v[80:95], v[160:163], v[172:175], v[80:95]
    v_mfma_f32_32x32x16_bf16 v[96:111], v[164:167], v[168:171], v[96:111]
    v_mfma_f32_32x32x16_bf16 v[112:127], v[164:167], v[172:175], v[112:127]
    s_branch G_cont_46
G_tail_45:
    s_waitcnt vmcnt(0) lgkmcnt(0)
    s_barrier
    v_mfma_f32_32x32x16_bf16 v[0:15], v[152:155], v[168:171], v[0:15]
    ds_read_b64_tr_b16 v[144:145], v180 offset:0
    ds_read_b64_tr_b16 v[146:147], v180 offset:2048
    v_mfma_f32_32x32x16_bf16 v[16:31], v[152:155], v[172:175], v[16:31]
    ds_read_b64_tr_b16 v[148:149], v181 offset:0
    ds_read_b64_tr_b16 v[150:151], v181 offset:2048
    v_mfma_f32_32x32x16_bf16 v[32:47], v[156:159], v[168:171], v[32:47]
    ds_read_b128 v[128:131], v176 offset:0
    ds_read_b128 v[132:135], v176 offset:1024
    v_mfma_f32_32x32x16_bf16 v[48:63], v[156:159], v[172:175], v[48:63]
    ds_read_b128 v[136:139], v176 offset:2048
    ds_read_b128 v[140:143], v176 offset:3072
    v_mfma_f32_32x32x16_bf16 v[64:79], v[160:163], v[168:171], v[64:79]
    v_mfma_f32_32x32x16_bf16 v[80:95], v[160:163], v[172:175], v[80:95]
    v_mfma_f32_32x32x16_bf16 v[96:111], v[164:167], v[168:171], v[96:111]
    v_mfma_f32_32x32x16_bf16 v[112:127], v[164:167], v[172:175], v[112:127]
G_cont_46:
    s_add_u32 s34, s34, 1
    s_cmp_ge_u32 s34, 16
    s_cbranch_scc1 G_end_38
    s_branch G_loop_37
G_end_38:
    s_waitcnt lgkmcnt(0)
    s_nop 15
    v_and_b32 v194, 31, v192
    s_mul_i32 s25, s28, 64
    s_add_u32 s25, s25, s23
    v_add_u32 v194, s25, v194
    v_lshlrev_b32 v194, 5, v194
    v_lshrrev_b32 v195, 5, v192
    v_bfe_u32 v200, v192, 3, 1
    v_xor_b32 v200, v195, v200
    v_lshl_add_u32 v194, v200, 4, v194
    s_mul_i32 s25, s27, 128
    s_add_u32 s25, s25, s22
    s_lshr_b32 s26, s25, 4
    s_mul_i32 s26, s26, 131072
    v_add_u32 v194, s26, v194
    v_cvt_pk_bf16_f32 v204, v0, v1
    v_cvt_pk_bf16_f32 v205, v2, v3
    v_cvt_pk_bf16_f32 v206, v4, v5
    v_cvt_pk_bf16_f32 v207, v6, v7
    s_mov_b32 s39, 0
    buffer_store_dwordx4 v[204:207], v194, s[12:15], s39 offen offset:0
    v_cvt_pk_bf16_f32 v208, v8, v9
    v_cvt_pk_bf16_f32 v209, v10, v11
    v_cvt_pk_bf16_f32 v210, v12, v13
    v_cvt_pk_bf16_f32 v211, v14, v15
    s_mov_b32 s39, 131072
    buffer_store_dwordx4 v[208:211], v194, s[12:15], s39 offen offset:0
    v_cvt_pk_bf16_f32 v212, v16, v17
    v_cvt_pk_bf16_f32 v213, v18, v19
    v_cvt_pk_bf16_f32 v214, v20, v21
    v_cvt_pk_bf16_f32 v215, v22, v23
    s_mov_b32 s39, 0
    buffer_store_dwordx4 v[212:215], v194, s[12:15], s39 offen offset:1024
    v_cvt_pk_bf16_f32 v216, v24, v25
    v_cvt_pk_bf16_f32 v217, v26, v27
    v_cvt_pk_bf16_f32 v218, v28, v29
    v_cvt_pk_bf16_f32 v219, v30, v31
    s_mov_b32 s39, 131072
    buffer_store_dwordx4 v[216:219], v194, s[12:15], s39 offen offset:1024
    v_cvt_pk_bf16_f32 v204, v32, v33
    v_cvt_pk_bf16_f32 v205, v34, v35
    v_cvt_pk_bf16_f32 v206, v36, v37
    v_cvt_pk_bf16_f32 v207, v38, v39
    s_mov_b32 s39, 262144
    buffer_store_dwordx4 v[204:207], v194, s[12:15], s39 offen offset:0
    v_cvt_pk_bf16_f32 v208, v40, v41
    v_cvt_pk_bf16_f32 v209, v42, v43
    v_cvt_pk_bf16_f32 v210, v44, v45
    v_cvt_pk_bf16_f32 v211, v46, v47
    s_mov_b32 s39, 393216
    buffer_store_dwordx4 v[208:211], v194, s[12:15], s39 offen offset:0
    v_cvt_pk_bf16_f32 v212, v48, v49
    v_cvt_pk_bf16_f32 v213, v50, v51
    v_cvt_pk_bf16_f32 v214, v52, v53
    v_cvt_pk_bf16_f32 v215, v54, v55
    s_mov_b32 s39, 262144
    buffer_store_dwordx4 v[212:215], v194, s[12:15], s39 offen offset:1024
    v_cvt_pk_bf16_f32 v216, v56, v57
    v_cvt_pk_bf16_f32 v217, v58, v59
    v_cvt_pk_bf16_f32 v218, v60, v61
    v_cvt_pk_bf16_f32 v219, v62, v63
    s_mov_b32 s39, 393216
    buffer_store_dwordx4 v[216:219], v194, s[12:15], s39 offen offset:1024
    v_cvt_pk_bf16_f32 v204, v64, v65
    v_cvt_pk_bf16_f32 v205, v66, v67
    v_cvt_pk_bf16_f32 v206, v68, v69
    v_cvt_pk_bf16_f32 v207, v70, v71
    s_mov_b32 s39, 524288
    buffer_store_dwordx4 v[204:207], v194, s[12:15], s39 offen offset:0
    v_cvt_pk_bf16_f32 v208, v72, v73
    v_cvt_pk_bf16_f32 v209, v74, v75
    v_cvt_pk_bf16_f32 v210, v76, v77
    v_cvt_pk_bf16_f32 v211, v78, v79
    s_mov_b32 s39, 655360
    buffer_store_dwordx4 v[208:211], v194, s[12:15], s39 offen offset:0
    v_cvt_pk_bf16_f32 v212, v80, v81
    v_cvt_pk_bf16_f32 v213, v82, v83
    v_cvt_pk_bf16_f32 v214, v84, v85
    v_cvt_pk_bf16_f32 v215, v86, v87
    s_mov_b32 s39, 524288
    buffer_store_dwordx4 v[212:215], v194, s[12:15], s39 offen offset:1024
    v_cvt_pk_bf16_f32 v216, v88, v89
    v_cvt_pk_bf16_f32 v217, v90, v91
    v_cvt_pk_bf16_f32 v218, v92, v93
    v_cvt_pk_bf16_f32 v219, v94, v95
    s_mov_b32 s39, 655360
    buffer_store_dwordx4 v[216:219], v194, s[12:15], s39 offen offset:1024
    v_cvt_pk_bf16_f32 v204, v96, v97
    v_cvt_pk_bf16_f32 v205, v98, v99
    v_cvt_pk_bf16_f32 v206, v100, v101
    v_cvt_pk_bf16_f32 v207, v102, v103
    s_mov_b32 s39, 786432
    buffer_store_dwordx4 v[204:207], v194, s[12:15], s39 offen offset:0
    v_cvt_pk_bf16_f32 v208, v104, v105
    v_cvt_pk_bf16_f32 v209, v106, v107
    v_cvt_pk_bf16_f32 v210, v108, v109
    v_cvt_pk_bf16_f32 v211, v110, v111
    s_mov_b32 s39, 917504
    buffer_store_dwordx4 v[208:211], v194, s[12:15], s39 offen offset:0
    v_cvt_pk_bf16_f32 v212, v112, v113
    v_cvt_pk_bf16_f32 v213, v114, v115
    v_cvt_pk_bf16_f32 v214, v116, v117
    v_cvt_pk_bf16_f32 v215, v118, v119
    s_mov_b32 s39, 786432
    buffer_store_dwordx4 v[212:215], v194, s[12:15], s39 offen offset:1024
    v_cvt_pk_bf16_f32 v216, v120, v121
    v_cvt_pk_bf16_f32 v217, v122, v123
    v_cvt_pk_bf16_f32 v218, v124, v125
    v_cvt_pk_bf16_f32 v219, v126, v127
    s_mov_b32 s39, 917504
    buffer_store_dwordx4 v[216:219], v194, s[12:15], s39 offen offset:1024
G1_done_3:
    s_endpgm
.globl attn_kernel
.type attn_kernel,@function
.p2align 8
attn_kernel:
    s_load_dwordx2 s[40:41], s[0:1], 104
    s_cmp_ge_u32 s2, 256
    s_cbranch_scc1 A_done_47
    v_mov_b32 v243, v0
    s_mov_b32 s60, 0
    s_waitcnt lgkmcnt(0)
A_pass_48:
    s_and_b32 s21, s2, 7
    s_lshr_b32 s20, s2, 3
    s_and_b32 s22, s20, 3
    s_lshl_b32 s21, s21, 2
    s_add_u32 s22, s22, s21
    s_lshr_b32 s23, s20, 2
    s_sub_u32 s24, 15, s23
    s_cmp_eq_u32 s60, 0
    s_cselect_b32 s23, s24, s23
    s_add_u32 s4, s40, 0x1000000
    s_addc_u32 s5, s41, 0
    s_and_b32 s5, s5, 0xffff
    s_mov_b32 s6, 0x1000000
    s_mov_b32 s7, 0x00020000
    s_add_u32 s8, s40, 0x2000000
    s_addc_u32 s9, s41, 0
    s_and_b32 s9, s9, 0xffff
    s_mov_b32 s10, 0x1000000
    s_mov_b32 s11, 0x00020000
    s_add_u32 s12, s40, 0x3000000
    s_addc_u32 s13, s41, 0
    s_and_b32 s13, s13, 0xffff
    s_mov_b32 s14, 0x1000000
    s_mov_b32 s15, 0x00020000
    s_add_u32 s16, s40, 0x5000000
    s_addc_u32 s17, s41, 0
    s_and_b32 s17, s17, 0xffff
    s_mov_b32 s18, 0x1000000
    s_mov_b32 s19, 0x00020000
    v_and_b32 v176, 63, v243
    v_lshrrev_b32 v177, 6, v243
    s_nop 0
    v_readfirstlane_b32 s25, v177
    s_lshr_b32 s66, s25, 2
    s_and_b32 s25, s25, 3
    v_and_b32 v178, 31, v176
    v_lshrrev_b32 v180, 5, v176
    v_bfe_u32 v181, v176, 3, 1
    v_xor_b32 v181, v181, v180
    v_lshlrev_b32 v181, 4, v181
    v_lshl_add_u32 v240, v178, 5, v181
    s_lshl_b32 s26, s23, 7
    s_lshl_b32 s27, s25, 5
    s_add_u32 s26, s26, s27
    s_lshl_b32 s27, s22, 14
    s_add_u32 s27, s27, s26
    s_lshl_b32 s39, s27, 5
    v_add_u32 v185, s39, v240
    s_mov_b32 s28, 0
    buffer_load_dwordx4 v[128:131], v185, s[4:7], s28 offen
    s_mov_b32 s28, 65536
    buffer_load_dwordx4 v[132:135], v185, s[4:7], s28 offen
    s_mov_b32 s28, 131072
    buffer_load_dwordx4 v[136:139], v185, s[4:7], s28 offen
    s_mov_b32 s28, 196608
    buffer_load_dwordx4 v[140:143], v185, s[4:7], s28 offen
    s_mov_b32 s28, 262144
    buffer_load_dwordx4 v[144:147], v185, s[4:7], s28 offen
    s_mov_b32 s28, 327680
    buffer_load_dwordx4 v[148:151], v185, s[4:7], s28 offen
    s_mov_b32 s28, 393216
    buffer_load_dwordx4 v[152:155], v185, s[4:7], s28 offen
    s_mov_b32 s28, 458752
    buffer_load_dwordx4 v[156:159], v185, s[4:7], s28 offen
    s_lshl_b32 s27, s25, 5
    v_add_u32 v251, s27, v178
    v_lshlrev_b32 v181, 2, v180
    v_sub_u32 v251, v251, v181
    v_lshlrev_b32 v181, 4, v176
    s_lshl_b32 s27, s22, 3
    s_lshl_b32 s28, s25, 1
    s_add_u32 s27, s27, s28
    s_add_u32 s27, s27, 0
    s_lshl_b32 s27, s27, 16
    v_add_u32 v244, s27, v181
    s_lshl_b32 s27, s22, 3
    s_lshl_b32 s28, s25, 1
    s_add_u32 s27, s27, s28
    s_add_u32 s27, s27, 1
    s_lshl_b32 s27, s27, 16
    v_add_u32 v245, s27, v181
    s_lshl_b32 s27, s25, 12
    s_lshl_b32 s28, s22, 7
    s_add_u32 s27, s27, s28
    s_lshl_b32 s27, s27, 5
    v_add_u32 v246, s27, v181
    v_mov_b32 v0, 0
    v_mov_b32 v1, 0
    v_mov_b32 v2, 0
    v_mov_b32 v3, 0
    v_mov_b32 v4, 0
    v_mov_b32 v5, 0
    v_mov_b32 v6, 0
    v_mov_b32 v7, 0
    v_mov_b32 v8, 0
    v_mov_b32 v9, 0
    v_mov_b32 v10, 0
    v_mov_b32 v11, 0
    v_mov_b32 v12, 0
    v_mov_b32 v13, 0
    v_mov_b32 v14, 0
    v_mov_b32 v15, 0
    v_mov_b32 v16, 0
    v_mov_b32 v17, 0
    v_mov_b32 v18, 0
    v_mov_b32 v19, 0
    v_mov_b32 v20, 0
    v_mov_b32 v21, 0
    v_mov_b32 v22, 0
    v_mov_b32 v23, 0
    v_mov_b32 v24, 0
    v_mov_b32 v25, 0
    v_mov_b32 v26, 0
    v_mov_b32 v27, 0
    v_mov_b32 v28, 0
    v_mov_b32 v29, 0
    v_mov_b32 v30, 0
    v_mov_b32 v31, 0
    v_mov_b32 v32, 0
    v_mov_b32 v33, 0
    v_mov_b32 v34, 0
    v_mov_b32 v35, 0
    v_mov_b32 v36, 0
    v_mov_b32 v37, 0
    v_mov_b32 v38, 0
    v_mov_b32 v39, 0
    v_mov_b32 v40, 0
    v_mov_b32 v41, 0
    v_mov_b32 v42, 0
    v_mov_b32 v43, 0
    v_mov_b32 v44, 0
    v_mov_b32 v45, 0
    v_mov_b32 v46, 0
    v_mov_b32 v47, 0
    v_mov_b32 v48, 0
    v_mov_b32 v49, 0
    v_mov_b32 v50, 0
    v_mov_b32 v51, 0
    v_mov_b32 v52, 0
    v_mov_b32 v53, 0
    v_mov_b32 v54, 0
    v_mov_b32 v55, 0
    v_mov_b32 v56, 0
    v_mov_b32 v57, 0
    v_mov_b32 v58, 0
    v_mov_b32 v59, 0
    v_mov_b32 v60, 0
    v_mov_b32 v61, 0
    v_mov_b32 v62, 0
    v_mov_b32 v63, 0
    v_mov_b32 v248, 0xf149f2ca
    v_mov_b32 v249, 0
    v_mov_b32 v250, 0
    s_mov_b32 s30, 0x3e0293ee
    s_mov_b32 s29, 0x42faf233
    s_lshl_b32 s31, s25, 12
    s_lshl_b32 s67, s66, 14
    s_add_u32 s31, s31, s67
    s_lshl_b32 s32, s66, 11
    s_lshl_b32 s33, s66, 19
    s_lshl_b32 s37, s66, 6
    s_add_u32 s36, s23, 1
    s_add_u32 m0, s31, 0
    s_nop 0
    buffer_load_dwordx4 v244, s[8:11], s32 offen lds
    buffer_load_dwordx4 v244, s[8:11], s32 offen offset:1024 lds
    s_add_u32 m0, s31, 2048
    s_nop 0
    buffer_load_dwordx4 v245, s[8:11], s32 offen lds
    buffer_load_dwordx4 v245, s[8:11], s32 offen offset:1024 lds
    s_add_u32 s32, s32, 4096
    s_add_u32 m0, s31, 65536
    s_nop 0
    buffer_load_dwordx4 v246, s[12:15], s33 offen lds
    buffer_load_dwordx4 v246, s[12:15], s33 offen offset:1024 lds
    buffer_load_dwordx4 v246, s[12:15], s33 offen offset:2048 lds
    buffer_load_dwordx4 v246, s[12:15], s33 offen offset:3072 lds
    s_add_u32 s33, s33, 1048576
    s_add_u32 m0, s31, 32768
    s_nop 0
    buffer_load_dwordx4 v244, s[8:11], s32 offen lds
    buffer_load_dwordx4 v244, s[8:11], s32 offen offset:1024 lds
    s_add_u32 m0, s31, 34816
    s_nop 0
    buffer_load_dwordx4 v245, s[8:11], s32 offen lds
    buffer_load_dwordx4 v245, s[8:11], s32 offen offset:1024 lds
    s_add_u32 s32, s32, 4096
    s_waitcnt vmcnt(8)
    s_barrier
    v_add_u32 v241, s67, v240
    ds_read_b128 v[176:179], v241 offset:0
    ds_read_b128 v[180:183], v241 offset:2048
    ds_read_b128 v[184:187], v241 offset:4096
    ds_read_b128 v[188:191], v241 offset:6144
    ds_read_b128 v[192:195], v241 offset:8192
    ds_read_b128 v[196:199], v241 offset:10240
    ds_read_b128 v[200:203], v241 offset:12288
    ds_read_b128 v[204:207], v241 offset:14336
    ds_read_b128 v[208:211], v241 offset:1024
    ds_read_b128 v[212:215], v241 offset:3072
    ds_read_b128 v[216:219], v241 offset:5120
    ds_read_b128 v[220:223], v241 offset:7168
    ds_read_b128 v[224:227], v241 offset:9216
    ds_read_b128 v[228:231], v241 offset:11264
    ds_read_b128 v[232:235], v241 offset:13312
    ds_read_b128 v[236:239], v241 offset:15360
    s_waitcnt lgkmcnt(0)
    v_mfma_f32_32x32x16_bf16 v[64:79], v[176:179], v[128:131], 0
    v_mfma_f32_32x32x16_bf16 v[64:79], v[180:183], v[132:135], v[64:79]
    v_mfma_f32_32x32x16_bf16 v[64:79], v[184:187], v[136:139], v[64:79]
    v_mfma_f32_32x32x16_bf16 v[64:79], v[188:191], v[140:143], v[64:79]
    v_mfma_f32_32x32x16_bf16 v[64:79], v[192:195], v[144:147], v[64:79]
    v_mfma_f32_32x32x16_bf16 v[64:79], v[196:199], v[148:151], v[64:79]
    v_mfma_f32_32x32x16_bf16 v[64:79], v[200:203], v[152:155], v[64:79]
    v_mfma_f32_32x32x16_bf16 v[64:79], v[204:207], v[156:159], v[64:79]
    v_mfma_f32_32x32x16_bf16 v[80:95], v[208:211], v[128:131], 0
    v_mfma_f32_32x32x16_bf16 v[80:95], v[212:215], v[132:135], v[80:95]
    v_mfma_f32_32x32x16_bf16 v[80:95], v[216:219], v[136:139], v[80:95]
    v_mfma_f32_32x32x16_bf16 v[80:95], v[220:223], v[140:143], v[80:95]
    v_mfma_f32_32x32x16_bf16 v[80:95], v[224:227], v[144:147], v[80:95]
    v_mfma_f32_32x32x16_bf16 v[80:95], v[228:231], v[148:151], v[80:95]
    v_mfma_f32_32x32x16_bf16 v[80:95], v[232:235], v[152:155], v[80:95]
    v_mfma_f32_32x32x16_bf16 v[80:95], v[236:239], v[156:159], v[80:95]
    s_nop 15
    s_nop 7
    s_cmp_eq_u32 s23, 0
    s_cbranch_scc1 A_pm_49
    v_max3_f32 v252, v64, v65, v66
    v_max3_f32 v252, v252, v67, v68
    v_max3_f32 v252, v252, v69, v70
    v_max3_f32 v252, v252, v71, v72
    v_max3_f32 v252, v252, v73, v74
    v_max3_f32 v252, v252, v75, v76
    v_max3_f32 v252, v252, v77, v78
    v_max3_f32 v252, v252, v79, v80
    v_max3_f32 v252, v252, v81, v82
    v_max3_f32 v252, v252, v83, v84
    v_max3_f32 v252, v252, v85, v86
    v_max3_f32 v252, v252, v87, v88
    v_max3_f32 v252, v252, v89, v90
    v_max3_f32 v252, v252, v91, v92
    v_max3_f32 v252, v252, v93, v94
    v_max_f32 v252, v252, v95
    v_mov_b32 v253, v252
    s_nop 1
    v_permlane32_swap_b32 v253, v252
    v_max_f32 v252, v252, v253
    v_sub_f32 v253, v252, v248
    v_cmp_lt_f32 vcc, s29, v253
    s_branch A_pe_50
A_pm_49:
    v_subrev_u32 v252, s37, v251
    v_mov_b32 v253, 0xff800000
    v_cmp_gt_i32 vcc, 0, v252
    s_nop 1
    v_cndmask_b32 v64, v64, v253, vcc
    v_cmp_gt_i32 vcc, 1, v252
    s_nop 1
    v_cndmask_b32 v65, v65, v253, vcc
    v_cmp_gt_i32 vcc, 2, v252
    s_nop 1
    v_cndmask_b32 v66, v66, v253, vcc
    v_cmp_gt_i32 vcc, 3, v252
    s_nop 1
    v_cndmask_b32 v67, v67, v253, vcc
    v_cmp_gt_i32 vcc, 8, v252
    s_nop 1
    v_cndmask_b32 v68, v68, v253, vcc
    v_cmp_gt_i32 vcc, 9, v252
    s_nop 1
    v_cndmask_b32 v69, v69, v253, vcc
    v_cmp_gt_i32 vcc, 10, v252
    s_nop 1
    v_cndmask_b32 v70, v70, v253, vcc
    v_cmp_gt_i32 vcc, 11, v252
    s_nop 1
    v_cndmask_b32 v71, v71, v253, vcc
    v_cmp_gt_i32 vcc, 16, v252
    s_nop 1
    v_cndmask_b32 v72, v72, v253, vcc
    v_cmp_gt_i32 vcc, 17, v252
    s_nop 1
    v_cndmask_b32 v73, v73, v253, vcc
    v_cmp_gt_i32 vcc, 18, v252
    s_nop 1
    v_cndmask_b32 v74, v74, v253, vcc
    v_cmp_gt_i32 vcc, 19, v252
    s_nop 1
    v_cndmask_b32 v75, v75, v253, vcc
    v_cmp_gt_i32 vcc, 24, v252
    s_nop 1
    v_cndmask_b32 v76, v76, v253, vcc
    v_cmp_gt_i32 vcc, 25, v252
    s_nop 1
    v_cndmask_b32 v77, v77, v253, vcc
    v_cmp_gt_i32 vcc, 26, v252
    s_nop 1
    v_cndmask_b32 v78, v78, v253, vcc
    v_cmp_gt_i32 vcc, 27, v252
    s_nop 1
    v_cndmask_b32 v79, v79, v253, vcc
    v_cmp_gt_i32 vcc, 32, v252
    s_nop 1
    v_cndmask_b32 v80, v80, v253, vcc
    v_cmp_gt_i32 vcc, 33, v252
    s_nop 1
    v_cndmask_b32 v81, v81, v253, vcc
    v_cmp_gt_i32 vcc, 34, v252
    s_nop 1
    v_cndmask_b32 v82, v82, v253, vcc
    v_cmp_gt_i32 vcc, 35, v252
    s_nop 1
    v_cndmask_b32 v83, v83, v253, vcc
    v_cmp_gt_i32 vcc, 40, v252
    s_nop 1
    v_cndmask_b32 v84, v84, v253, vcc
    v_cmp_gt_i32 vcc, 41, v252
    s_nop 1
    v_cndmask_b32 v85, v85, v253, vcc
    v_cmp_gt_i32 vcc, 42, v252
    s_nop 1
    v_cndmask_b32 v86, v86, v253, vcc
    v_cmp_gt_i32 vcc, 43, v252
    s_nop 1
    v_cndmask_b32 v87, v87, v253, vcc
    v_cmp_gt_i32 vcc, 48, v252
    s_nop 1
    v_cndmask_b32 v88, v88, v253, vcc
    v_cmp_gt_i32 vcc, 49, v252
    s_nop 1
    v_cndmask_b32 v89, v89, v253, vcc
    v_cmp_gt_i32 vcc, 50, v252
    s_nop 1
    v_cndmask_b32 v90, v90, v253, vcc
    v_cmp_gt_i32 vcc, 51, v252
    s_nop 1
    v_cndmask_b32 v91, v91, v253, vcc
    v_cmp_gt_i32 vcc, 56, v252
    s_nop 1
    v_cndmask_b32 v92, v92, v253, vcc
    v_cmp_gt_i32 vcc, 57, v252
    s_nop 1
    v_cndmask_b32 v93, v93, v253, vcc
    v_cmp_gt_i32 vcc, 58, v252
    s_nop 1
    v_cndmask_b32 v94, v94, v253, vcc
    v_cmp_gt_i32 vcc, 59, v252
    s_nop 1
    v_cndmask_b32 v95, v95, v253, vcc
    v_max3_f32 v252, v64, v65, v66
    v_max3_f32 v252, v252, v67, v68
    v_max3_f32 v252, v252, v69, v70
    v_max3_f32 v252, v252, v71, v72
    v_max3_f32 v252, v252, v73, v74
    v_max3_f32 v252, v252, v75, v76
    v_max3_f32 v252, v252, v77, v78
    v_max3_f32 v252, v252, v79, v80
    v_max3_f32 v252, v252, v81, v82
    v_max3_f32 v252, v252, v83, v84
    v_max3_f32 v252, v252, v85, v86
    v_max3_f32 v252, v252, v87, v88
    v_max3_f32 v252, v252, v89, v90
    v_max3_f32 v252, v252, v91, v92
    v_max3_f32 v252, v252, v93, v94
    v_max_f32 v252, v252, v95
    v_mov_b32 v253, v252
    s_nop 1
    v_permlane32_swap_b32 v253, v252
    v_max_f32 v252, v252, v253
    v_sub_f32 v253, v252, v248
    v_cmp_lt_f32 vcc, s29, v253
A_pe_50:
    s_nop 0
    s_cbranch_vccz A_nors_51
    s_nop 15
    s_nop 15
    v_max_f32 v252, v252, v248
    v_sub_f32 v253, v248, v252
    v_mul_f32 v253, s30, v253
    v_exp_f32 v253, v253
    v_mov_b32 v248, v252
    v_mul_f32 v250, s30, v252
    v_mul_f32 v249, v249, v253
    v_mul_f32 v0, v0, v253
    v_mul_f32 v1, v1, v253
    v_mul_f32 v2, v2, v253
    v_mul_f32 v3, v3, v253
    v_mul_f32 v4, v4, v253
    v_mul_f32 v5, v5, v253
    v_mul_f32 v6, v6, v253
    v_mul_f32 v7, v7, v253
    v_mul_f32 v8, v8, v253
    v_mul_f32 v9, v9, v253
    v_mul_f32 v10, v10, v253
    v_mul_f32 v11, v11, v253
    v_mul_f32 v12, v12, v253
    v_mul_f32 v13, v13, v253
    v_mul_f32 v14, v14, v253
    v_mul_f32 v15, v15, v253
    v_mul_f32 v16, v16, v253
    v_mul_f32 v17, v17, v253
    v_mul_f32 v18, v18, v253
    v_mul_f32 v19, v19, v253
    v_mul_f32 v20, v20, v253
    v_mul_f32 v21, v21, v253
    v_mul_f32 v22, v22, v253
    v_mul_f32 v23, v23, v253
    v_mul_f32 v24, v24, v253
    v_mul_f32 v25, v25, v253
    v_mul_f32 v26, v26, v253
    v_mul_f32 v27, v27, v253
    v_mul_f32 v28, v28, v253
    v_mul_f32 v29, v29, v253
    v_mul_f32 v30, v30, v253
    v_mul_f32 v31, v31, v253
    v_mul_f32 v32, v32, v253
    v_mul_f32 v33, v33, v253
    v_mul_f32 v34, v34, v253
    v_mul_f32 v35, v35, v253
    v_mul_f32 v36, v36, v253
    v_mul_f32 v37, v37, v253
    v_mul_f32 v38, v38, v253
    v_mul_f32 v39, v39, v253
    v_mul_f32 v40, v40, v253
    v_mul_f32 v41, v41, v253
    v_mul_f32 v42, v42, v253
    v_mul_f32 v43, v43, v253
    v_mul_f32 v44, v44, v253
    v_mul_f32 v45, v45, v253
    v_mul_f32 v46, v46, v253
    v_mul_f32 v47, v47, v253
    v_mul_f32 v48, v48, v253
    v_mul_f32 v49, v49, v253
    v_mul_f32 v50, v50, v253
    v_mul_f32 v51, v51, v253
    v_mul_f32 v52, v52, v253
    v_mul_f32 v53, v53, v253
    v_mul_f32 v54, v54, v253
    v_mul_f32 v55, v55, v253
    v_mul_f32 v56, v56, v253
    v_mul_f32 v57, v57, v253
    v_mul_f32 v58, v58, v253
    v_mul_f32 v59, v59, v253
    v_mul_f32 v60, v60, v253
    v_mul_f32 v61, v61, v253
    v_mul_f32 v62, v62, v253
    v_mul_f32 v63, v63, v253
    s_nop 1
A_nors_51:
    s_mov_b32 s35, 0
A_loop_52:
    s_waitcnt vmcnt(0)
    s_barrier
    s_add_u32 s65, s67, 32768
    v_add_u32 v241, s65, v240
    s_add_u32 s65, s67, 65536
    v_add_u32 v242, s65, v240
    s_add_u32 s38, s35, 1
    s_cmp_ge_u32 s38, s36
    s_cbranch_scc1 A_last_54
    s_cmp_ge_u32 s38, s23
    s_cbranch_scc1 A_msk_55
    ds_read_b128 v[176:179], v241 offset:0
    ds_read_b128 v[180:183], v241 offset:2048
    ds_read_b128 v[184:187], v241 offset:4096
    ds_read_b128 v[188:191], v241 offset:6144
    ds_read_b128 v[192:195], v241 offset:8192
    ds_read_b128 v[196:199], v241 offset:10240
    ds_read_b128 v[200:203], v241 offset:12288
    ds_read_b128 v[204:207], v241 offset:14336
    ds_read_b128 v[208:211], v241 offset:1024
    ds_read_b128 v[212:215], v241 offset:3072
    ds_read_b128 v[216:219], v241 offset:5120
    ds_read_b128 v[220:223], v241 offset:7168
    ds_read_b128 v[224:227], v241 offset:9216
    ds_read_b128 v[228:231], v241 offset:11264
    ds_read_b128 v[232:235], v241 offset:13312
    ds_read_b128 v[236:239], v241 offset:15360
    v_fma_f32 v64, v64, s30, -v250
    v_fma_f32 v65, v65, s30, -v250
    v_fma_f32 v66, v66, s30, -v250
    v_exp_f32 v64, v64
    v_fma_f32 v67, v67, s30, -v250
    v_exp_f32 v65, v65
    v_fma_f32 v68, v68, s30, -v250
    v_exp_f32 v66, v66
    v_fma_f32 v69, v69, s30, -v250
    v_exp_f32 v67, v67
    s_waitcnt lgkmcnt(8)
    v_mfma_f32_32x32x16_bf16 v[96:111], v[176:179], v[128:131], 0
    v_cvt_pk_bf16_f32 v160, v64, v65
    v_fma_f32 v70, v70, s30, -v250
    v_exp_f32 v68, v68
    v_mfma_f32_32x32x16_bf16 v[96:111], v[180:183], v[132:135], v[96:111]
    v_fma_f32 v71, v71, s30, -v250
    v_exp_f32 v69, v69
    v_cvt_pk_bf16_f32 v161, v66, v67
    v_mfma_f32_32x32x16_bf16 v[96:111], v[184:187], v[136:139], v[96:111]
    v_fma_f32 v72, v72, s30, -v250
    v_exp_f32 v70, v70
    v_fma_f32 v73, v73, s30, -v250
    v_mfma_f32_32x32x16_bf16 v[96:111], v[188:191], v[140:143], v[96:111]
    v_exp_f32 v71, v71
    v_cvt_pk_bf16_f32 v162, v68, v69
    v_mfma_f32_32x32x16_bf16 v[96:111], v[192:195], v[144:147], v[96:111]
    v_fma_f32 v74, v74, s30, -v250
    v_exp_f32 v72, v72
    v_fma_f32 v75, v75, s30, -v250
    v_mfma_f32_32x32x16_bf16 v[96:111], v[196:199], v[148:151], v[96:111]
    v_exp_f32 v73, v73
    s_add_u32 m0, s31, 98304
    s_nop 0
    v_mfma_f32_32x32x16_bf16 v[96:111], v[200:203], v[152:155], v[96:111]
    buffer_load_dwordx4 v246, s[12:15], s33 offen lds
    buffer_load_dwordx4 v246, s[12:15], s33 offen offset:1024 lds
    buffer_load_dwordx4 v246, s[12:15], s33 offen offset:2048 lds
    v_mfma_f32_32x32x16_bf16 v[96:111], v[204:207], v[156:159], v[96:111]
    buffer_load_dwordx4 v246, s[12:15], s33 offen offset:3072 lds
    s_add_u32 s33, s33, 1048576
    s_waitcnt lgkmcnt(0)
    v_mfma_f32_32x32x16_bf16 v[112:127], v[208:211], v[128:131], 0
    ds_read_b128 v[176:179], v242 offset:0
    ds_read_b128 v[180:183], v242 offset:1024
    ds_read_b128 v[184:187], v242 offset:2048
    v_mfma_f32_32x32x16_bf16 v[112:127], v[212:215], v[132:135], v[112:127]
    ds_read_b128 v[188:191], v242 offset:3072
    ds_read_b128 v[192:195], v242 offset:4096
    ds_read_b128 v[196:199], v242 offset:5120
    v_mfma_f32_32x32x16_bf16 v[112:127], v[216:219], v[136:139], v[112:127]
    ds_read_b128 v[200:203], v242 offset:6144
    ds_read_b128 v[204:207], v242 offset:7168
    v_cvt_pk_bf16_f32 v163, v70, v71
    v_mfma_f32_32x32x16_bf16 v[112:127], v[220:223], v[140:143], v[112:127]
    v_fma_f32 v76, v76, s30, -v250
    v_exp_f32 v74, v74
    v_fma_f32 v77, v77, s30, -v250
    v_mfma_f32_32x32x16_bf16 v[112:127], v[224:227], v[144:147], v[112:127]
    v_exp_f32 v75, v75
    v_cvt_pk_bf16_f32 v164, v72, v73
    v_fma_f32 v78, v78, s30, -v250
    v_mfma_f32_32x32x16_bf16 v[112:127], v[228:231], v[148:151], v[112:127]
    v_exp_f32 v76, v76
    v_fma_f32 v79, v79, s30, -v250
    v_exp_f32 v77, v77
    v_mfma_f32_32x32x16_bf16 v[112:127], v[232:235], v[152:155], v[112:127]
    v_cvt_pk_bf16_f32 v165, v74, v75
    v_exp_f32 v78, v78
    v_exp_f32 v79, v79
    v_mfma_f32_32x32x16_bf16 v[112:127], v[236:239], v[156:159], v[112:127]
    v_cvt_pk_bf16_f32 v166, v76, v77
    v_cvt_pk_bf16_f32 v167, v78, v79
    s_waitcnt lgkmcnt(0)
    s_nop 1
    v_mfma_f32_32x32x16_bf16 v[0:15], v[176:179], v[160:163], v[0:15]
    ds_read_b128 v[208:211], v242 offset:8192
    ds_read_b128 v[212:215], v242 offset:9216
    ds_read_b128 v[216:219], v242 offset:10240
    ds_read_b128 v[220:223], v242 offset:11264
    ds_read_b128 v[224:227], v242 offset:12288
    ds_read_b128 v[228:231], v242 offset:13312
    v_mfma_f32_32x32x16_bf16 v[16:31], v[180:183], v[160:163], v[16:31]
    ds_read_b128 v[232:235], v242 offset:14336
    ds_read_b128 v[236:239], v242 offset:15360
    v_fma_f32 v80, v80, s30, -v250
    v_fma_f32 v81, v81, s30, -v250
    v_fma_f32 v82, v82, s30, -v250
    v_exp_f32 v80, v80
    v_mfma_f32_32x32x16_bf16 v[32:47], v[184:187], v[160:163], v[32:47]
    v_fma_f32 v83, v83, s30, -v250
    v_exp_f32 v81, v81
    v_fma_f32 v84, v84, s30, -v250
    v_exp_f32 v82, v82
    v_fma_f32 v85, v85, s30, -v250
    v_exp_f32 v83, v83
    v_mfma_f32_32x32x16_bf16 v[48:63], v[188:191], v[160:163], v[48:63]
    v_cvt_pk_bf16_f32 v168, v80, v81
    v_fma_f32 v86, v86, s30, -v250
    v_exp_f32 v84, v84
    v_fma_f32 v87, v87, s30, -v250
    v_exp_f32 v85, v85
    v_cvt_pk_bf16_f32 v169, v82, v83
    v_mfma_f32_32x32x16_bf16 v[0:15], v[192:195], v[164:167], v[0:15]
    v_fma_f32 v88, v88, s30, -v250
    v_exp_f32 v86, v86
    v_fma_f32 v89, v89, s30, -v250
    v_exp_f32 v87, v87
    v_cvt_pk_bf16_f32 v170, v84, v85
    v_fma_f32 v90, v90, s30, -v250
    v_mfma_f32_32x32x16_bf16 v[16:31], v[196:199], v[164:167], v[16:31]
    v_exp_f32 v88, v88
    v_fma_f32 v91, v91, s30, -v250
    v_exp_f32 v89, v89
    v_cvt_pk_bf16_f32 v171, v86, v87
    v_fma_f32 v92, v92, s30, -v250
    v_exp_f32 v90, v90
    v_mfma_f32_32x32x16_bf16 v[32:47], v[200:203], v[164:167], v[32:47]
    v_fma_f32 v93, v93, s30, -v250
    v_exp_f32 v91, v91
    v_cvt_pk_bf16_f32 v172, v88, v89
    v_fma_f32 v94, v94, s30, -v250
    v_exp_f32 v92, v92
    v_fma_f32 v95, v95, s30, -v250
    v_mfma_f32_32x32x16_bf16 v[48:63], v[204:207], v[164:167], v[48:63]
    v_exp_f32 v93, v93
    v_cvt_pk_bf16_f32 v173, v90, v91
    v_exp_f32 v94, v94
    v_exp_f32 v95, v95
    v_cvt_pk_bf16_f32 v174, v92, v93
    v_cvt_pk_bf16_f32 v175, v94, v95
    s_waitcnt lgkmcnt(0)
    s_nop 1
    v_mfma_f32_32x32x16_bf16 v[0:15], v[208:211], v[168:171], v[0:15]
    s_add_u32 m0, s31, 0
    s_nop 0
    buffer_load_dwordx4 v244, s[8:11], s32 offen lds
    buffer_load_dwordx4 v244, s[8:11], s32 offen offset:1024 lds
    s_add_u32 m0, s31, 2048
    s_nop 0
    buffer_load_dwordx4 v245, s[8:11], s32 offen lds
    buffer_load_dwordx4 v245, s[8:11], s32 offen offset:1024 lds
    v_mfma_f32_32x32x16_bf16 v[16:31], v[212:215], v[168:171], v[16:31]
    s_add_u32 s32, s32, 4096
    v_add_f32 v252, v64, v65
    v_add_f32 v252, v252, v66
    v_add_f32 v252, v252, v67
    v_add_f32 v252, v252, v68
    v_add_f32 v252, v252, v69
    v_add_f32 v252, v252, v70
    v_add_f32 v252, v252, v71
    v_mfma_f32_32x32x16_bf16 v[32:47], v[216:219], v[168:171], v[32:47]
    v_add_f32 v252, v252, v72
    v_add_f32 v252, v252, v73
    v_add_f32 v252, v252, v74
    v_add_f32 v252, v252, v75
    v_add_f32 v252, v252, v76
    v_add_f32 v252, v252, v77
    v_add_f32 v252, v252, v78
    v_add_f32 v252, v252, v79
    v_mfma_f32_32x32x16_bf16 v[48:63], v[220:223], v[168:171], v[48:63]
    v_add_f32 v252, v252, v80
    v_add_f32 v252, v252, v81
    v_add_f32 v252, v252, v82
    v_add_f32 v252, v252, v83
    v_add_f32 v252, v252, v84
    v_add_f32 v252, v252, v85
    v_add_f32 v252, v252, v86
    v_add_f32 v252, v252, v87
    v_mfma_f32_32x32x16_bf16 v[0:15], v[224:227], v[172:175], v[0:15]
    v_add_f32 v252, v252, v88
    v_add_f32 v252, v252, v89
    v_add_f32 v252, v252, v90
    v_add_f32 v252, v252, v91
    v_add_f32 v252, v252, v92
    v_add_f32 v252, v252, v93
    v_add_f32 v252, v252, v94
    v_add_f32 v252, v252, v95
    v_mfma_f32_32x32x16_bf16 v[16:31], v[228:231], v[172:175], v[16:31]
    v_add_f32 v249, v249, v252
    v_max3_f32 v252, v96, v97, v98
    v_max3_f32 v252, v252, v99, v100
    v_max3_f32 v252, v252, v101, v102
    v_max3_f32 v252, v252, v103, v104
    v_max3_f32 v252, v252, v105, v106
    v_max3_f32 v252, v252, v107, v108
    v_max3_f32 v252, v252, v109, v110
    v_mfma_f32_32x32x16_bf16 v[32:47], v[232:235], v[172:175], v[32:47]
    v_max3_f32 v252, v252, v111, v112
    v_max3_f32 v252, v252, v113, v114
    v_max3_f32 v252, v252, v115, v116
    v_max3_f32 v252, v252, v117, v118
    v_max3_f32 v252, v252, v119, v120
    v_max3_f32 v252, v252, v121, v122
    v_max3_f32 v252, v252, v123, v124
    v_max3_f32 v252, v252, v125, v126
    v_mfma_f32_32x32x16_bf16 v[48:63], v[236:239], v[172:175], v[48:63]
    v_max_f32 v252, v252, v127
    v_mov_b32 v253, v252
    s_nop 1
    v_permlane32_swap_b32 v253, v252
    v_max_f32 v252, v252, v253
    v_sub_f32 v253, v252, v248
    v_cmp_lt_f32 vcc, s29, v253
    s_nop 0
    s_cbranch_vccz A_nors_57
    s_nop 15
    s_nop 15
    v_max_f32 v252, v252, v248
    v_sub_f32 v253, v248, v252
    v_mul_f32 v253, s30, v253
    v_exp_f32 v253, v253
    v_mov_b32 v248, v252
    v_mul_f32 v250, s30, v252
    v_mul_f32 v249, v249, v253
    v_mul_f32 v0, v0, v253
    v_mul_f32 v1, v1, v253
    v_mul_f32 v2, v2, v253
    v_mul_f32 v3, v3, v253
    v_mul_f32 v4, v4, v253
    v_mul_f32 v5, v5, v253
    v_mul_f32 v6, v6, v253
    v_mul_f32 v7, v7, v253
    v_mul_f32 v8, v8, v253
    v_mul_f32 v9, v9, v253
    v_mul_f32 v10, v10, v253
    v_mul_f32 v11, v11, v253
    v_mul_f32 v12, v12, v253
    v_mul_f32 v13, v13, v253
    v_mul_f32 v14, v14, v253
    v_mul_f32 v15, v15, v253
    v_mul_f32 v16, v16, v253
    v_mul_f32 v17, v17, v253
    v_mul_f32 v18, v18, v253
    v_mul_f32 v19, v19, v253
    v_mul_f32 v20, v20, v253
    v_mul_f32 v21, v21, v253
    v_mul_f32 v22, v22, v253
    v_mul_f32 v23, v23, v253
    v_mul_f32 v24, v24, v253
    v_mul_f32 v25, v25, v253
    v_mul_f32 v26, v26, v253
    v_mul_f32 v27, v27, v253
    v_mul_f32 v28, v28, v253
    v_mul_f32 v29, v29, v253
    v_mul_f32 v30, v30, v253
    v_mul_f32 v31, v31, v253
    v_mul_f32 v32, v32, v253
    v_mul_f32 v33, v33, v253
    v_mul_f32 v34, v34, v253
    v_mul_f32 v35, v35, v253
    v_mul_f32 v36, v36, v253
    v_mul_f32 v37, v37, v253
    v_mul_f32 v38, v38, v253
    v_mul_f32 v39, v39, v253
    v_mul_f32 v40, v40, v253
    v_mul_f32 v41, v41, v253
    v_mul_f32 v42, v42, v253
    v_mul_f32 v43, v43, v253
    v_mul_f32 v44, v44, v253
    v_mul_f32 v45, v45, v253
    v_mul_f32 v46, v46, v253
    v_mul_f32 v47, v47, v253
    v_mul_f32 v48, v48, v253
    v_mul_f32 v49, v49, v253
    v_mul_f32 v50, v50, v253
    v_mul_f32 v51, v51, v253
    v_mul_f32 v52, v52, v253
    v_mul_f32 v53, v53, v253
    v_mul_f32 v54, v54, v253
    v_mul_f32 v55, v55, v253
    v_mul_f32 v56, v56, v253
    v_mul_f32 v57, v57, v253
    v_mul_f32 v58, v58, v253
    v_mul_f32 v59, v59, v253
    v_mul_f32 v60, v60, v253
    v_mul_f32 v61, v61, v253
    v_mul_f32 v62, v62, v253
    v_mul_f32 v63, v63, v253
    s_nop 1
A_nors_57:
    s_branch A_nxt_56
A_msk_55:
    ds_read_b128 v[176:179], v241 offset:0
    ds_read_b128 v[180:183], v241 offset:2048
    ds_read_b128 v[184:187], v241 offset:4096
    ds_read_b128 v[188:191], v241 offset:6144
    ds_read_b128 v[192:195], v241 offset:8192
    ds_read_b128 v[196:199], v241 offset:10240
    ds_read_b128 v[200:203], v241 offset:12288
    ds_read_b128 v[204:207], v241 offset:14336
    ds_read_b128 v[208:211], v241 offset:1024
    ds_read_b128 v[212:215], v241 offset:3072
    ds_read_b128 v[216:219], v241 offset:5120
    ds_read_b128 v[220:223], v241 offset:7168
    ds_read_b128 v[224:227], v241 offset:9216
    ds_read_b128 v[228:231], v241 offset:11264
    ds_read_b128 v[232:235], v241 offset:13312
    ds_read_b128 v[236:239], v241 offset:15360
    v_fma_f32 v64, v64, s30, -v250
    v_fma_f32 v65, v65, s30, -v250
    v_fma_f32 v66, v66, s30, -v250
    v_exp_f32 v64, v64
    v_fma_f32 v67, v67, s30, -v250
    v_exp_f32 v65, v65
    v_fma_f32 v68, v68, s30, -v250
    v_exp_f32 v66, v66
    v_fma_f32 v69, v69, s30, -v250
    v_exp_f32 v67, v67
    s_waitcnt lgkmcnt(8)
    v_mfma_f32_32x32x16_bf16 v[96:111], v[176:179], v[128:131], 0
    v_cvt_pk_bf16_f32 v160, v64, v65
    v_fma_f32 v70, v70, s30, -v250
    v_exp_f32 v68, v68
    v_mfma_f32_32x32x16_bf16 v[96:111], v[180:183], v[132:135], v[96:111]
    v_fma_f32 v71, v71, s30, -v250
    v_exp_f32 v69, v69
    v_cvt_pk_bf16_f32 v161, v66, v67
    v_mfma_f32_32x32x16_bf16 v[96:111], v[184:187], v[136:139], v[96:111]
    v_fma_f32 v72, v72, s30, -v250
    v_exp_f32 v70, v70
    v_fma_f32 v73, v73, s30, -v250
    v_mfma_f32_32x32x16_bf16 v[96:111], v[188:191], v[140:143], v[96:111]
    v_exp_f32 v71, v71
    v_cvt_pk_bf16_f32 v162, v68, v69
    v_mfma_f32_32x32x16_bf16 v[96:111], v[192:195], v[144:147], v[96:111]
    v_fma_f32 v74, v74, s30, -v250
    v_exp_f32 v72, v72
    v_fma_f32 v75, v75, s30, -v250
    v_mfma_f32_32x32x16_bf16 v[96:111], v[196:199], v[148:151], v[96:111]
    v_exp_f32 v73, v73
    s_add_u32 m0, s31, 98304
    s_nop 0
    v_mfma_f32_32x32x16_bf16 v[96:111], v[200:203], v[152:155], v[96:111]
    buffer_load_dwordx4 v246, s[12:15], s33 offen lds
    buffer_load_dwordx4 v246, s[12:15], s33 offen offset:1024 lds
    buffer_load_dwordx4 v246, s[12:15], s33 offen offset:2048 lds
    v_mfma_f32_32x32x16_bf16 v[96:111], v[204:207], v[156:159], v[96:111]
    buffer_load_dwordx4 v246, s[12:15], s33 offen offset:3072 lds
    s_add_u32 s33, s33, 1048576
    s_waitcnt lgkmcnt(0)
    v_mfma_f32_32x32x16_bf16 v[112:127], v[208:211], v[128:131], 0
    ds_read_b128 v[176:179], v242 offset:0
    ds_read_b128 v[180:183], v242 offset:1024
    ds_read_b128 v[184:187], v242 offset:2048
    v_mfma_f32_32x32x16_bf16 v[112:127], v[212:215], v[132:135], v[112:127]
    ds_read_b128 v[188:191], v242 offset:3072
    ds_read_b128 v[192:195], v242 offset:4096
    ds_read_b128 v[196:199], v242 offset:5120
    v_mfma_f32_32x32x16_bf16 v[112:127], v[216:219], v[136:139], v[112:127]
    ds_read_b128 v[200:203], v242 offset:6144
    ds_read_b128 v[204:207], v242 offset:7168
    v_cvt_pk_bf16_f32 v163, v70, v71
    v_mfma_f32_32x32x16_bf16 v[112:127], v[220:223], v[140:143], v[112:127]
    v_fma_f32 v76, v76, s30, -v250
    v_exp_f32 v74, v74
    v_fma_f32 v77, v77, s30, -v250
    v_mfma_f32_32x32x16_bf16 v[112:127], v[224:227], v[144:147], v[112:127]
    v_exp_f32 v75, v75
    v_cvt_pk_bf16_f32 v164, v72, v73
    v_fma_f32 v78, v78, s30, -v250
    v_mfma_f32_32x32x16_bf16 v[112:127], v[228:231], v[148:151], v[112:127]
    v_exp_f32 v76, v76
    v_fma_f32 v79, v79, s30, -v250
    v_exp_f32 v77, v77
    v_mfma_f32_32x32x16_bf16 v[112:127], v[232:235], v[152:155], v[112:127]
    v_cvt_pk_bf16_f32 v165, v74, v75
    v_exp_f32 v78, v78
    v_exp_f32 v79, v79
    v_mfma_f32_32x32x16_bf16 v[112:127], v[236:239], v[156:159], v[112:127]
    v_cvt_pk_bf16_f32 v166, v76, v77
    v_cvt_pk_bf16_f32 v167, v78, v79
    s_waitcnt lgkmcnt(0)
    s_nop 1
    v_mfma_f32_32x32x16_bf16 v[0:15], v[176:179], v[160:163], v[0:15]
    ds_read_b128 v[208:211], v242 offset:8192
    ds_read_b128 v[212:215], v242 offset:9216
    ds_read_b128 v[216:219], v242 offset:10240
    ds_read_b128 v[220:223], v242 offset:11264
    ds_read_b128 v[224:227], v242 offset:12288
    ds_read_b128 v[228:231], v242 offset:13312
    v_mfma_f32_32x32x16_bf16 v[16:31], v[180:183], v[160:163], v[16:31]
    ds_read_b128 v[232:235], v242 offset:14336
    ds_read_b128 v[236:239], v242 offset:15360
    v_fma_f32 v80, v80, s30, -v250
    v_fma_f32 v81, v81, s30, -v250
    v_fma_f32 v82, v82, s30, -v250
    v_exp_f32 v80, v80
    v_mfma_f32_32x32x16_bf16 v[32:47], v[184:187], v[160:163], v[32:47]
    v_fma_f32 v83, v83, s30, -v250
    v_exp_f32 v81, v81
    v_fma_f32 v84, v84, s30, -v250
    v_exp_f32 v82, v82
    v_fma_f32 v85, v85, s30, -v250
    v_exp_f32 v83, v83
    v_mfma_f32_32x32x16_bf16 v[48:63], v[188:191], v[160:163], v[48:63]
    v_cvt_pk_bf16_f32 v168, v80, v81
    v_fma_f32 v86, v86, s30, -v250
    v_exp_f32 v84, v84
    v_fma_f32 v87, v87, s30, -v250
    v_exp_f32 v85, v85
    v_cvt_pk_bf16_f32 v169, v82, v83
    v_mfma_f32_32x32x16_bf16 v[0:15], v[192:195], v[164:167], v[0:15]
    v_fma_f32 v88, v88, s30, -v250
    v_exp_f32 v86, v86
    v_fma_f32 v89, v89, s30, -v250
    v_exp_f32 v87, v87
    v_cvt_pk_bf16_f32 v170, v84, v85
    v_fma_f32 v90, v90, s30, -v250
    v_mfma_f32_32x32x16_bf16 v[16:31], v[196:199], v[164:167], v[16:31]
    v_exp_f32 v88, v88
    v_fma_f32 v91, v91, s30, -v250
    v_exp_f32 v89, v89
    v_cvt_pk_bf16_f32 v171, v86, v87
    v_fma_f32 v92, v92, s30, -v250
    v_exp_f32 v90, v90
    v_mfma_f32_32x32x16_bf16 v[32:47], v[200:203], v[164:167], v[32:47]
    v_fma_f32 v93, v93, s30, -v250
    v_exp_f32 v91, v91
    v_cvt_pk_bf16_f32 v172, v88, v89
    v_fma_f32 v94, v94, s30, -v250
    v_exp_f32 v92, v92
    v_fma_f32 v95, v95, s30, -v250
    v_mfma_f32_32x32x16_bf16 v[48:63], v[204:207], v[164:167], v[48:63]
    v_exp_f32 v93, v93
    v_cvt_pk_bf16_f32 v173, v90, v91
    v_exp_f32 v94, v94
    v_exp_f32 v95, v95
    v_cvt_pk_bf16_f32 v174, v92, v93
    v_cvt_pk_bf16_f32 v175, v94, v95
    s_waitcnt lgkmcnt(0)
    s_nop 1
    v_mfma_f32_32x32x16_bf16 v[0:15], v[208:211], v[168:171], v[0:15]
    s_add_u32 m0, s31, 0
    s_nop 0
    buffer_load_dwordx4 v244, s[8:11], s32 offen lds
    buffer_load_dwordx4 v244, s[8:11], s32 offen offset:1024 lds
    s_add_u32 m0, s31, 2048
    s_nop 0
    buffer_load_dwordx4 v245, s[8:11], s32 offen lds
    buffer_load_dwordx4 v245, s[8:11], s32 offen offset:1024 lds
    s_add_u32 s32, s32, 4096
    v_add_f32 v252, v64, v65
    v_add_f32 v252, v252, v66
    v_add_f32 v252, v252, v67
    v_add_f32 v252, v252, v68
    v_add_f32 v252, v252, v69
    v_add_f32 v252, v252, v70
    v_add_f32 v252, v252, v71
    v_add_f32 v252, v252, v72
    v_add_f32 v252, v252, v73
    v_add_f32 v252, v252, v74
    v_add_f32 v252, v252, v75
    v_add_f32 v252, v252, v76
    v_mfma_f32_32x32x16_bf16 v[16:31], v[212:215], v[168:171], v[16:31]
    v_add_f32 v252, v252, v77
    v_add_f32 v252, v252, v78
    v_add_f32 v252, v252, v79
    v_add_f32 v252, v252, v80
    v_add_f32 v252, v252, v81
    v_add_f32 v252, v252, v82
    v_add_f32 v252, v252, v83
    v_add_f32 v252, v252, v84
    v_add_f32 v252, v252, v85
    v_add_f32 v252, v252, v86
    v_add_f32 v252, v252, v87
    v_add_f32 v252, v252, v88
    v_add_f32 v252, v252, v89
    v_add_f32 v252, v252, v90
    v_add_f32 v252, v252, v91
    v_add_f32 v252, v252, v92
    v_add_f32 v252, v252, v93
    v_add_f32 v252, v252, v94
    v_add_f32 v252, v252, v95
    v_add_f32 v249, v249, v252
    v_mfma_f32_32x32x16_bf16 v[32:47], v[216:219], v[168:171], v[32:47]
    v_subrev_u32 v252, s37, v251
    v_mov_b32 v253, 0xff800000
    v_cmp_gt_i32 vcc, 0, v252
    s_nop 1
    v_cndmask_b32 v96, v96, v253, vcc
    v_cmp_gt_i32 vcc, 1, v252
    s_nop 1
    v_cndmask_b32 v97, v97, v253, vcc
    v_cmp_gt_i32 vcc, 2, v252
    s_nop 1
    v_cndmask_b32 v98, v98, v253, vcc
    v_cmp_gt_i32 vcc, 3, v252
    s_nop 1
    v_cndmask_b32 v99, v99, v253, vcc
    v_cmp_gt_i32 vcc, 8, v252
    s_nop 1
    v_cndmask_b32 v100, v100, v253, vcc
    v_cmp_gt_i32 vcc, 9, v252
    s_nop 1
    v_cndmask_b32 v101, v101, v253, vcc
    v_mfma_f32_32x32x16_bf16 v[48:63], v[220:223], v[168:171], v[48:63]
    v_cmp_gt_i32 vcc, 10, v252
    s_nop 1
    v_cndmask_b32 v102, v102, v253, vcc
    v_cmp_gt_i32 vcc, 11, v252
    s_nop 1
    v_cndmask_b32 v103, v103, v253, vcc
    v_cmp_gt_i32 vcc, 16, v252
    s_nop 1
    v_cndmask_b32 v104, v104, v253, vcc
    v_cmp_gt_i32 vcc, 17, v252
    s_nop 1
    v_cndmask_b32 v105, v105, v253, vcc
    v_cmp_gt_i32 vcc, 18, v252
    s_nop 1
    v_cndmask_b32 v106, v106, v253, vcc
    v_cmp_gt_i32 vcc, 19, v252
    s_nop 1
    v_cndmask_b32 v107, v107, v253, vcc
    v_cmp_gt_i32 vcc, 24, v252
    s_nop 1
    v_mfma_f32_32x32x16_bf16 v[0:15], v[224:227], v[172:175], v[0:15]
    v_cndmask_b32 v108, v108, v253, vcc
    v_cmp_gt_i32 vcc, 25, v252
    s_nop 1
    v_cndmask_b32 v109, v109, v253, vcc
    v_cmp_gt_i32 vcc, 26, v252
    s_nop 1
    v_cndmask_b32 v110, v110, v253, vcc
    v_cmp_gt_i32 vcc, 27, v252
    s_nop 1
    v_cndmask_b32 v111, v111, v253, vcc
    v_cmp_gt_i32 vcc, 32, v252
    s_nop 1
    v_cndmask_b32 v112, v112, v253, vcc
    v_cmp_gt_i32 vcc, 33, v252
    s_nop 1
    v_cndmask_b32 v113, v113, v253, vcc
    v_cmp_gt_i32 vcc, 34, v252
    s_nop 1
    v_cndmask_b32 v114, v114, v253, vcc
    v_cmp_gt_i32 vcc, 35, v252
    v_mfma_f32_32x32x16_bf16 v[16:31], v[228:231], v[172:175], v[16:31]
    s_nop 1
    v_cndmask_b32 v115, v115, v253, vcc
    v_cmp_gt_i32 vcc, 40, v252
    s_nop 1
    v_cndmask_b32 v116, v116, v253, vcc
    v_cmp_gt_i32 vcc, 41, v252
    s_nop 1
    v_cndmask_b32 v117, v117, v253, vcc
    v_cmp_gt_i32 vcc, 42, v252
    s_nop 1
    v_cndmask_b32 v118, v118, v253, vcc
    v_cmp_gt_i32 vcc, 43, v252
    s_nop 1
    v_cndmask_b32 v119, v119, v253, vcc
    v_cmp_gt_i32 vcc, 48, v252
    s_nop 1
    v_cndmask_b32 v120, v120, v253, vcc
    v_cmp_gt_i32 vcc, 49, v252
    s_nop 1
    v_cndmask_b32 v121, v121, v253, vcc
    v_mfma_f32_32x32x16_bf16 v[32:47], v[232:235], v[172:175], v[32:47]
    v_cmp_gt_i32 vcc, 50, v252
    s_nop 1
    v_cndmask_b32 v122, v122, v253, vcc
    v_cmp_gt_i32 vcc, 51, v252
    s_nop 1
    v_cndmask_b32 v123, v123, v253, vcc
    v_cmp_gt_i32 vcc, 56, v252
    s_nop 1
    v_cndmask_b32 v124, v124, v253, vcc
    v_cmp_gt_i32 vcc, 57, v252
    s_nop 1
    v_cndmask_b32 v125, v125, v253, vcc
    v_cmp_gt_i32 vcc, 58, v252
    s_nop 1
    v_cndmask_b32 v126, v126, v253, vcc
    v_cmp_gt_i32 vcc, 59, v252
    s_nop 1
    v_cndmask_b32 v127, v127, v253, vcc
    v_max3_f32 v252, v96, v97, v98
    v_max3_f32 v252, v252, v99, v100
    v_mfma_f32_32x32x16_bf16 v[48:63], v[236:239], v[172:175], v[48:63]
    v_max3_f32 v252, v252, v101, v102
    v_max3_f32 v252, v252, v103, v104
    v_max3_f32 v252, v252, v105, v106
    v_max3_f32 v252, v252, v107, v108
    v_max3_f32 v252, v252, v109, v110
    v_max3_f32 v252, v252, v111, v112
    v_max3_f32 v252, v252, v113, v114
    v_max3_f32 v252, v252, v115, v116
    v_max3_f32 v252, v252, v117, v118
    v_max3_f32 v252, v252, v119, v120
    v_max3_f32 v252, v252, v121, v122
    v_max3_f32 v252, v252, v123, v124
    v_max3_f32 v252, v252, v125, v126
    v_max_f32 v252, v252, v127
    v_mov_b32 v253, v252
    s_nop 1
    v_permlane32_swap_b32 v253, v252
    v_max_f32 v252, v252, v253
    v_sub_f32 v253, v252, v248
    v_cmp_lt_f32 vcc, s29, v253
    s_nop 0
    s_cbranch_vccz A_nors_58
    s_nop 15
    s_nop 15
    v_max_f32 v252, v252, v248
    v_sub_f32 v253, v248, v252
    v_mul_f32 v253, s30, v253
    v_exp_f32 v253, v253
    v_mov_b32 v248, v252
    v_mul_f32 v250, s30, v252
    v_mul_f32 v249, v249, v253
    v_mul_f32 v0, v0, v253
    v_mul_f32 v1, v1, v253
    v_mul_f32 v2, v2, v253
    v_mul_f32 v3, v3, v253
    v_mul_f32 v4, v4, v253
    v_mul_f32 v5, v5, v253
    v_mul_f32 v6, v6, v253
    v_mul_f32 v7, v7, v253
    v_mul_f32 v8, v8, v253
    v_mul_f32 v9, v9, v253
    v_mul_f32 v10, v10, v253
    v_mul_f32 v11, v11, v253
    v_mul_f32 v12, v12, v253
    v_mul_f32 v13, v13, v253
    v_mul_f32 v14, v14, v253
    v_mul_f32 v15, v15, v253
    v_mul_f32 v16, v16, v253
    v_mul_f32 v17, v17, v253
    v_mul_f32 v18, v18, v253
    v_mul_f32 v19, v19, v253
    v_mul_f32 v20, v20, v253
    v_mul_f32 v21, v21, v253
    v_mul_f32 v22, v22, v253
    v_mul_f32 v23, v23, v253
    v_mul_f32 v24, v24, v253
    v_mul_f32 v25, v25, v253
    v_mul_f32 v26, v26, v253
    v_mul_f32 v27, v27, v253
    v_mul_f32 v28, v28, v253
    v_mul_f32 v29, v29, v253
    v_mul_f32 v30, v30, v253
    v_mul_f32 v31, v31, v253
    v_mul_f32 v32, v32, v253
    v_mul_f32 v33, v33, v253
    v_mul_f32 v34, v34, v253
    v_mul_f32 v35, v35, v253
    v_mul_f32 v36, v36, v253
    v_mul_f32 v37, v37, v253
    v_mul_f32 v38, v38, v253
    v_mul_f32 v39, v39, v253
    v_mul_f32 v40, v40, v253
    v_mul_f32 v41, v41, v253
    v_mul_f32 v42, v42, v253
    v_mul_f32 v43, v43, v253
    v_mul_f32 v44, v44, v253
    v_mul_f32 v45, v45, v253
    v_mul_f32 v46, v46, v253
    v_mul_f32 v47, v47, v253
    v_mul_f32 v48, v48, v253
    v_mul_f32 v49, v49, v253
    v_mul_f32 v50, v50, v253
    v_mul_f32 v51, v51, v253
    v_mul_f32 v52, v52, v253
    v_mul_f32 v53, v53, v253
    v_mul_f32 v54, v54, v253
    v_mul_f32 v55, v55, v253
    v_mul_f32 v56, v56, v253
    v_mul_f32 v57, v57, v253
    v_mul_f32 v58, v58, v253
    v_mul_f32 v59, v59, v253
    v_mul_f32 v60, v60, v253
    v_mul_f32 v61, v61, v253
    v_mul_f32 v62, v62, v253
    v_mul_f32 v63, v63, v253
    s_nop 1
A_nors_58:
    s_branch A_nxt_56
A_last_54:
    ds_read_b128 v[176:179], v242 offset:0
    ds_read_b128 v[180:183], v242 offset:1024
    ds_read_b128 v[184:187], v242 offset:2048
    ds_read_b128 v[188:191], v242 offset:3072
    ds_read_b128 v[192:195], v242 offset:4096
    ds_read_b128 v[196:199], v242 offset:5120
    ds_read_b128 v[200:203], v242 offset:6144
    ds_read_b128 v[204:207], v242 offset:7168
    ds_read_b128 v[208:211], v242 offset:8192
    ds_read_b128 v[212:215], v242 offset:9216
    ds_read_b128 v[216:219], v242 offset:10240
    ds_read_b128 v[220:223], v242 offset:11264
    ds_read_b128 v[224:227], v242 offset:12288
    ds_read_b128 v[228:231], v242 offset:13312
    ds_read_b128 v[232:235], v242 offset:14336
    ds_read_b128 v[236:239], v242 offset:15360
    v_fma_f32 v64, v64, s30, -v250
    v_fma_f32 v65, v65, s30, -v250
    v_fma_f32 v66, v66, s30, -v250
    v_exp_f32 v64, v64
    v_fma_f32 v67, v67, s30, -v250
    v_exp_f32 v65, v65
    v_fma_f32 v68, v68, s30, -v250
    v_exp_f32 v66, v66
    v_fma_f32 v69, v69, s30, -v250
    v_exp_f32 v67, v67
    v_cvt_pk_bf16_f32 v160, v64, v65
    v_fma_f32 v70, v70, s30, -v250
    v_exp_f32 v68, v68
    v_fma_f32 v71, v71, s30, -v250
    v_exp_f32 v69, v69
    v_cvt_pk_bf16_f32 v161, v66, v67
    v_fma_f32 v72, v72, s30, -v250
    v_exp_f32 v70, v70
    v_fma_f32 v73, v73, s30, -v250
    v_exp_f32 v71, v71
    v_cvt_pk_bf16_f32 v162, v68, v69
    v_fma_f32 v74, v74, s30, -v250
    v_exp_f32 v72, v72
    v_fma_f32 v75, v75, s30, -v250
    v_exp_f32 v73, v73
    v_cvt_pk_bf16_f32 v163, v70, v71
    v_fma_f32 v76, v76, s30, -v250
    v_exp_f32 v74, v74
    v_fma_f32 v77, v77, s30, -v250
    v_exp_f32 v75, v75
    v_cvt_pk_bf16_f32 v164, v72, v73
    v_fma_f32 v78, v78, s30, -v250
    v_exp_f32 v76, v76
    v_fma_f32 v79, v79, s30, -v250
    v_exp_f32 v77, v77
    v_cvt_pk_bf16_f32 v165, v74, v75
    v_exp_f32 v78, v78
    v_exp_f32 v79, v79
    v_cvt_pk_bf16_f32 v166, v76, v77
    v_cvt_pk_bf16_f32 v167, v78, v79
    v_fma_f32 v80, v80, s30, -v250
    v_fma_f32 v81, v81, s30, -v250
    v_fma_f32 v82, v82, s30, -v250
    v_exp_f32 v80, v80
    v_fma_f32 v83, v83, s30, -v250
    v_exp_f32 v81, v81
    v_fma_f32 v84, v84, s30, -v250
    v_exp_f32 v82, v82
    v_fma_f32 v85, v85, s30, -v250
    v_exp_f32 v83, v83
    v_cvt_pk_bf16_f32 v168, v80, v81
    v_fma_f32 v86, v86, s30, -v250
    v_exp_f32 v84, v84
    v_fma_f32 v87, v87, s30, -v250
    v_exp_f32 v85, v85
    v_cvt_pk_bf16_f32 v169, v82, v83
    v_fma_f32 v88, v88, s30, -v250
    v_exp_f32 v86, v86
    v_fma_f32 v89, v89, s30, -v250
    v_exp_f32 v87, v87
    v_cvt_pk_bf16_f32 v170, v84, v85
    v_fma_f32 v90, v90, s30, -v250
    v_exp_f32 v88, v88
    v_fma_f32 v91, v91, s30, -v250
    v_exp_f32 v89, v89
    v_cvt_pk_bf16_f32 v171, v86, v87
    v_fma_f32 v92, v92, s30, -v250
    v_exp_f32 v90, v90
    v_fma_f32 v93, v93, s30, -v250
    v_exp_f32 v91, v91
    v_cvt_pk_bf16_f32 v172, v88, v89
    v_fma_f32 v94, v94, s30, -v250
    v_exp_f32 v92, v92
    v_fma_f32 v95, v95, s30, -v250
    v_exp_f32 v93, v93
    v_cvt_pk_bf16_f32 v173, v90, v91
    v_exp_f32 v94, v94
    v_exp_f32 v95, v95
    v_cvt_pk_bf16_f32 v174, v92, v93
    v_cvt_pk_bf16_f32 v175, v94, v95
    s_waitcnt lgkmcnt(0)
    s_nop 1
    v_mfma_f32_32x32x16_bf16 v[0:15], v[176:179], v[160:163], v[0:15]
    v_add_f32 v252, v64, v65
    v_add_f32 v252, v252, v66
    v_mfma_f32_32x32x16_bf16 v[16:31], v[180:183], v[160:163], v[16:31]
    v_add_f32 v252, v252, v67
    v_add_f32 v252, v252, v68
    v_mfma_f32_32x32x16_bf16 v[32:47], v[184:187], v[160:163], v[32:47]
    v_add_f32 v252, v252, v69
    v_add_f32 v252, v252, v70
    v_mfma_f32_32x32x16_bf16 v[48:63], v[188:191], v[160:163], v[48:63]
    v_add_f32 v252, v252, v71
    v_add_f32 v252, v252, v72
    v_mfma_f32_32x32x16_bf16 v[0:15], v[192:195], v[164:167], v[0:15]
    v_add_f32 v252, v252, v73
    v_add_f32 v252, v252, v74
    v_mfma_f32_32x32x16_bf16 v[16:31], v[196:199], v[164:167], v[16:31]
    v_add_f32 v252, v252, v75
    v_add_f32 v252, v252, v76
    v_mfma_f32_32x32x16_bf16 v[32:47], v[200:203], v[164:167], v[32:47]
    v_add_f32 v252, v252, v77
    v_add_f32 v252, v252, v78
    v_mfma_f32_32x32x16_bf16 v[48:63], v[204:207], v[164:167], v[48:63]
    v_add_f32 v252, v252, v79
    v_add_f32 v252, v252, v80
    v_mfma_f32_32x32x16_bf16 v[0:15], v[208:211], v[168:171], v[0:15]
    v_add_f32 v252, v252, v81
    v_add_f32 v252, v252, v82
    v_mfma_f32_32x32x16_bf16 v[16:31], v[212:215], v[168:171], v[16:31]
    v_add_f32 v252, v252, v83
    v_add_f32 v252, v252, v84
    v_mfma_f32_32x32x16_bf16 v[32:47], v[216:219], v[168:171], v[32:47]
    v_add_f32 v252, v252, v85
    v_add_f32 v252, v252, v86
    v_mfma_f32_32x32x16_bf16 v[48:63], v[220:223], v[168:171], v[48:63]
    v_add_f32 v252, v252, v87
    v_add_f32 v252, v252, v88
    v_mfma_f32_32x32x16_bf16 v[0:15], v[224:227], v[172:175], v[0:15]
    v_add_f32 v252, v252, v89
    v_add_f32 v252, v252, v90
    v_mfma_f32_32x32x16_bf16 v[16:31], v[228:231], v[172:175], v[16:31]
    v_add_f32 v252, v252, v91
    v_add_f32 v252, v252, v92
    v_mfma_f32_32x32x16_bf16 v[32:47], v[232:235], v[172:175], v[32:47]
    v_add_f32 v252, v252, v93
    v_add_f32 v252, v252, v94
    v_mfma_f32_32x32x16_bf16 v[48:63], v[236:239], v[172:175], v[48:63]
    v_add_f32 v252, v252, v95
    v_add_f32 v249, v249, v252
    s_branch A_fin_53
A_nxt_56:
    s_add_u32 s35, s35, 1
    s_waitcnt vmcnt(0)
    s_barrier
    s_add_u32 s65, s67, 0
    v_add_u32 v241, s65, v240
    s_add_u32 s65, s67, 98304
    v_add_u32 v242, s65, v240
    s_add_u32 s38, s35, 1
    s_cmp_ge_u32 s38, s36
    s_cbranch_scc1 A_last_59
    s_cmp_ge_u32 s38, s23
    s_cbranch_scc1 A_msk_60
    ds_read_b128 v[176:179], v241 offset:0
    ds_read_b128 v[180:183], v241 offset:2048
    ds_read_b128 v[184:187], v241 offset:4096
    ds_read_b128 v[188:191], v241 offset:6144
    ds_read_b128 v[192:195], v241 offset:8192
    ds_read_b128 v[196:199], v241 offset:10240
    ds_read_b128 v[200:203], v241 offset:12288
    ds_read_b128 v[204:207], v241 offset:14336
    ds_read_b128 v[208:211], v241 offset:1024
    ds_read_b128 v[212:215], v241 offset:3072
    ds_read_b128 v[216:219], v241 offset:5120
    ds_read_b128 v[220:223], v241 offset:7168
    ds_read_b128 v[224:227], v241 offset:9216
    ds_read_b128 v[228:231], v241 offset:11264
    ds_read_b128 v[232:235], v241 offset:13312
    ds_read_b128 v[236:239], v241 offset:15360
    v_fma_f32 v96, v96, s30, -v250
    v_fma_f32 v97, v97, s30, -v250
    v_fma_f32 v98, v98, s30, -v250
    v_exp_f32 v96, v96
    v_fma_f32 v99, v99, s30, -v250
    v_exp_f32 v97, v97
    v_fma_f32 v100, v100, s30, -v250
    v_exp_f32 v98, v98
    v_fma_f32 v101, v101, s30, -v250
    v_exp_f32 v99, v99
    s_waitcnt lgkmcnt(8)
    v_mfma_f32_32x32x16_bf16 v[64:79], v[176:179], v[128:131], 0
    v_cvt_pk_bf16_f32 v160, v96, v97
    v_fma_f32 v102, v102, s30, -v250
    v_exp_f32 v100, v100
    v_mfma_f32_32x32x16_bf16 v[64:79], v[180:183], v[132:135], v[64:79]
    v_fma_f32 v103, v103, s30, -v250
    v_exp_f32 v101, v101
    v_cvt_pk_bf16_f32 v161, v98, v99
    v_mfma_f32_32x32x16_bf16 v[64:79], v[184:187], v[136:139], v[64:79]
    v_fma_f32 v104, v104, s30, -v250
    v_exp_f32 v102, v102
    v_fma_f32 v105, v105, s30, -v250
    v_mfma_f32_32x32x16_bf16 v[64:79], v[188:191], v[140:143], v[64:79]
    v_exp_f32 v103, v103
    v_cvt_pk_bf16_f32 v162, v100, v101
    v_mfma_f32_32x32x16_bf16 v[64:79], v[192:195], v[144:147], v[64:79]
    v_fma_f32 v106, v106, s30, -v250
    v_exp_f32 v104, v104
    v_fma_f32 v107, v107, s30, -v250
    v_mfma_f32_32x32x16_bf16 v[64:79], v[196:199], v[148:151], v[64:79]
    v_exp_f32 v105, v105
    s_add_u32 m0, s31, 65536
    s_nop 0
    v_mfma_f32_32x32x16_bf16 v[64:79], v[200:203], v[152:155], v[64:79]
    buffer_load_dwordx4 v246, s[12:15], s33 offen lds
    buffer_load_dwordx4 v246, s[12:15], s33 offen offset:1024 lds
    buffer_load_dwordx4 v246, s[12:15], s33 offen offset:2048 lds
    v_mfma_f32_32x32x16_bf16 v[64:79], v[204:207], v[156:159], v[64:79]
    buffer_load_dwordx4 v246, s[12:15], s33 offen offset:3072 lds
    s_add_u32 s33, s33, 1048576
    s_waitcnt lgkmcnt(0)
    v_mfma_f32_32x32x16_bf16 v[80:95], v[208:211], v[128:131], 0
    ds_read_b128 v[176:179], v242 offset:0
    ds_read_b128 v[180:183], v242 offset:1024
    ds_read_b128 v[184:187], v242 offset:2048
    v_mfma_f32_32x32x16_bf16 v[80:95], v[212:215], v[132:135], v[80:95]
    ds_read_b128 v[188:191], v242 offset:3072
    ds_read_b128 v[192:195], v242 offset:4096
    ds_read_b128 v[196:199], v242 offset:5120
    v_mfma_f32_32x32x16_bf16 v[80:95], v[216:219], v[136:139], v[80:95]
    ds_read_b128 v[200:203], v242 offset:6144
    ds_read_b128 v[204:207], v242 offset:7168
    v_cvt_pk_bf16_f32 v163, v102, v103
    v_mfma_f32_32x32x16_bf16 v[80:95], v[220:223], v[140:143], v[80:95]
    v_fma_f32 v108, v108, s30, -v250
    v_exp_f32 v106, v106
    v_fma_f32 v109, v109, s30, -v250
    v_mfma_f32_32x32x16_bf16 v[80:95], v[224:227], v[144:147], v[80:95]
    v_exp_f32 v107, v107
    v_cvt_pk_bf16_f32 v164, v104, v105
    v_fma_f32 v110, v110, s30, -v250
    v_mfma_f32_32x32x16_bf16 v[80:95], v[228:231], v[148:151], v[80:95]
    v_exp_f32 v108, v108
    v_fma_f32 v111, v111, s30, -v250
    v_exp_f32 v109, v109
    v_mfma_f32_32x32x16_bf16 v[80:95], v[232:235], v[152:155], v[80:95]
    v_cvt_pk_bf16_f32 v165, v106, v107
    v_exp_f32 v110, v110
    v_exp_f32 v111, v111
    v_mfma_f32_32x32x16_bf16 v[80:95], v[236:239], v[156:159], v[80:95]
    v_cvt_pk_bf16_f32 v166, v108, v109
    v_cvt_pk_bf16_f32 v167, v110, v111
    s_waitcnt lgkmcnt(0)
    s_nop 1
    v_mfma_f32_32x32x16_bf16 v[0:15], v[176:179], v[160:163], v[0:15]
    ds_read_b128 v[208:211], v242 offset:8192
    ds_read_b128 v[212:215], v242 offset:9216
    ds_read_b128 v[216:219], v242 offset:10240
    ds_read_b128 v[220:223], v242 offset:11264
    ds_read_b128 v[224:227], v242 offset:12288
    ds_read_b128 v[228:231], v242 offset:13312
    v_mfma_f32_32x32x16_bf16 v[16:31], v[180:183], v[160:163], v[16:31]
    ds_read_b128 v[232:235], v242 offset:14336
    ds_read_b128 v[236:239], v242 offset:15360
    v_fma_f32 v112, v112, s30, -v250
    v_fma_f32 v113, v113, s30, -v250
    v_fma_f32 v114, v114, s30, -v250
    v_exp_f32 v112, v112
    v_mfma_f32_32x32x16_bf16 v[32:47], v[184:187], v[160:163], v[32:47]
    v_fma_f32 v115, v115, s30, -v250
    v_exp_f32 v113, v113
    v_fma_f32 v116, v116, s30, -v250
    v_exp_f32 v114, v114
    v_fma_f32 v117, v117, s30, -v250
    v_exp_f32 v115, v115
    v_mfma_f32_32x32x16_bf16 v[48:63], v[188:191], v[160:163], v[48:63]
    v_cvt_pk_bf16_f32 v168, v112, v113
    v_fma_f32 v118, v118, s30, -v250
    v_exp_f32 v116, v116
    v_fma_f32 v119, v119, s30, -v250
    v_exp_f32 v117, v117
    v_cvt_pk_bf16_f32 v169, v114, v115
    v_mfma_f32_32x32x16_bf16 v[0:15], v[192:195], v[164:167], v[0:15]
    v_fma_f32 v120, v120, s30, -v250
    v_exp_f32 v118, v118
    v_fma_f32 v121, v121, s30, -v250
    v_exp_f32 v119, v119
    v_cvt_pk_bf16_f32 v170, v116, v117
    v_fma_f32 v122, v122, s30, -v250
    v_mfma_f32_32x32x16_bf16 v[16:31], v[196:199], v[164:167], v[16:31]
    v_exp_f32 v120, v120
    v_fma_f32 v123, v123, s30, -v250
    v_exp_f32 v121, v121
    v_cvt_pk_bf16_f32 v171, v118, v119
    v_fma_f32 v124, v124, s30, -v250
    v_exp_f32 v122, v122
    v_mfma_f32_32x32x16_bf16 v[32:47], v[200:203], v[164:167], v[32:47]
    v_fma_f32 v125, v125, s30, -v250
    v_exp_f32 v123, v123
    v_cvt_pk_bf16_f32 v172, v120, v121
    v_fma_f32 v126, v126, s30, -v250
    v_exp_f32 v124, v124
    v_fma_f32 v127, v127, s30, -v250
    v_mfma_f32_32x32x16_bf16 v[48:63], v[204:207], v[164:167], v[48:63]
    v_exp_f32 v125, v125
    v_cvt_pk_bf16_f32 v173, v122, v123
    v_exp_f32 v126, v126
    v_exp_f32 v127, v127
    v_cvt_pk_bf16_f32 v174, v124, v125
    v_cvt_pk_bf16_f32 v175, v126, v127
    s_waitcnt lgkmcnt(0)
    s_nop 1
    v_mfma_f32_32x32x16_bf16 v[0:15], v[208:211], v[168:171], v[0:15]
    s_add_u32 m0, s31, 32768
    s_nop 0
    buffer_load_dwordx4 v244, s[8:11], s32 offen lds
    buffer_load_dwordx4 v244, s[8:11], s32 offen offset:1024 lds
    s_add_u32 m0, s31, 34816
    s_nop 0
    buffer_load_dwordx4 v245, s[8:11], s32 offen lds
    buffer_load_dwordx4 v245, s[8:11], s32 offen offset:1024 lds
    v_mfma_f32_32x32x16_bf16 v[16:31], v[212:215], v[168:171], v[16:31]
    s_add_u32 s32, s32, 4096
    v_add_f32 v252, v96, v97
    v_add_f32 v252, v252, v98
    v_add_f32 v252, v252, v99
    v_add_f32 v252, v252, v100
    v_add_f32 v252, v252, v101
    v_add_f32 v252, v252, v102
    v_add_f32 v252, v252, v103
    v_mfma_f32_32x32x16_bf16 v[32:47], v[216:219], v[168:171], v[32:47]
    v_add_f32 v252, v252, v104
    v_add_f32 v252, v252, v105
    v_add_f32 v252, v252, v106
    v_add_f32 v252, v252, v107
    v_add_f32 v252, v252, v108
    v_add_f32 v252, v252, v109
    v_add_f32 v252, v252, v110
    v_add_f32 v252, v252, v111
    v_mfma_f32_32x32x16_bf16 v[48:63], v[220:223], v[168:171], v[48:63]
    v_add_f32 v252, v252, v112
    v_add_f32 v252, v252, v113
    v_add_f32 v252, v252, v114
    v_add_f32 v252, v252, v115
    v_add_f32 v252, v252, v116
    v_add_f32 v252, v252, v117
    v_add_f32 v252, v252, v118
    v_add_f32 v252, v252, v119
    v_mfma_f32_32x32x16_bf16 v[0:15], v[224:227], v[172:175], v[0:15]
    v_add_f32 v252, v252, v120
    v_add_f32 v252, v252, v121
    v_add_f32 v252, v252, v122
    v_add_f32 v252, v252, v123
    v_add_f32 v252, v252, v124
    v_add_f32 v252, v252, v125
    v_add_f32 v252, v252, v126
    v_add_f32 v252, v252, v127
    v_mfma_f32_32x32x16_bf16 v[16:31], v[228:231], v[172:175], v[16:31]
    v_add_f32 v249, v249, v252
    v_max3_f32 v252, v64, v65, v66
    v_max3_f32 v252, v252, v67, v68
    v_max3_f32 v252, v252, v69, v70
    v_max3_f32 v252, v252, v71, v72
    v_max3_f32 v252, v252, v73, v74
    v_max3_f32 v252, v252, v75, v76
    v_max3_f32 v252, v252, v77, v78
    v_mfma_f32_32x32x16_bf16 v[32:47], v[232:235], v[172:175], v[32:47]
    v_max3_f32 v252, v252, v79, v80
    v_max3_f32 v252, v252, v81, v82
    v_max3_f32 v252, v252, v83, v84
    v_max3_f32 v252, v252, v85, v86
    v_max3_f32 v252, v252, v87, v88
    v_max3_f32 v252, v252, v89, v90
    v_max3_f32 v252, v252, v91, v92
    v_max3_f32 v252, v252, v93, v94
    v_mfma_f32_32x32x16_bf16 v[48:63], v[236:239], v[172:175], v[48:63]
    v_max_f32 v252, v252, v95
    v_mov_b32 v253, v252
    s_nop 1
    v_permlane32_swap_b32 v253, v252
    v_max_f32 v252, v252, v253
    v_sub_f32 v253, v252, v248
    v_cmp_lt_f32 vcc, s29, v253
    s_nop 0
    s_cbranch_vccz A_nors_62
    s_nop 15
    s_nop 15
    v_max_f32 v252, v252, v248
    v_sub_f32 v253, v248, v252
    v_mul_f32 v253, s30, v253
    v_exp_f32 v253, v253
    v_mov_b32 v248, v252
    v_mul_f32 v250, s30, v252
    v_mul_f32 v249, v249, v253
    v_mul_f32 v0, v0, v253
    v_mul_f32 v1, v1, v253
    v_mul_f32 v2, v2, v253
    v_mul_f32 v3, v3, v253
    v_mul_f32 v4, v4, v253
    v_mul_f32 v5, v5, v253
    v_mul_f32 v6, v6, v253
    v_mul_f32 v7, v7, v253
    v_mul_f32 v8, v8, v253
    v_mul_f32 v9, v9, v253
    v_mul_f32 v10, v10, v253
    v_mul_f32 v11, v11, v253
    v_mul_f32 v12, v12, v253
    v_mul_f32 v13, v13, v253
    v_mul_f32 v14, v14, v253
    v_mul_f32 v15, v15, v253
    v_mul_f32 v16, v16, v253
    v_mul_f32 v17, v17, v253
    v_mul_f32 v18, v18, v253
    v_mul_f32 v19, v19, v253
    v_mul_f32 v20, v20, v253
    v_mul_f32 v21, v21, v253
    v_mul_f32 v22, v22, v253
    v_mul_f32 v23, v23, v253
    v_mul_f32 v24, v24, v253
    v_mul_f32 v25, v25, v253
    v_mul_f32 v26, v26, v253
    v_mul_f32 v27, v27, v253
    v_mul_f32 v28, v28, v253
    v_mul_f32 v29, v29, v253
    v_mul_f32 v30, v30, v253
    v_mul_f32 v31, v31, v253
    v_mul_f32 v32, v32, v253
    v_mul_f32 v33, v33, v253
    v_mul_f32 v34, v34, v253
    v_mul_f32 v35, v35, v253
    v_mul_f32 v36, v36, v253
    v_mul_f32 v37, v37, v253
    v_mul_f32 v38, v38, v253
    v_mul_f32 v39, v39, v253
    v_mul_f32 v40, v40, v253
    v_mul_f32 v41, v41, v253
    v_mul_f32 v42, v42, v253
    v_mul_f32 v43, v43, v253
    v_mul_f32 v44, v44, v253
    v_mul_f32 v45, v45, v253
    v_mul_f32 v46, v46, v253
    v_mul_f32 v47, v47, v253
    v_mul_f32 v48, v48, v253
    v_mul_f32 v49, v49, v253
    v_mul_f32 v50, v50, v253
    v_mul_f32 v51, v51, v253
    v_mul_f32 v52, v52, v253
    v_mul_f32 v53, v53, v253
    v_mul_f32 v54, v54, v253
    v_mul_f32 v55, v55, v253
    v_mul_f32 v56, v56, v253
    v_mul_f32 v57, v57, v253
    v_mul_f32 v58, v58, v253
    v_mul_f32 v59, v59, v253
    v_mul_f32 v60, v60, v253
    v_mul_f32 v61, v61, v253
    v_mul_f32 v62, v62, v253
    v_mul_f32 v63, v63, v253
    s_nop 1
A_nors_62:
    s_branch A_nxt_61
A_msk_60:
    ds_read_b128 v[176:179], v241 offset:0
    ds_read_b128 v[180:183], v241 offset:2048
    ds_read_b128 v[184:187], v241 offset:4096
    ds_read_b128 v[188:191], v241 offset:6144
    ds_read_b128 v[192:195], v241 offset:8192
    ds_read_b128 v[196:199], v241 offset:10240
    ds_read_b128 v[200:203], v241 offset:12288
    ds_read_b128 v[204:207], v241 offset:14336
    ds_read_b128 v[208:211], v241 offset:1024
    ds_read_b128 v[212:215], v241 offset:3072
    ds_read_b128 v[216:219], v241 offset:5120
    ds_read_b128 v[220:223], v241 offset:7168
    ds_read_b128 v[224:227], v241 offset:9216
    ds_read_b128 v[228:231], v241 offset:11264
    ds_read_b128 v[232:235], v241 offset:13312
    ds_read_b128 v[236:239], v241 offset:15360
    v_fma_f32 v96, v96, s30, -v250
    v_fma_f32 v97, v97, s30, -v250
    v_fma_f32 v98, v98, s30, -v250
    v_exp_f32 v96, v96
    v_fma_f32 v99, v99, s30, -v250
    v_exp_f32 v97, v97
    v_fma_f32 v100, v100, s30, -v250
    v_exp_f32 v98, v98
    v_fma_f32 v101, v101, s30, -v250
    v_exp_f32 v99, v99
    s_waitcnt lgkmcnt(8)
    v_mfma_f32_32x32x16_bf16 v[64:79], v[176:179], v[128:131], 0
    v_cvt_pk_bf16_f32 v160, v96, v97
    v_fma_f32 v102, v102, s30, -v250
    v_exp_f32 v100, v100
    v_mfma_f32_32x32x16_bf16 v[64:79], v[180:183], v[132:135], v[64:79]
    v_fma_f32 v103, v103, s30, -v250
    v_exp_f32 v101, v101
    v_cvt_pk_bf16_f32 v161, v98, v99
    v_mfma_f32_32x32x16_bf16 v[64:79], v[184:187], v[136:139], v[64:79]
    v_fma_f32 v104, v104, s30, -v250
    v_exp_f32 v102, v102
    v_fma_f32 v105, v105, s30, -v250
    v_mfma_f32_32x32x16_bf16 v[64:79], v[188:191], v[140:143], v[64:79]
    v_exp_f32 v103, v103
    v_cvt_pk_bf16_f32 v162, v100, v101
    v_mfma_f32_32x32x16_bf16 v[64:79], v[192:195], v[144:147], v[64:79]
    v_fma_f32 v106, v106, s30, -v250
    v_exp_f32 v104, v104
    v_fma_f32 v107, v107, s30, -v250
    v_mfma_f32_32x32x16_bf16 v[64:79], v[196:199], v[148:151], v[64:79]
    v_exp_f32 v105, v105
    s_add_u32 m0, s31, 65536
    s_nop 0
    v_mfma_f32_32x32x16_bf16 v[64:79], v[200:203], v[152:155], v[64:79]
    buffer_load_dwordx4 v246, s[12:15], s33 offen lds
    buffer_load_dwordx4 v246, s[12:15], s33 offen offset:1024 lds
    buffer_load_dwordx4 v246, s[12:15], s33 offen offset:2048 lds
    v_mfma_f32_32x32x16_bf16 v[64:79], v[204:207], v[156:159], v[64:79]
    buffer_load_dwordx4 v246, s[12:15], s33 offen offset:3072 lds
    s_add_u32 s33, s33, 1048576
    s_waitcnt lgkmcnt(0)
    v_mfma_f32_32x32x16_bf16 v[80:95], v[208:211], v[128:131], 0
    ds_read_b128 v[176:179], v242 offset:0
    ds_read_b128 v[180:183], v242 offset:1024
    ds_read_b128 v[184:187], v242 offset:2048
    v_mfma_f32_32x32x16_bf16 v[80:95], v[212:215], v[132:135], v[80:95]
    ds_read_b128 v[188:191], v242 offset:3072
    ds_read_b128 v[192:195], v242 offset:4096
    ds_read_b128 v[196:199], v242 offset:5120
    v_mfma_f32_32x32x16_bf16 v[80:95], v[216:219], v[136:139], v[80:95]
    ds_read_b128 v[200:203], v242 offset:6144
    ds_read_b128 v[204:207], v242 offset:7168
    v_cvt_pk_bf16_f32 v163, v102, v103
    v_mfma_f32_32x32x16_bf16 v[80:95], v[220:223], v[140:143], v[80:95]
    v_fma_f32 v108, v108, s30, -v250
    v_exp_f32 v106, v106
    v_fma_f32 v109, v109, s30, -v250
    v_mfma_f32_32x32x16_bf16 v[80:95], v[224:227], v[144:147], v[80:95]
    v_exp_f32 v107, v107
    v_cvt_pk_bf16_f32 v164, v104, v105
    v_fma_f32 v110, v110, s30, -v250
    v_mfma_f32_32x32x16_bf16 v[80:95], v[228:231], v[148:151], v[80:95]
    v_exp_f32 v108, v108
    v_fma_f32 v111, v111, s30, -v250
    v_exp_f32 v109, v109
    v_mfma_f32_32x32x16_bf16 v[80:95], v[232:235], v[152:155], v[80:95]
    v_cvt_pk_bf16_f32 v165, v106, v107
    v_exp_f32 v110, v110
    v_exp_f32 v111, v111
    v_mfma_f32_32x32x16_bf16 v[80:95], v[236:239], v[156:159], v[80:95]
    v_cvt_pk_bf16_f32 v166, v108, v109
    v_cvt_pk_bf16_f32 v167, v110, v111
    s_waitcnt lgkmcnt(0)
    s_nop 1
    v_mfma_f32_32x32x16_bf16 v[0:15], v[176:179], v[160:163], v[0:15]
    ds_read_b128 v[208:211], v242 offset:8192
    ds_read_b128 v[212:215], v242 offset:9216
    ds_read_b128 v[216:219], v242 offset:10240
    ds_read_b128 v[220:223], v242 offset:11264
    ds_read_b128 v[224:227], v242 offset:12288
    ds_read_b128 v[228:231], v242 offset:13312
    v_mfma_f32_32x32x16_bf16 v[16:31], v[180:183], v[160:163], v[16:31]
    ds_read_b128 v[232:235], v242 offset:14336
    ds_read_b128 v[236:239], v242 offset:15360
    v_fma_f32 v112, v112, s30, -v250
    v_fma_f32 v113, v113, s30, -v250
    v_fma_f32 v114, v114, s30, -v250
    v_exp_f32 v112, v112
    v_mfma_f32_32x32x16_bf16 v[32:47], v[184:187], v[160:163], v[32:47]
    v_fma_f32 v115, v115, s30, -v250
    v_exp_f32 v113, v113
    v_fma_f32 v116, v116, s30, -v250
    v_exp_f32 v114, v114
    v_fma_f32 v117, v117, s30, -v250
    v_exp_f32 v115, v115
    v_mfma_f32_32x32x16_bf16 v[48:63], v[188:191], v[160:163], v[48:63]
    v_cvt_pk_bf16_f32 v168, v112, v113
    v_fma_f32 v118, v118, s30, -v250
    v_exp_f32 v116, v116
    v_fma_f32 v119, v119, s30, -v250
    v_exp_f32 v117, v117
    v_cvt_pk_bf16_f32 v169, v114, v115
    v_mfma_f32_32x32x16_bf16 v[0:15], v[192:195], v[164:167], v[0:15]
    v_fma_f32 v120, v120, s30, -v250
    v_exp_f32 v118, v118
    v_fma_f32 v121, v121, s30, -v250
    v_exp_f32 v119, v119
    v_cvt_pk_bf16_f32 v170, v116, v117
    v_fma_f32 v122, v122, s30, -v250
    v_mfma_f32_32x32x16_bf16 v[16:31], v[196:199], v[164:167], v[16:31]
    v_exp_f32 v120, v120
    v_fma_f32 v123, v123, s30, -v250
    v_exp_f32 v121, v121
    v_cvt_pk_bf16_f32 v171, v118, v119
    v_fma_f32 v124, v124, s30, -v250
    v_exp_f32 v122, v122
    v_mfma_f32_32x32x16_bf16 v[32:47], v[200:203], v[164:167], v[32:47]
    v_fma_f32 v125, v125, s30, -v250
    v_exp_f32 v123, v123
    v_cvt_pk_bf16_f32 v172, v120, v121
    v_fma_f32 v126, v126, s30, -v250
    v_exp_f32 v124, v124
    v_fma_f32 v127, v127, s30, -v250
    v_mfma_f32_32x32x16_bf16 v[48:63], v[204:207], v[164:167], v[48:63]
    v_exp_f32 v125, v125
    v_cvt_pk_bf16_f32 v173, v122, v123
    v_exp_f32 v126, v126
    v_exp_f32 v127, v127
    v_cvt_pk_bf16_f32 v174, v124, v125
    v_cvt_pk_bf16_f32 v175, v126, v127
    s_waitcnt lgkmcnt(0)
    s_nop 1
    v_mfma_f32_32x32x16_bf16 v[0:15], v[208:211], v[168:171], v[0:15]
    s_add_u32 m0, s31, 32768
    s_nop 0
    buffer_load_dwordx4 v244, s[8:11], s32 offen lds
    buffer_load_dwordx4 v244, s[8:11], s32 offen offset:1024 lds
    s_add_u32 m0, s31, 34816
    s_nop 0
    buffer_load_dwordx4 v245, s[8:11], s32 offen lds
    buffer_load_dwordx4 v245, s[8:11], s32 offen offset:1024 lds
    s_add_u32 s32, s32, 4096
    v_add_f32 v252, v96, v97
    v_add_f32 v252, v252, v98
    v_add_f32 v252, v252, v99
    v_add_f32 v252, v252, v100
    v_add_f32 v252, v252, v101
    v_add_f32 v252, v252, v102
    v_add_f32 v252, v252, v103
    v_add_f32 v252, v252, v104
    v_add_f32 v252, v252, v105
    v_add_f32 v252, v252, v106
    v_add_f32 v252, v252, v107
    v_add_f32 v252, v252, v108
    v_mfma_f32_32x32x16_bf16 v[16:31], v[212:215], v[168:171], v[16:31]
    v_add_f32 v252, v252, v109
    v_add_f32 v252, v252, v110
    v_add_f32 v252, v252, v111
    v_add_f32 v252, v252, v112
    v_add_f32 v252, v252, v113
    v_add_f32 v252, v252, v114
    v_add_f32 v252, v252, v115
    v_add_f32 v252, v252, v116
    v_add_f32 v252, v252, v117
    v_add_f32 v252, v252, v118
    v_add_f32 v252, v252, v119
    v_add_f32 v252, v252, v120
    v_add_f32 v252, v252, v121
    v_add_f32 v252, v252, v122
    v_add_f32 v252, v252, v123
    v_add_f32 v252, v252, v124
    v_add_f32 v252, v252, v125
    v_add_f32 v252, v252, v126
    v_add_f32 v252, v252, v127
    v_add_f32 v249, v249, v252
    v_mfma_f32_32x32x16_bf16 v[32:47], v[216:219], v[168:171], v[32:47]
    v_subrev_u32 v252, s37, v251
    v_mov_b32 v253, 0xff800000
    v_cmp_gt_i32 vcc, 0, v252
    s_nop 1
    v_cndmask_b32 v64, v64, v253, vcc
    v_cmp_gt_i32 vcc, 1, v252
    s_nop 1
    v_cndmask_b32 v65, v65, v253, vcc
    v_cmp_gt_i32 vcc, 2, v252
    s_nop 1
    v_cndmask_b32 v66, v66, v253, vcc
    v_cmp_gt_i32 vcc, 3, v252
    s_nop 1
    v_cndmask_b32 v67, v67, v253, vcc
    v_cmp_gt_i32 vcc, 8, v252
    s_nop 1
    v_cndmask_b32 v68, v68, v253, vcc
    v_cmp_gt_i32 vcc, 9, v252
    s_nop 1
    v_cndmask_b32 v69, v69, v253, vcc
    v_mfma_f32_32x32x16_bf16 v[48:63], v[220:223], v[168:171], v[48:63]
    v_cmp_gt_i32 vcc, 10, v252
    s_nop 1
    v_cndmask_b32 v70, v70, v253, vcc
    v_cmp_gt_i32 vcc, 11, v252
    s_nop 1
    v_cndmask_b32 v71, v71, v253, vcc
    v_cmp_gt_i32 vcc, 16, v252
    s_nop 1
    v_cndmask_b32 v72, v72, v253, vcc
    v_cmp_gt_i32 vcc, 17, v252
    s_nop 1
    v_cndmask_b32 v73, v73, v253, vcc
    v_cmp_gt_i32 vcc, 18, v252
    s_nop 1
    v_cndmask_b32 v74, v74, v253, vcc
    v_cmp_gt_i32 vcc, 19, v252
    s_nop 1
    v_cndmask_b32 v75, v75, v253, vcc
    v_cmp_gt_i32 vcc, 24, v252
    s_nop 1
    v_mfma_f32_32x32x16_bf16 v[0:15], v[224:227], v[172:175], v[0:15]
    v_cndmask_b32 v76, v76, v253, vcc
    v_cmp_gt_i32 vcc, 25, v252
    s_nop 1
    v_cndmask_b32 v77, v77, v253, vcc
    v_cmp_gt_i32 vcc, 26, v252
    s_nop 1
    v_cndmask_b32 v78, v78, v253, vcc
    v_cmp_gt_i32 vcc, 27, v252
    s_nop 1
    v_cndmask_b32 v79, v79, v253, vcc
    v_cmp_gt_i32 vcc, 32, v252
    s_nop 1
    v_cndmask_b32 v80, v80, v253, vcc
    v_cmp_gt_i32 vcc, 33, v252
    s_nop 1
    v_cndmask_b32 v81, v81, v253, vcc
    v_cmp_gt_i32 vcc, 34, v252
    s_nop 1
    v_cndmask_b32 v82, v82, v253, vcc
    v_cmp_gt_i32 vcc, 35, v252
    v_mfma_f32_32x32x16_bf16 v[16:31], v[228:231], v[172:175], v[16:31]
    s_nop 1
    v_cndmask_b32 v83, v83, v253, vcc
    v_cmp_gt_i32 vcc, 40, v252
    s_nop 1
    v_cndmask_b32 v84, v84, v253, vcc
    v_cmp_gt_i32 vcc, 41, v252
    s_nop 1
    v_cndmask_b32 v85, v85, v253, vcc
    v_cmp_gt_i32 vcc, 42, v252
    s_nop 1
    v_cndmask_b32 v86, v86, v253, vcc
    v_cmp_gt_i32 vcc, 43, v252
    s_nop 1
    v_cndmask_b32 v87, v87, v253, vcc
    v_cmp_gt_i32 vcc, 48, v252
    s_nop 1
    v_cndmask_b32 v88, v88, v253, vcc
    v_cmp_gt_i32 vcc, 49, v252
    s_nop 1
    v_cndmask_b32 v89, v89, v253, vcc
    v_mfma_f32_32x32x16_bf16 v[32:47], v[232:235], v[172:175], v[32:47]
    v_cmp_gt_i32 vcc, 50, v252
    s_nop 1
    v_cndmask_b32 v90, v90, v253, vcc
    v_cmp_gt_i32 vcc, 51, v252
    s_nop 1
    v_cndmask_b32 v91, v91, v253, vcc
    v_cmp_gt_i32 vcc, 56, v252
    s_nop 1
    v_cndmask_b32 v92, v92, v253, vcc
    v_cmp_gt_i32 vcc, 57, v252
    s_nop 1
    v_cndmask_b32 v93, v93, v253, vcc
    v_cmp_gt_i32 vcc, 58, v252
    s_nop 1
    v_cndmask_b32 v94, v94, v253, vcc
    v_cmp_gt_i32 vcc, 59, v252
    s_nop 1
    v_cndmask_b32 v95, v95, v253, vcc
    v_max3_f32 v252, v64, v65, v66
    v_max3_f32 v252, v252, v67, v68
    v_mfma_f32_32x32x16_bf16 v[48:63], v[236:239], v[172:175], v[48:63]
    v_max3_f32 v252, v252, v69, v70
    v_max3_f32 v252, v252, v71, v72
    v_max3_f32 v252, v252, v73, v74
    v_max3_f32 v252, v252, v75, v76
    v_max3_f32 v252, v252, v77, v78
    v_max3_f32 v252, v252, v79, v80
    v_max3_f32 v252, v252, v81, v82
    v_max3_f32 v252, v252, v83, v84
    v_max3_f32 v252, v252, v85, v86
    v_max3_f32 v252, v252, v87, v88
    v_max3_f32 v252, v252, v89, v90
    v_max3_f32 v252, v252, v91, v92
    v_max3_f32 v252, v252, v93, v94
    v_max_f32 v252, v252, v95
    v_mov_b32 v253, v252
    s_nop 1
    v_permlane32_swap_b32 v253, v252
    v_max_f32 v252, v252, v253
    v_sub_f32 v253, v252, v248
    v_cmp_lt_f32 vcc, s29, v253
    s_nop 0
    s_cbranch_vccz A_nors_63
    s_nop 15
    s_nop 15
    v_max_f32 v252, v252, v248
    v_sub_f32 v253, v248, v252
    v_mul_f32 v253, s30, v253
    v_exp_f32 v253, v253
    v_mov_b32 v248, v252
    v_mul_f32 v250, s30, v252
    v_mul_f32 v249, v249, v253
    v_mul_f32 v0, v0, v253
    v_mul_f32 v1, v1, v253
    v_mul_f32 v2, v2, v253
    v_mul_f32 v3, v3, v253
    v_mul_f32 v4, v4, v253
    v_mul_f32 v5, v5, v253
    v_mul_f32 v6, v6, v253
    v_mul_f32 v7, v7, v253
    v_mul_f32 v8, v8, v253
    v_mul_f32 v9, v9, v253
    v_mul_f32 v10, v10, v253
    v_mul_f32 v11, v11, v253
    v_mul_f32 v12, v12, v253
    v_mul_f32 v13, v13, v253
    v_mul_f32 v14, v14, v253
    v_mul_f32 v15, v15, v253
    v_mul_f32 v16, v16, v253
    v_mul_f32 v17, v17, v253
    v_mul_f32 v18, v18, v253
    v_mul_f32 v19, v19, v253
    v_mul_f32 v20, v20, v253
    v_mul_f32 v21, v21, v253
    v_mul_f32 v22, v22, v253
    v_mul_f32 v23, v23, v253
    v_mul_f32 v24, v24, v253
    v_mul_f32 v25, v25, v253
    v_mul_f32 v26, v26, v253
    v_mul_f32 v27, v27, v253
    v_mul_f32 v28, v28, v253
    v_mul_f32 v29, v29, v253
    v_mul_f32 v30, v30, v253
    v_mul_f32 v31, v31, v253
    v_mul_f32 v32, v32, v253
    v_mul_f32 v33, v33, v253
    v_mul_f32 v34, v34, v253
    v_mul_f32 v35, v35, v253
    v_mul_f32 v36, v36, v253
    v_mul_f32 v37, v37, v253
    v_mul_f32 v38, v38, v253
    v_mul_f32 v39, v39, v253
    v_mul_f32 v40, v40, v253
    v_mul_f32 v41, v41, v253
    v_mul_f32 v42, v42, v253
    v_mul_f32 v43, v43, v253
    v_mul_f32 v44, v44, v253
    v_mul_f32 v45, v45, v253
    v_mul_f32 v46, v46, v253
    v_mul_f32 v47, v47, v253
    v_mul_f32 v48, v48, v253
    v_mul_f32 v49, v49, v253
    v_mul_f32 v50, v50, v253
    v_mul_f32 v51, v51, v253
    v_mul_f32 v52, v52, v253
    v_mul_f32 v53, v53, v253
    v_mul_f32 v54, v54, v253
    v_mul_f32 v55, v55, v253
    v_mul_f32 v56, v56, v253
    v_mul_f32 v57, v57, v253
    v_mul_f32 v58, v58, v253
    v_mul_f32 v59, v59, v253
    v_mul_f32 v60, v60, v253
    v_mul_f32 v61, v61, v253
    v_mul_f32 v62, v62, v253
    v_mul_f32 v63, v63, v253
    s_nop 1
A_nors_63:
    s_branch A_nxt_61
A_last_59:
    ds_read_b128 v[176:179], v242 offset:0
    ds_read_b128 v[180:183], v242 offset:1024
    ds_read_b128 v[184:187], v242 offset:2048
    ds_read_b128 v[188:191], v242 offset:3072
    ds_read_b128 v[192:195], v242 offset:4096
    ds_read_b128 v[196:199], v242 offset:5120
    ds_read_b128 v[200:203], v242 offset:6144
    ds_read_b128 v[204:207], v242 offset:7168
    ds_read_b128 v[208:211], v242 offset:8192
    ds_read_b128 v[212:215], v242 offset:9216
    ds_read_b128 v[216:219], v242 offset:10240
    ds_read_b128 v[220:223], v242 offset:11264
    ds_read_b128 v[224:227], v242 offset:12288
    ds_read_b128 v[228:231], v242 offset:13312
    ds_read_b128 v[232:235], v242 offset:14336
    ds_read_b128 v[236:239], v242 offset:15360
    v_fma_f32 v96, v96, s30, -v250
    v_fma_f32 v97, v97, s30, -v250
    v_fma_f32 v98, v98, s30, -v250
    v_exp_f32 v96, v96
    v_fma_f32 v99, v99, s30, -v250
    v_exp_f32 v97, v97
    v_fma_f32 v100, v100, s30, -v250
    v_exp_f32 v98, v98
    v_fma_f32 v101, v101, s30, -v250
    v_exp_f32 v99, v99
    v_cvt_pk_bf16_f32 v160, v96, v97
    v_fma_f32 v102, v102, s30, -v250
    v_exp_f32 v100, v100
    v_fma_f32 v103, v103, s30, -v250
    v_exp_f32 v101, v101
    v_cvt_pk_bf16_f32 v161, v98, v99
    v_fma_f32 v104, v104, s30, -v250
    v_exp_f32 v102, v102
    v_fma_f32 v105, v105, s30, -v250
    v_exp_f32 v103, v103
    v_cvt_pk_bf16_f32 v162, v100, v101
    v_fma_f32 v106, v106, s30, -v250
    v_exp_f32 v104, v104
    v_fma_f32 v107, v107, s30, -v250
    v_exp_f32 v105, v105
    v_cvt_pk_bf16_f32 v163, v102, v103
    v_fma_f32 v108, v108, s30, -v250
    v_exp_f32 v106, v106
    v_fma_f32 v109, v109, s30, -v250
    v_exp_f32 v107, v107
    v_cvt_pk_bf16_f32 v164, v104, v105
    v_fma_f32 v110, v110, s30, -v250
    v_exp_f32 v108, v108
    v_fma_f32 v111, v111, s30, -v250
    v_exp_f32 v109, v109
    v_cvt_pk_bf16_f32 v165, v106, v107
    v_exp_f32 v110, v110
    v_exp_f32 v111, v111
    v_cvt_pk_bf16_f32 v166, v108, v109
    v_cvt_pk_bf16_f32 v167, v110, v111
    v_fma_f32 v112, v112, s30, -v250
    v_fma_f32 v113, v113, s30, -v250
    v_fma_f32 v114, v114, s30, -v250
    v_exp_f32 v112, v112
    v_fma_f32 v115, v115, s30, -v250
    v_exp_f32 v113, v113
    v_fma_f32 v116, v116, s30, -v250
    v_exp_f32 v114, v114
    v_fma_f32 v117, v117, s30, -v250
    v_exp_f32 v115, v115
    v_cvt_pk_bf16_f32 v168, v112, v113
    v_fma_f32 v118, v118, s30, -v250
    v_exp_f32 v116, v116
    v_fma_f32 v119, v119, s30, -v250
    v_exp_f32 v117, v117
    v_cvt_pk_bf16_f32 v169, v114, v115
    v_fma_f32 v120, v120, s30, -v250
    v_exp_f32 v118, v118
    v_fma_f32 v121, v121, s30, -v250
    v_exp_f32 v119, v119
    v_cvt_pk_bf16_f32 v170, v116, v117
    v_fma_f32 v122, v122, s30, -v250
    v_exp_f32 v120, v120
    v_fma_f32 v123, v123, s30, -v250
    v_exp_f32 v121, v121
    v_cvt_pk_bf16_f32 v171, v118, v119
    v_fma_f32 v124, v124, s30, -v250
    v_exp_f32 v122, v122
    v_fma_f32 v125, v125, s30, -v250
    v_exp_f32 v123, v123
    v_cvt_pk_bf16_f32 v172, v120, v121
    v_fma_f32 v126, v126, s30, -v250
    v_exp_f32 v124, v124
    v_fma_f32 v127, v127, s30, -v250
    v_exp_f32 v125, v125
    v_cvt_pk_bf16_f32 v173, v122, v123
    v_exp_f32 v126, v126
    v_exp_f32 v127, v127
    v_cvt_pk_bf16_f32 v174, v124, v125
    v_cvt_pk_bf16_f32 v175, v126, v127
    s_waitcnt lgkmcnt(0)
    s_nop 1
    v_mfma_f32_32x32x16_bf16 v[0:15], v[176:179], v[160:163], v[0:15]
    v_add_f32 v252, v96, v97
    v_add_f32 v252, v252, v98
    v_mfma_f32_32x32x16_bf16 v[16:31], v[180:183], v[160:163], v[16:31]
    v_add_f32 v252, v252, v99
    v_add_f32 v252, v252, v100
    v_mfma_f32_32x32x16_bf16 v[32:47], v[184:187], v[160:163], v[32:47]
    v_add_f32 v252, v252, v101
    v_add_f32 v252, v252, v102
    v_mfma_f32_32x32x16_bf16 v[48:63], v[188:191], v[160:163], v[48:63]
    v_add_f32 v252, v252, v103
    v_add_f32 v252, v252, v104
    v_mfma_f32_32x32x16_bf16 v[0:15], v[192:195], v[164:167], v[0:15]
    v_add_f32 v252, v252, v105
    v_add_f32 v252, v252, v106
    v_mfma_f32_32x32x16_bf16 v[16:31], v[196:199], v[164:167], v[16:31]
    v_add_f32 v252, v252, v107
    v_add_f32 v252, v252, v108
    v_mfma_f32_32x32x16_bf16 v[32:47], v[200:203], v[164:167], v[32:47]
    v_add_f32 v252, v252, v109
    v_add_f32 v252, v252, v110
    v_mfma_f32_32x32x16_bf16 v[48:63], v[204:207], v[164:167], v[48:63]
    v_add_f32 v252, v252, v111
    v_add_f32 v252, v252, v112
    v_mfma_f32_32x32x16_bf16 v[0:15], v[208:211], v[168:171], v[0:15]
    v_add_f32 v252, v252, v113
    v_add_f32 v252, v252, v114
    v_mfma_f32_32x32x16_bf16 v[16:31], v[212:215], v[168:171], v[16:31]
    v_add_f32 v252, v252, v115
    v_add_f32 v252, v252, v116
    v_mfma_f32_32x32x16_bf16 v[32:47], v[216:219], v[168:171], v[32:47]
    v_add_f32 v252, v252, v117
    v_add_f32 v252, v252, v118
    v_mfma_f32_32x32x16_bf16 v[48:63], v[220:223], v[168:171], v[48:63]
    v_add_f32 v252, v252, v119
    v_add_f32 v252, v252, v120
    v_mfma_f32_32x32x16_bf16 v[0:15], v[224:227], v[172:175], v[0:15]
    v_add_f32 v252, v252, v121
    v_add_f32 v252, v252, v122
    v_mfma_f32_32x32x16_bf16 v[16:31], v[228:231], v[172:175], v[16:31]
    v_add_f32 v252, v252, v123
    v_add_f32 v252, v252, v124
    v_mfma_f32_32x32x16_bf16 v[32:47], v[232:235], v[172:175], v[32:47]
    v_add_f32 v252, v252, v125
    v_add_f32 v252, v252, v126
    v_mfma_f32_32x32x16_bf16 v[48:63], v[236:239], v[172:175], v[48:63]
    v_add_f32 v252, v252, v127
    v_add_f32 v249, v249, v252
    s_branch A_fin_53
A_nxt_61:
    s_add_u32 s35, s35, 1
    s_branch A_loop_52
A_fin_53:
    s_nop 15
    s_nop 7
    s_waitcnt vmcnt(0)
    s_barrier
    v_and_b32 v176, 63, v243
    v_lshlrev_b32 v176, 4, v176
    s_mul_i32 s27, s25, 17408
    v_add_u32 v176, s27, v176
    s_cmp_eq_u32 s66, 0
    s_cbranch_scc1 A_g0_64
    ds_write_b128 v176, v[0:3] offset:0
    ds_write_b128 v176, v[4:7] offset:1024
    ds_write_b128 v176, v[8:11] offset:2048
    ds_write_b128 v176, v[12:15] offset:3072
    ds_write_b128 v176, v[16:19] offset:4096
    ds_write_b128 v176, v[20:23] offset:5120
    ds_write_b128 v176, v[24:27] offset:6144
    ds_write_b128 v176, v[28:31] offset:7168
    ds_write_b128 v176, v[32:35] offset:8192
    ds_write_b128 v176, v[36:39] offset:9216
    ds_write_b128 v176, v[40:43] offset:10240
    ds_write_b128 v176, v[44:47] offset:11264
    ds_write_b128 v176, v[48:51] offset:12288
    ds_write_b128 v176, v[52:55] offset:13312
    ds_write_b128 v176, v[56:59] offset:14336
    ds_write_b128 v176, v[60:63] offset:15360
    v_mov_b32 v180, v248
    v_mov_b32 v181, v249
    ds_write_b64 v176, v[180:181] offset:16384
    s_waitcnt lgkmcnt(0)
    s_barrier
    s_branch A_mg_65
A_g0_64:
    s_barrier
    ds_read_b128 v[64:67], v176 offset:0
    ds_read_b128 v[68:71], v176 offset:1024
    ds_read_b128 v[72:75], v176 offset:2048
    ds_read_b128 v[76:79], v176 offset:3072
    ds_read_b128 v[80:83], v176 offset:4096
    ds_read_b128 v[84:87], v176 offset:5120
    ds_read_b128 v[88:91], v176 offset:6144
    ds_read_b128 v[92:95], v176 offset:7168
    ds_read_b128 v[96:99], v176 offset:8192
    ds_read_b128 v[100:103], v176 offset:9216
    ds_read_b128 v[104:107], v176 offset:10240
    ds_read_b128 v[108:111], v176 offset:11264
    ds_read_b128 v[112:115], v176 offset:12288
    ds_read_b128 v[116:119], v176 offset:13312
    ds_read_b128 v[120:123], v176 offset:14336
    ds_read_b128 v[124:127], v176 offset:15360
    ds_read_b64 v[180:181], v176 offset:16384
    s_waitcnt lgkmcnt(0)
    v_max_f32 v252, v248, v180
    v_sub_f32 v182, v248, v252
    v_sub_f32 v183, v180, v252
    v_mul_f32 v182, s30, v182
    v_mul_f32 v183, s30, v183
    v_exp_f32 v182, v182
    v_exp_f32 v183, v183
    s_nop 0
    v_mul_f32 v249, v249, v182
    v_fmac_f32 v249, v181, v183
    v_mov_b32 v252, v249
    s_nop 1
    v_permlane32_swap_b32 v252, v249
    v_add_f32 v252, v252, v249
    v_rcp_f32 v252, v252
    s_nop 0
    v_mul_f32 v182, v182, v252
    v_mul_f32 v183, v183, v252
    v_add_u32 v253, s39, v240
    v_mul_f32 v0, v0, v182
    v_fmac_f32 v0, v64, v183
    v_mul_f32 v1, v1, v182
    v_fmac_f32 v1, v65, v183
    v_mul_f32 v2, v2, v182
    v_fmac_f32 v2, v66, v183
    v_mul_f32 v3, v3, v182
    v_fmac_f32 v3, v67, v183
    v_mul_f32 v4, v4, v182
    v_fmac_f32 v4, v68, v183
    v_mul_f32 v5, v5, v182
    v_fmac_f32 v5, v69, v183
    v_mul_f32 v6, v6, v182
    v_fmac_f32 v6, v70, v183
    v_mul_f32 v7, v7, v182
    v_fmac_f32 v7, v71, v183
    v_mul_f32 v8, v8, v182
    v_fmac_f32 v8, v72, v183
    v_mul_f32 v9, v9, v182
    v_fmac_f32 v9, v73, v183
    v_mul_f32 v10, v10, v182
    v_fmac_f32 v10, v74, v183
    v_mul_f32 v11, v11, v182
    v_fmac_f32 v11, v75, v183
    v_mul_f32 v12, v12, v182
    v_fmac_f32 v12, v76, v183
    v_mul_f32 v13, v13, v182
    v_fmac_f32 v13, v77, v183
    v_mul_f32 v14, v14, v182
    v_fmac_f32 v14, v78, v183
    v_mul_f32 v15, v15, v182
    v_fmac_f32 v15, v79, v183
    v_mul_f32 v16, v16, v182
    v_fmac_f32 v16, v80, v183
    v_mul_f32 v17, v17, v182
    v_fmac_f32 v17, v81, v183
    v_mul_f32 v18, v18, v182
    v_fmac_f32 v18, v82, v183
    v_mul_f32 v19, v19, v182
    v_fmac_f32 v19, v83, v183
    v_mul_f32 v20, v20, v182
    v_fmac_f32 v20, v84, v183
    v_mul_f32 v21, v21, v182
    v_fmac_f32 v21, v85, v183
    v_mul_f32 v22, v22, v182
    v_fmac_f32 v22, v86, v183
    v_mul_f32 v23, v23, v182
    v_fmac_f32 v23, v87, v183
    v_mul_f32 v24, v24, v182
    v_fmac_f32 v24, v88, v183
    v_mul_f32 v25, v25, v182
    v_fmac_f32 v25, v89, v183
    v_mul_f32 v26, v26, v182
    v_fmac_f32 v26, v90, v183
    v_mul_f32 v27, v27, v182
    v_fmac_f32 v27, v91, v183
    v_mul_f32 v28, v28, v182
    v_fmac_f32 v28, v92, v183
    v_mul_f32 v29, v29, v182
    v_fmac_f32 v29, v93, v183
    v_mul_f32 v30, v30, v182
    v_fmac_f32 v30, v94, v183
    v_mul_f32 v31, v31, v182
    v_fmac_f32 v31, v95, v183
    v_mul_f32 v32, v32, v182
    v_fmac_f32 v32, v96, v183
    v_mul_f32 v33, v33, v182
    v_fmac_f32 v33, v97, v183
    v_mul_f32 v34, v34, v182
    v_fmac_f32 v34, v98, v183
    v_mul_f32 v35, v35, v182
    v_fmac_f32 v35, v99, v183
    v_mul_f32 v36, v36, v182
    v_fmac_f32 v36, v100, v183
    v_mul_f32 v37, v37, v182
    v_fmac_f32 v37, v101, v183
    v_mul_f32 v38, v38, v182
    v_fmac_f32 v38, v102, v183
    v_mul_f32 v39, v39, v182
    v_fmac_f32 v39, v103, v183
    v_mul_f32 v40, v40, v182
    v_fmac_f32 v40, v104, v183
    v_mul_f32 v41, v41, v182
    v_fmac_f32 v41, v105, v183
    v_mul_f32 v42, v42, v182
    v_fmac_f32 v42, v106, v183
    v_mul_f32 v43, v43, v182
    v_fmac_f32 v43, v107, v183
    v_mul_f32 v44, v44, v182
    v_fmac_f32 v44, v108, v183
    v_mul_f32 v45, v45, v182
    v_fmac_f32 v45, v109, v183
    v_mul_f32 v46, v46, v182
    v_fmac_f32 v46, v110, v183
    v_mul_f32 v47, v47, v182
    v_fmac_f32 v47, v111, v183
    v_mul_f32 v48, v48, v182
    v_fmac_f32 v48, v112, v183
    v_mul_f32 v49, v49, v182
    v_fmac_f32 v49, v113, v183
    v_mul_f32 v50, v50, v182
    v_fmac_f32 v50, v114, v183
    v_mul_f32 v51, v51, v182
    v_fmac_f32 v51, v115, v183
    v_mul_f32 v52, v52, v182
    v_fmac_f32 v52, v116, v183
    v_mul_f32 v53, v53, v182
    v_fmac_f32 v53, v117, v183
    v_mul_f32 v54, v54, v182
    v_fmac_f32 v54, v118, v183
    v_mul_f32 v55, v55, v182
    v_fmac_f32 v55, v119, v183
    v_mul_f32 v56, v56, v182
    v_fmac_f32 v56, v120, v183
    v_mul_f32 v57, v57, v182
    v_fmac_f32 v57, v121, v183
    v_mul_f32 v58, v58, v182
    v_fmac_f32 v58, v122, v183
    v_mul_f32 v59, v59, v182
    v_fmac_f32 v59, v123, v183
    v_mul_f32 v60, v60, v182
    v_fmac_f32 v60, v124, v183
    v_mul_f32 v61, v61, v182
    v_fmac_f32 v61, v125, v183
    v_mul_f32 v62, v62, v182
    v_fmac_f32 v62, v126, v183
    v_mul_f32 v63, v63, v182
    v_fmac_f32 v63, v127, v183
    v_cvt_pk_bf16_f32 v208, v0, v1
    v_cvt_pk_bf16_f32 v209, v2, v3
    v_cvt_pk_bf16_f32 v210, v4, v5
    v_cvt_pk_bf16_f32 v211, v6, v7
    s_mov_b32 s28, 0
    buffer_store_dwordx4 v[208:211], v253, s[16:19], s28 offen
    v_cvt_pk_bf16_f32 v212, v8, v9
    v_cvt_pk_bf16_f32 v213, v10, v11
    v_cvt_pk_bf16_f32 v214, v12, v13
    v_cvt_pk_bf16_f32 v215, v14, v15
    s_mov_b32 s28, 65536
    buffer_store_dwordx4 v[212:215], v253, s[16:19], s28 offen
    v_cvt_pk_bf16_f32 v216, v16, v17
    v_cvt_pk_bf16_f32 v217, v18, v19
    v_cvt_pk_bf16_f32 v218, v20, v21
    v_cvt_pk_bf16_f32 v219, v22, v23
    s_mov_b32 s28, 131072
    buffer_store_dwordx4 v[216:219], v253, s[16:19], s28 offen
    v_cvt_pk_bf16_f32 v220, v24, v25
    v_cvt_pk_bf16_f32 v221, v26, v27
    v_cvt_pk_bf16_f32 v222, v28, v29
    v_cvt_pk_bf16_f32 v223, v30, v31
    s_mov_b32 s28, 196608
    buffer_store_dwordx4 v[220:223], v253, s[16:19], s28 offen
    v_cvt_pk_bf16_f32 v208, v32, v33
    v_cvt_pk_bf16_f32 v209, v34, v35
    v_cvt_pk_bf16_f32 v210, v36, v37
    v_cvt_pk_bf16_f32 v211, v38, v39
    s_mov_b32 s28, 262144
    buffer_store_dwordx4 v[208:211], v253, s[16:19], s28 offen
    v_cvt_pk_bf16_f32 v212, v40, v41
    v_cvt_pk_bf16_f32 v213, v42, v43
    v_cvt_pk_bf16_f32 v214, v44, v45
    v_cvt_pk_bf16_f32 v215, v46, v47
    s_mov_b32 s28, 327680
    buffer_store_dwordx4 v[212:215], v253, s[16:19], s28 offen
    v_cvt_pk_bf16_f32 v216, v48, v49
    v_cvt_pk_bf16_f32 v217, v50, v51
    v_cvt_pk_bf16_f32 v218, v52, v53
    v_cvt_pk_bf16_f32 v219, v54, v55
    s_mov_b32 s28, 393216
    buffer_store_dwordx4 v[216:219], v253, s[16:19], s28 offen
    v_cvt_pk_bf16_f32 v220, v56, v57
    v_cvt_pk_bf16_f32 v221, v58, v59
    v_cvt_pk_bf16_f32 v222, v60, v61
    v_cvt_pk_bf16_f32 v223, v62, v63
    s_mov_b32 s28, 458752
    buffer_store_dwordx4 v[220:223], v253, s[16:19], s28 offen
A_mg_65:
    s_cmp_lg_u32 s60, 0
    s_cbranch_scc1 A_done_47
    s_mov_b32 s60, 1
    s_barrier
    s_branch A_pass_48
A_done_47:
    s_endpgm
.globl final_kernel
.type final_kernel,@function
.p2align 8
final_kernel:
    s_load_dwordx2 s[42:43], s[0:1], 40
    s_load_dwordx2 s[44:45], s[0:1], 72
    s_load_dwordx2 s[52:53], s[0:1], 104
    s_cmp_ge_u32 s2, 240
    s_cbranch_scc1 F_done_66
    s_and_b32 s20, s2, 7
    s_lshr_b32 s21, s2, 3
    s_mul_hi_u32 s36, s21, 0x55555556
    s_mul_i32 s37, s36, 3
    s_sub_u32 s37, s21, s37
    s_and_b32 s22, s36, 1
    s_lshl_b32 s20, s20, 1
    s_add_u32 s22, s22, s20
    s_lshl_b32 s22, s22, 7
    s_lshr_b32 s23, s36, 1
    s_lshl_b32 s23, s23, 7
    s_waitcnt lgkmcnt(0)
    v_mov_b32 v140, v0
    v_and_b32 v112, 63, v140
    v_lshrrev_b32 v113, 6, v140
    s_nop 0
    v_readfirstlane_b32 s24, v113
    s_lshr_b32 s27, s24, 1
    s_and_b32 s28, s24, 1
    v_and_b32 v114, 31, v112
    s_mul_i32 s25, s27, 64
    v_add_u32 v114, s25, v114
    v_lshlrev_b32 v114, 5, v114
    v_lshrrev_b32 v115, 5, v112
    v_bfe_u32 v116, v112, 3, 1
    v_xor_b32 v116, v115, v116
    v_lshl_add_u32 v96, v116, 4, v114
    v_add_u32 v97, 16384, v96
    v_add_u32 v98, 32768, v96
    v_add_u32 v99, 49152, v96
    v_bfe_u32 v117, v112, 2, 2
    v_lshl_add_u32 v118, v115, 2, v117
    v_mul_u32_u24 v118, 256, v118
    v_bfe_u32 v119, v112, 4, 1
    v_lshlrev_b32 v119, 1, v119
    v_bfe_u32 v120, v112, 1, 1
    v_add_u32 v119, v119, v120
    s_mul_i32 s25, s28, 8
    v_add_u32 v119, s25, v119
    v_lshlrev_b32 v120, 2, v117
    v_and_b32 v121, 1, v112
    v_lshlrev_b32 v121, 3, v121
    v_add_u32 v118, v118, v121
    v_add_u32 v118, 8192, v118
    v_add_u32 v121, 0, v119
    v_xor_b32 v121, v121, v120
    v_lshl_add_u32 v100, v121, 4, v118
    v_add_u32 v102, 16384, v100
    v_add_u32 v104, 32768, v100
    v_add_u32 v106, 49152, v100
    v_add_u32 v121, 4, v119
    v_xor_b32 v121, v121, v120
    v_lshl_add_u32 v101, v121, 4, v118
    v_add_u32 v103, 16384, v101
    v_add_u32 v105, 32768, v101
    v_add_u32 v107, 49152, v101
    s_mul_i32 s30, s24, 2048
    s_mul_i32 s31, s24, 2048
    s_add_u32 s31, s31, 8192
    v_mov_b32 v0, 0
    v_mov_b32 v1, 0
    v_mov_b32 v2, 0
    v_mov_b32 v3, 0
    v_mov_b32 v4, 0
    v_mov_b32 v5, 0
    v_mov_b32 v6, 0
    v_mov_b32 v7, 0
    v_mov_b32 v8, 0
    v_mov_b32 v9, 0
    v_mov_b32 v10, 0
    v_mov_b32 v11, 0
    v_mov_b32 v12, 0
    v_mov_b32 v13, 0
    v_mov_b32 v14, 0
    v_mov_b32 v15, 0
    v_mov_b32 v16, 0
    v_mov_b32 v17, 0
    v_mov_b32 v18, 0
    v_mov_b32 v19, 0
    v_mov_b32 v20, 0
    v_mov_b32 v21, 0
    v_mov_b32 v22, 0
    v_mov_b32 v23, 0
    v_mov_b32 v24, 0
    v_mov_b32 v25, 0
    v_mov_b32 v26, 0
    v_mov_b32 v27, 0
    v_mov_b32 v28, 0
    v_mov_b32 v29, 0
    v_mov_b32 v30, 0
    v_mov_b32 v31, 0
    v_mov_b32 v32, 0
    v_mov_b32 v33, 0
    v_mov_b32 v34, 0
    v_mov_b32 v35, 0
    v_mov_b32 v36, 0
    v_mov_b32 v37, 0
    v_mov_b32 v38, 0
    v_mov_b32 v39, 0
    v_mov_b32 v40, 0
    v_mov_b32 v41, 0
    v_mov_b32 v42, 0
    v_mov_b32 v43, 0
    v_mov_b32 v44, 0
    v_mov_b32 v45, 0
    v_mov_b32 v46, 0
    v_mov_b32 v47, 0
    v_mov_b32 v48, 0
    v_mov_b32 v49, 0
    v_mov_b32 v50, 0
    v_mov_b32 v51, 0
    v_mov_b32 v52, 0
    v_mov_b32 v53, 0
    v_mov_b32 v54, 0
    v_mov_b32 v55, 0
    v_mov_b32 v56, 0
    v_mov_b32 v57, 0
    v_mov_b32 v58, 0
    v_mov_b32 v59, 0
    v_mov_b32 v60, 0
    v_mov_b32 v61, 0
    v_mov_b32 v62, 0
    v_mov_b32 v63, 0
    s_add_u32 s4, s52, 0x5000000
    s_addc_u32 s5, s53, 0
    s_and_b32 s5, s5, 0xffff
    s_mov_b32 s6, 0x1000000
    s_mov_b32 s7, 0x00020000
    s_mov_b32 s8, s42
    s_and_b32 s9, s43, 0xffff
    s_mov_b32 s10, 0x500000
    s_mov_b32 s11, 0x00020000
    v_lshlrev_b32 v116, 4, v112
    s_mul_i32 s25, s24, 2
    s_add_u32 s25, s25, 0
    s_lshr_b32 s26, s25, 2
    s_and_b32 s25, s25, 3
    s_mul_i32 s26, s26, 2048
    s_lshl_b32 s25, s25, 5
    s_add_u32 s25, s25, s26
    s_add_u32 s25, s25, s22
    s_lshl_b32 s25, s25, 5
    v_add_u32 v108, s25, v116
    s_mul_i32 s25, s24, 2
    s_add_u32 s25, s25, 1
    s_lshr_b32 s26, s25, 2
    s_and_b32 s25, s25, 3
    s_mul_i32 s26, s26, 2048
    s_lshl_b32 s25, s25, 5
    s_add_u32 s25, s25, s26
    s_add_u32 s25, s25, s22
    s_lshl_b32 s25, s25, 5
    v_add_u32 v109, s25, v116
    s_mov_b32 s26, 1280
    s_lshl_b32 s29, s23, 1
    s_mul_i32 s25, s24, 8
    s_add_u32 s25, s25, 0
    v_lshrrev_b32 v116, 4, v112
    v_add_u32 v116, s25, v116
    v_and_b32 v117, 3, v116
    v_lshlrev_b32 v117, 2, v117
    v_and_b32 v118, 15, v112
    v_xor_b32 v117, v117, v118
    v_mul_lo_u32 v116, v116, s26
    v_lshl_add_u32 v116, v117, 4, v116
    v_add_u32 v110, s29, v116
    s_mul_i32 s25, s24, 8
    s_add_u32 s25, s25, 4
    v_lshrrev_b32 v116, 4, v112
    v_add_u32 v116, s25, v116
    v_and_b32 v117, 3, v116
    v_lshlrev_b32 v117, 2, v117
    v_and_b32 v118, 15, v112
    v_xor_b32 v117, v117, v118
    v_mul_lo_u32 v116, v116, s26
    v_lshl_add_u32 v116, v117, 4, v116
    v_add_u32 v111, s29, v116
    s_mul_i32 s38, s37, 60
    s_mul_i32 s39, s38, 131072
    s_mul_i32 s38, s38, 40960
    s_cmp_eq_u32 s37, 2
    s_cselect_b32 s54, 8, 60
    s_mov_b32 s32, s39
    s_mov_b32 s33, s38
    s_add_u32 m0, s30, 0
    s_nop 0
    buffer_load_dwordx4 v108, s[4:7], s32 offen lds
    s_add_u32 m0, s30, 1024
    s_nop 0
    buffer_load_dwordx4 v109, s[4:7], s32 offen lds
    s_add_u32 m0, s31, 0
    s_nop 0
    buffer_load_dwordx4 v110, s[8:11], s33 offen lds
    s_add_u32 m0, s31, 1024
    s_nop 0
    buffer_load_dwordx4 v111, s[8:11], s33 offen lds
    s_add_u32 s32, s32, 131072
    s_add_u32 s33, s33, 40960
    s_add_u32 m0, s30, 16384
    s_nop 0
    buffer_load_dwordx4 v108, s[4:7], s32 offen lds
    s_add_u32 m0, s30, 17408
    s_nop 0
    buffer_load_dwordx4 v109, s[4:7], s32 offen lds
    s_add_u32 m0, s31, 16384
    s_nop 0
    buffer_load_dwordx4 v110, s[8:11], s33 offen lds
    s_add_u32 m0, s31, 17408
    s_nop 0
    buffer_load_dwordx4 v111, s[8:11], s33 offen lds
    s_add_u32 s32, s32, 131072
    s_add_u32 s33, s33, 40960
    s_add_u32 m0, s30, 32768
    s_nop 0
    buffer_load_dwordx4 v108, s[4:7], s32 offen lds
    s_add_u32 m0, s30, 33792
    s_nop 0
    buffer_load_dwordx4 v109, s[4:7], s32 offen lds
    s_add_u32 m0, s31, 32768
    s_nop 0
    buffer_load_dwordx4 v110, s[8:11], s33 offen lds
    s_add_u32 m0, s31, 33792
    s_nop 0
    buffer_load_dwordx4 v111, s[8:11], s33 offen lds
    s_add_u32 s32, s32, 131072
    s_add_u32 s33, s33, 40960
    s_add_u32 m0, s30, 49152
    s_nop 0
    buffer_load_dwordx4 v108, s[4:7], s32 offen lds
    s_add_u32 m0, s30, 50176
    s_nop 0
    buffer_load_dwordx4 v109, s[4:7], s32 offen lds
    s_add_u32 m0, s31, 49152
    s_nop 0
    buffer_load_dwordx4 v110, s[8:11], s33 offen lds
    s_add_u32 m0, s31, 50176
    s_nop 0
    buffer_load_dwordx4 v111, s[8:11], s33 offen lds
    s_add_u32 s32, s32, 131072
    s_add_u32 s33, s33, 40960
    s_waitcnt vmcnt(12)
    s_barrier
    ds_read_b64_tr_b16 v[72:73], v100 offset:0
    ds_read_b64_tr_b16 v[74:75], v100 offset:2048
    ds_read_b64_tr_b16 v[76:77], v101 offset:0
    ds_read_b64_tr_b16 v[78:79], v101 offset:2048
    ds_read_b128 v[64:67], v96 offset:0
    ds_read_b128 v[68:71], v96 offset:1024
    s_mov_b32 s34, 0
G_loop_68:
    s_waitcnt lgkmcnt(0)
    v_mfma_f32_32x32x16_bf16 v[0:15], v[72:75], v[64:67], v[0:15]
    ds_read_b64_tr_b16 v[88:89], v100 offset:4096
    ds_read_b64_tr_b16 v[90:91], v100 offset:6144
    ds_read_b64_tr_b16 v[92:93], v101 offset:4096
    v_mfma_f32_32x32x16_bf16 v[16:31], v[76:79], v[64:67], v[16:31]
    ds_read_b64_tr_b16 v[94:95], v101 offset:6144
    ds_read_b128 v[80:83], v96 offset:4096
    ds_read_b128 v[84:87], v96 offset:5120
    v_mfma_f32_32x32x16_bf16 v[32:47], v[72:75], v[68:71], v[32:47]
    v_mfma_f32_32x32x16_bf16 v[48:63], v[76:79], v[68:71], v[48:63]
    s_add_u32 s35, s34, 4
    s_cmp_ge_u32 s35, s54
    s_cbranch_scc1 G_tail_70
    s_waitcnt vmcnt(8) lgkmcnt(0)
    s_barrier
    v_mfma_f32_32x32x16_bf16 v[0:15], v[88:91], v[80:83], v[0:15]
    ds_read_b64_tr_b16 v[72:73], v102 offset:0
    s_add_u32 m0, s30, 0
    s_nop 0
    buffer_load_dwordx4 v108, s[4:7], s32 offen lds
    ds_read_b64_tr_b16 v[74:75], v102 offset:2048
    s_add_u32 m0, s30, 1024
    s_nop 0
    buffer_load_dwordx4 v109, s[4:7], s32 offen lds
    ds_read_b64_tr_b16 v[76:77], v103 offset:0
    v_mfma_f32_32x32x16_bf16 v[16:31], v[92:95], v[80:83], v[16:31]
    s_add_u32 m0, s31, 0
    s_nop 0
    buffer_load_dwordx4 v110, s[8:11], s33 offen lds
    ds_read_b64_tr_b16 v[78:79], v103 offset:2048
    s_add_u32 m0, s31, 1024
    s_nop 0
    buffer_load_dwordx4 v111, s[8:11], s33 offen lds
    s_add_u32 s32, s32, 131072
    s_add_u32 s33, s33, 40960
    ds_read_b128 v[64:67], v97 offset:0
    ds_read_b128 v[68:71], v97 offset:1024
    v_mfma_f32_32x32x16_bf16 v[32:47], v[88:91], v[84:87], v[32:47]
    v_mfma_f32_32x32x16_bf16 v[48:63], v[92:95], v[84:87], v[48:63]
    s_branch G_cont_71
G_tail_70:
    s_waitcnt vmcnt(0) lgkmcnt(0)
    s_barrier
    v_mfma_f32_32x32x16_bf16 v[0:15], v[88:91], v[80:83], v[0:15]
    ds_read_b64_tr_b16 v[72:73], v102 offset:0
    ds_read_b64_tr_b16 v[74:75], v102 offset:2048
    ds_read_b64_tr_b16 v[76:77], v103 offset:0
    v_mfma_f32_32x32x16_bf16 v[16:31], v[92:95], v[80:83], v[16:31]
    ds_read_b64_tr_b16 v[78:79], v103 offset:2048
    ds_read_b128 v[64:67], v97 offset:0
    ds_read_b128 v[68:71], v97 offset:1024
    v_mfma_f32_32x32x16_bf16 v[32:47], v[88:91], v[84:87], v[32:47]
    v_mfma_f32_32x32x16_bf16 v[48:63], v[92:95], v[84:87], v[48:63]
G_cont_71:
    s_add_u32 s34, s34, 1
    s_cmp_ge_u32 s34, s54
    s_cbranch_scc1 G_end_69
    s_waitcnt lgkmcnt(0)
    v_mfma_f32_32x32x16_bf16 v[0:15], v[72:75], v[64:67], v[0:15]
    ds_read_b64_tr_b16 v[88:89], v102 offset:4096
    ds_read_b64_tr_b16 v[90:91], v102 offset:6144
    ds_read_b64_tr_b16 v[92:93], v103 offset:4096
    v_mfma_f32_32x32x16_bf16 v[16:31], v[76:79], v[64:67], v[16:31]
    ds_read_b64_tr_b16 v[94:95], v103 offset:6144
    ds_read_b128 v[80:83], v97 offset:4096
    ds_read_b128 v[84:87], v97 offset:5120
    v_mfma_f32_32x32x16_bf16 v[32:47], v[72:75], v[68:71], v[32:47]
    v_mfma_f32_32x32x16_bf16 v[48:63], v[76:79], v[68:71], v[48:63]
    s_add_u32 s35, s34, 4
    s_cmp_ge_u32 s35, s54
    s_cbranch_scc1 G_tail_72
    s_waitcnt vmcnt(8) lgkmcnt(0)
    s_barrier
    v_mfma_f32_32x32x16_bf16 v[0:15], v[88:91], v[80:83], v[0:15]
    ds_read_b64_tr_b16 v[72:73], v104 offset:0
    s_add_u32 m0, s30, 16384
    s_nop 0
    buffer_load_dwordx4 v108, s[4:7], s32 offen lds
    ds_read_b64_tr_b16 v[74:75], v104 offset:2048
    s_add_u32 m0, s30, 17408
    s_nop 0
    buffer_load_dwordx4 v109, s[4:7], s32 offen lds
    ds_read_b64_tr_b16 v[76:77], v105 offset:0
    v_mfma_f32_32x32x16_bf16 v[16:31], v[92:95], v[80:83], v[16:31]
    s_add_u32 m0, s31, 16384
    s_nop 0
    buffer_load_dwordx4 v110, s[8:11], s33 offen lds
    ds_read_b64_tr_b16 v[78:79], v105 offset:2048
    s_add_u32 m0, s31, 17408
    s_nop 0
    buffer_load_dwordx4 v111, s[8:11], s33 offen lds
    s_add_u32 s32, s32, 131072
    s_add_u32 s33, s33, 40960
    ds_read_b128 v[64:67], v98 offset:0
    ds_read_b128 v[68:71], v98 offset:1024
    v_mfma_f32_32x32x16_bf16 v[32:47], v[88:91], v[84:87], v[32:47]
    v_mfma_f32_32x32x16_bf16 v[48:63], v[92:95], v[84:87], v[48:63]
    s_branch G_cont_73
G_tail_72:
    s_waitcnt vmcnt(0) lgkmcnt(0)
    s_barrier
    v_mfma_f32_32x32x16_bf16 v[0:15], v[88:91], v[80:83], v[0:15]
    ds_read_b64_tr_b16 v[72:73], v104 offset:0
    ds_read_b64_tr_b16 v[74:75], v104 offset:2048
    ds_read_b64_tr_b16 v[76:77], v105 offset:0
    v_mfma_f32_32x32x16_bf16 v[16:31], v[92:95], v[80:83], v[16:31]
    ds_read_b64_tr_b16 v[78:79], v105 offset:2048
    ds_read_b128 v[64:67], v98 offset:0
    ds_read_b128 v[68:71], v98 offset:1024
    v_mfma_f32_32x32x16_bf16 v[32:47], v[88:91], v[84:87], v[32:47]
    v_mfma_f32_32x32x16_bf16 v[48:63], v[92:95], v[84:87], v[48:63]
G_cont_73:
    s_add_u32 s34, s34, 1
    s_cmp_ge_u32 s34, s54
    s_cbranch_scc1 G_end_69
    s_waitcnt lgkmcnt(0)
    v_mfma_f32_32x32x16_bf16 v[0:15], v[72:75], v[64:67], v[0:15]
    ds_read_b64_tr_b16 v[88:89], v104 offset:4096
    ds_read_b64_tr_b16 v[90:91], v104 offset:6144
    ds_read_b64_tr_b16 v[92:93], v105 offset:4096
    v_mfma_f32_32x32x16_bf16 v[16:31], v[76:79], v[64:67], v[16:31]
    ds_read_b64_tr_b16 v[94:95], v105 offset:6144
    ds_read_b128 v[80:83], v98 offset:4096
    ds_read_b128 v[84:87], v98 offset:5120
    v_mfma_f32_32x32x16_bf16 v[32:47], v[72:75], v[68:71], v[32:47]
    v_mfma_f32_32x32x16_bf16 v[48:63], v[76:79], v[68:71], v[48:63]
    s_add_u32 s35, s34, 4
    s_cmp_ge_u32 s35, s54
    s_cbranch_scc1 G_tail_74
    s_waitcnt vmcnt(8) lgkmcnt(0)
    s_barrier
    v_mfma_f32_32x32x16_bf16 v[0:15], v[88:91], v[80:83], v[0:15]
    ds_read_b64_tr_b16 v[72:73], v106 offset:0
    s_add_u32 m0, s30, 32768
    s_nop 0
    buffer_load_dwordx4 v108, s[4:7], s32 offen lds
    ds_read_b64_tr_b16 v[74:75], v106 offset:2048
    s_add_u32 m0, s30, 33792
    s_nop 0
    buffer_load_dwordx4 v109, s[4:7], s32 offen lds
    ds_read_b64_tr_b16 v[76:77], v107 offset:0
    v_mfma_f32_32x32x16_bf16 v[16:31], v[92:95], v[80:83], v[16:31]
    s_add_u32 m0, s31, 32768
    s_nop 0
    buffer_load_dwordx4 v110, s[8:11], s33 offen lds
    ds_read_b64_tr_b16 v[78:79], v107 offset:2048
    s_add_u32 m0, s31, 33792
    s_nop 0
    buffer_load_dwordx4 v111, s[8:11], s33 offen lds
    s_add_u32 s32, s32, 131072
    s_add_u32 s33, s33, 40960
    ds_read_b128 v[64:67], v99 offset:0
    ds_read_b128 v[68:71], v99 offset:1024
    v_mfma_f32_32x32x16_bf16 v[32:47], v[88:91], v[84:87], v[32:47]
    v_mfma_f32_32x32x16_bf16 v[48:63], v[92:95], v[84:87], v[48:63]
    s_branch G_cont_75
G_tail_74:
    s_waitcnt vmcnt(0) lgkmcnt(0)
    s_barrier
    v_mfma_f32_32x32x16_bf16 v[0:15], v[88:91], v[80:83], v[0:15]
    ds_read_b64_tr_b16 v[72:73], v106 offset:0
    ds_read_b64_tr_b16 v[74:75], v106 offset:2048
    ds_read_b64_tr_b16 v[76:77], v107 offset:0
    v_mfma_f32_32x32x16_bf16 v[16:31], v[92:95], v[80:83], v[16:31]
    ds_read_b64_tr_b16 v[78:79], v107 offset:2048
    ds_read_b128 v[64:67], v99 offset:0
    ds_read_b128 v[68:71], v99 offset:1024
    v_mfma_f32_32x32x16_bf16 v[32:47], v[88:91], v[84:87], v[32:47]
    v_mfma_f32_32x32x16_bf16 v[48:63], v[92:95], v[84:87], v[48:63]
G_cont_75:
    s_add_u32 s34, s34, 1
    s_cmp_ge_u32 s34, s54
    s_cbranch_scc1 G_end_69
    s_waitcnt lgkmcnt(0)
    v_mfma_f32_32x32x16_bf16 v[0:15], v[72:75], v[64:67], v[0:15]
    ds_read_b64_tr_b16 v[88:89], v106 offset:4096
    ds_read_b64_tr_b16 v[90:91], v106 offset:6144
    ds_read_b64_tr_b16 v[92:93], v107 offset:4096
    v_mfma_f32_32x32x16_bf16 v[16:31], v[76:79], v[64:67], v[16:31]
    ds_read_b64_tr_b16 v[94:95], v107 offset:6144
    ds_read_b128 v[80:83], v99 offset:4096
    ds_read_b128 v[84:87], v99 offset:5120
    v_mfma_f32_32x32x16_bf16 v[32:47], v[72:75], v[68:71], v[32:47]
    v_mfma_f32_32x32x16_bf16 v[48:63], v[76:79], v[68:71], v[48:63]
    s_add_u32 s35, s34, 4
    s_cmp_ge_u32 s35, s54
    s_cbranch_scc1 G_tail_76
    s_waitcnt vmcnt(8) lgkmcnt(0)
    s_barrier
    v_mfma_f32_32x32x16_bf16 v[0:15], v[88:91], v[80:83], v[0:15]
    ds_read_b64_tr_b16 v[72:73], v100 offset:0
    s_add_u32 m0, s30, 49152
    s_nop 0
    buffer_load_dwordx4 v108, s[4:7], s32 offen lds
    ds_read_b64_tr_b16 v[74:75], v100 offset:2048
    s_add_u32 m0, s30, 50176
    s_nop 0
    buffer_load_dwordx4 v109, s[4:7], s32 offen lds
    ds_read_b64_tr_b16 v[76:77], v101 offset:0
    v_mfma_f32_32x32x16_bf16 v[16:31], v[92:95], v[80:83], v[16:31]
    s_add_u32 m0, s31, 49152
    s_nop 0
    buffer_load_dwordx4 v110, s[8:11], s33 offen lds
    ds_read_b64_tr_b16 v[78:79], v101 offset:2048
    s_add_u32 m0, s31, 50176
    s_nop 0
    buffer_load_dwordx4 v111, s[8:11], s33 offen lds
    s_add_u32 s32, s32, 131072
    s_add_u32 s33, s33, 40960
    ds_read_b128 v[64:67], v96 offset:0
    ds_read_b128 v[68:71], v96 offset:1024
    v_mfma_f32_32x32x16_bf16 v[32:47], v[88:91], v[84:87], v[32:47]
    v_mfma_f32_32x32x16_bf16 v[48:63], v[92:95], v[84:87], v[48:63]
    s_branch G_cont_77
G_tail_76:
    s_waitcnt vmcnt(0) lgkmcnt(0)
    s_barrier
    v_mfma_f32_32x32x16_bf16 v[0:15], v[88:91], v[80:83], v[0:15]
    ds_read_b64_tr_b16 v[72:73], v100 offset:0
    ds_read_b64_tr_b16 v[74:75], v100 offset:2048
    ds_read_b64_tr_b16 v[76:77], v101 offset:0
    v_mfma_f32_32x32x16_bf16 v[16:31], v[92:95], v[80:83], v[16:31]
    ds_read_b64_tr_b16 v[78:79], v101 offset:2048
    ds_read_b128 v[64:67], v96 offset:0
    ds_read_b128 v[68:71], v96 offset:1024
    v_mfma_f32_32x32x16_bf16 v[32:47], v[88:91], v[84:87], v[32:47]
    v_mfma_f32_32x32x16_bf16 v[48:63], v[92:95], v[84:87], v[48:63]
G_cont_77:
    s_add_u32 s34, s34, 1
    s_cmp_ge_u32 s34, s54
    s_cbranch_scc1 G_end_69
    s_branch G_loop_68
G_end_69:
    s_waitcnt lgkmcnt(0)
    s_cmp_lg_u32 s37, 2
    s_cbranch_scc1 F_ep_67
    s_barrier
    s_add_u32 s4, s52, 0x4000000
    s_addc_u32 s5, s53, 0
    s_and_b32 s5, s5, 0xffff
    s_mov_b32 s6, 0x21c000
    s_mov_b32 s7, 0x00020000
    s_mov_b32 s8, s44
    s_and_b32 s9, s45, 0xffff
    s_mov_b32 s10, 0x6c0000
    s_mov_b32 s11, 0x00020000
    v_and_b32 v112, 63, v140
    v_lshrrev_b32 v113, 6, v140
    s_nop 0
    v_readfirstlane_b32 s24, v113
    s_lshr_b32 s27, s24, 1
    s_and_b32 s28, s24, 1
    v_and_b32 v114, 31, v112
    s_mul_i32 s25, s28, 64
    v_add_u32 v114, s25, v114
    v_lshlrev_b32 v114, 5, v114
    v_lshrrev_b32 v115, 5, v112
    v_bfe_u32 v116, v112, 3, 1
    v_xor_b32 v116, v115, v116
    v_lshl_add_u32 v96, v116, 4, v114
    v_add_u32 v97, 16384, v96
    v_add_u32 v98, 32768, v96
    v_add_u32 v99, 49152, v96
    v_bfe_u32 v117, v112, 2, 2
    v_lshl_add_u32 v118, v115, 2, v117
    v_mul_u32_u24 v118, 256, v118
    v_bfe_u32 v119, v112, 4, 1
    v_lshlrev_b32 v119, 1, v119
    v_bfe_u32 v120, v112, 1, 1
    v_add_u32 v119, v119, v120
    s_mul_i32 s25, s27, 8
    v_add_u32 v119, s25, v119
    v_lshlrev_b32 v120, 2, v117
    v_and_b32 v121, 1, v112
    v_lshlrev_b32 v121, 3, v121
    v_add_u32 v118, v118, v121
    v_add_u32 v118, 8192, v118
    v_add_u32 v121, 0, v119
    v_xor_b32 v121, v121, v120
    v_lshl_add_u32 v100, v121, 4, v118
    v_add_u32 v102, 16384, v100
    v_add_u32 v104, 32768, v100
    v_add_u32 v106, 49152, v100
    v_add_u32 v121, 4, v119
    v_xor_b32 v121, v121, v120
    v_lshl_add_u32 v101, v121, 4, v118
    v_add_u32 v103, 16384, v101
    v_add_u32 v105, 32768, v101
    v_add_u32 v107, 49152, v101
    s_mul_i32 s30, s24, 2048
    s_mul_i32 s31, s24, 2048
    s_add_u32 s31, s31, 8192
    v_lshlrev_b32 v116, 4, v112
    s_mul_i32 s25, s24, 2
    s_add_u32 s25, s25, 0
    s_lshr_b32 s26, s25, 2
    s_and_b32 s25, s25, 3
    s_mul_i32 s26, s26, 640
    s_lshl_b32 s25, s25, 5
    s_add_u32 s25, s25, s26
    s_add_u32 s25, s25, s23
    s_lshl_b32 s25, s25, 5
    v_add_u32 v108, s25, v116
    s_mul_i32 s25, s24, 2
    s_add_u32 s25, s25, 1
    s_lshr_b32 s26, s25, 2
    s_and_b32 s25, s25, 3
    s_mul_i32 s26, s26, 640
    s_lshl_b32 s25, s25, 5
    s_add_u32 s25, s25, s26
    s_add_u32 s25, s25, s23
    s_lshl_b32 s25, s25, 5
    v_add_u32 v109, s25, v116
    s_mov_b32 s26, 4096
    s_lshl_b32 s29, s22, 1
    s_mul_i32 s25, s24, 8
    s_add_u32 s25, s25, 0
    v_lshrrev_b32 v116, 4, v112
    v_add_u32 v116, s25, v116
    v_and_b32 v117, 3, v116
    v_lshlrev_b32 v117, 2, v117
    v_and_b32 v118, 15, v112
    v_xor_b32 v117, v117, v118
    v_mul_lo_u32 v116, v116, s26
    v_lshl_add_u32 v116, v117, 4, v116
    v_add_u32 v110, s29, v116
    s_mul_i32 s25, s24, 8
    s_add_u32 s25, s25, 4
    v_lshrrev_b32 v116, 4, v112
    v_add_u32 v116, s25, v116
    v_and_b32 v117, 3, v116
    v_lshlrev_b32 v117, 2, v117
    v_and_b32 v118, 15, v112
    v_xor_b32 v117, v117, v118
    v_mul_lo_u32 v116, v116, s26
    v_lshl_add_u32 v116, v117, 4, v116
    v_add_u32 v111, s29, v116
    s_mov_b32 s32, 0
    s_mov_b32 s33, 0
    s_add_u32 m0, s30, 0
    s_nop 0
    buffer_load_dwordx4 v108, s[4:7], s32 offen lds
    s_add_u32 m0, s30, 1024
    s_nop 0
    buffer_load_dwordx4 v109, s[4:7], s32 offen lds
    s_add_u32 m0, s31, 0
    s_nop 0
    buffer_load_dwordx4 v110, s[8:11], s33 offen lds
    s_add_u32 m0, s31, 1024
    s_nop 0
    buffer_load_dwordx4 v111, s[8:11], s33 offen lds
    s_add_u32 s32, s32, 40960
    s_add_u32 s33, s33, 131072
    s_add_u32 m0, s30, 16384
    s_nop 0
    buffer_load_dwordx4 v108, s[4:7], s32 offen lds
    s_add_u32 m0, s30, 17408
    s_nop 0
    buffer_load_dwordx4 v109, s[4:7], s32 offen lds
    s_add_u32 m0, s31, 16384
    s_nop 0
    buffer_load_dwordx4 v110, s[8:11], s33 offen lds
    s_add_u32 m0, s31, 17408
    s_nop 0
    buffer_load_dwordx4 v111, s[8:11], s33 offen lds
    s_add_u32 s32, s32, 40960
    s_add_u32 s33, s33, 131072
    s_add_u32 m0, s30, 32768
    s_nop 0
    buffer_load_dwordx4 v108, s[4:7], s32 offen lds
    s_add_u32 m0, s30, 33792
    s_nop 0
    buffer_load_dwordx4 v109, s[4:7], s32 offen lds
    s_add_u32 m0, s31, 32768
    s_nop 0
    buffer_load_dwordx4 v110, s[8:11], s33 offen lds
    s_add_u32 m0, s31, 33792
    s_nop 0
    buffer_load_dwordx4 v111, s[8:11], s33 offen lds
    s_add_u32 s32, s32, 40960
    s_add_u32 s33, s33, 131072
    s_add_u32 m0, s30, 49152
    s_nop 0
    buffer_load_dwordx4 v108, s[4:7], s32 offen lds
    s_add_u32 m0, s30, 50176
    s_nop 0
    buffer_load_dwordx4 v109, s[4:7], s32 offen lds
    s_add_u32 m0, s31, 49152
    s_nop 0
    buffer_load_dwordx4 v110, s[8:11], s33 offen lds
    s_add_u32 m0, s31, 50176
    s_nop 0
    buffer_load_dwordx4 v111, s[8:11], s33 offen lds
    s_add_u32 s32, s32, 40960
    s_add_u32 s33, s33, 131072
    s_waitcnt vmcnt(12)
    s_barrier
    ds_read_b64_tr_b16 v[72:73], v100 offset:0
    ds_read_b64_tr_b16 v[74:75], v100 offset:2048
    ds_read_b64_tr_b16 v[76:77], v101 offset:0
    ds_read_b64_tr_b16 v[78:79], v101 offset:2048
    ds_read_b128 v[64:67], v96 offset:0
    ds_read_b128 v[68:71], v96 offset:1024
    s_mov_b32 s34, 0
G_loop_78:
    s_waitcnt lgkmcnt(0)
    v_mfma_f32_32x32x16_bf16 v[0:15], v[64:67], v[72:75], v[0:15]
    ds_read_b64_tr_b16 v[88:89], v100 offset:4096
    ds_read_b64_tr_b16 v[90:91], v100 offset:6144
    ds_read_b64_tr_b16 v[92:93], v101 offset:4096
    v_mfma_f32_32x32x16_bf16 v[32:47], v[64:67], v[76:79], v[32:47]
    ds_read_b64_tr_b16 v[94:95], v101 offset:6144
    ds_read_b128 v[80:83], v96 offset:4096
    ds_read_b128 v[84:87], v96 offset:5120
    v_mfma_f32_32x32x16_bf16 v[16:31], v[68:71], v[72:75], v[16:31]
    v_mfma_f32_32x32x16_bf16 v[48:63], v[68:71], v[76:79], v[48:63]
    s_add_u32 s35, s34, 4
    s_cmp_ge_u32 s35, 54
    s_cbranch_scc1 G_tail_80
    s_waitcnt vmcnt(8) lgkmcnt(0)
    s_barrier
    v_mfma_f32_32x32x16_bf16 v[0:15], v[80:83], v[88:91], v[0:15]
    ds_read_b64_tr_b16 v[72:73], v102 offset:0
    s_add_u32 m0, s30, 0
    s_nop 0
    buffer_load_dwordx4 v108, s[4:7], s32 offen lds
    ds_read_b64_tr_b16 v[74:75], v102 offset:2048
    s_add_u32 m0, s30, 1024
    s_nop 0
    buffer_load_dwordx4 v109, s[4:7], s32 offen lds
    ds_read_b64_tr_b16 v[76:77], v103 offset:0
    v_mfma_f32_32x32x16_bf16 v[32:47], v[80:83], v[92:95], v[32:47]
    s_add_u32 m0, s31, 0
    s_nop 0
    buffer_load_dwordx4 v110, s[8:11], s33 offen lds
    ds_read_b64_tr_b16 v[78:79], v103 offset:2048
    s_add_u32 m0, s31, 1024
    s_nop 0
    buffer_load_dwordx4 v111, s[8:11], s33 offen lds
    s_add_u32 s32, s32, 40960
    s_add_u32 s33, s33, 131072
    ds_read_b128 v[64:67], v97 offset:0
    ds_read_b128 v[68:71], v97 offset:1024
    v_mfma_f32_32x32x16_bf16 v[16:31], v[84:87], v[88:91], v[16:31]
    v_mfma_f32_32x32x16_bf16 v[48:63], v[84:87], v[92:95], v[48:63]
    s_branch G_cont_81
G_tail_80:
    s_waitcnt vmcnt(0) lgkmcnt(0)
    s_barrier
    v_mfma_f32_32x32x16_bf16 v[0:15], v[80:83], v[88:91], v[0:15]
    ds_read_b64_tr_b16 v[72:73], v102 offset:0
    ds_read_b64_tr_b16 v[74:75], v102 offset:2048
    ds_read_b64_tr_b16 v[76:77], v103 offset:0
    v_mfma_f32_32x32x16_bf16 v[32:47], v[80:83], v[92:95], v[32:47]
    ds_read_b64_tr_b16 v[78:79], v103 offset:2048
    ds_read_b128 v[64:67], v97 offset:0
    ds_read_b128 v[68:71], v97 offset:1024
    v_mfma_f32_32x32x16_bf16 v[16:31], v[84:87], v[88:91], v[16:31]
    v_mfma_f32_32x32x16_bf16 v[48:63], v[84:87], v[92:95], v[48:63]
G_cont_81:
    s_add_u32 s34, s34, 1
    s_cmp_ge_u32 s34, 54
    s_cbranch_scc1 G_end_79
    s_waitcnt lgkmcnt(0)
    v_mfma_f32_32x32x16_bf16 v[0:15], v[64:67], v[72:75], v[0:15]
    ds_read_b64_tr_b16 v[88:89], v102 offset:4096
    ds_read_b64_tr_b16 v[90:91], v102 offset:6144
    ds_read_b64_tr_b16 v[92:93], v103 offset:4096
    v_mfma_f32_32x32x16_bf16 v[32:47], v[64:67], v[76:79], v[32:47]
    ds_read_b64_tr_b16 v[94:95], v103 offset:6144
    ds_read_b128 v[80:83], v97 offset:4096
    ds_read_b128 v[84:87], v97 offset:5120
    v_mfma_f32_32x32x16_bf16 v[16:31], v[68:71], v[72:75], v[16:31]
    v_mfma_f32_32x32x16_bf16 v[48:63], v[68:71], v[76:79], v[48:63]
    s_add_u32 s35, s34, 4
    s_cmp_ge_u32 s35, 54
    s_cbranch_scc1 G_tail_82
    s_waitcnt vmcnt(8) lgkmcnt(0)
    s_barrier
    v_mfma_f32_32x32x16_bf16 v[0:15], v[80:83], v[88:91], v[0:15]
    ds_read_b64_tr_b16 v[72:73], v104 offset:0
    s_add_u32 m0, s30, 16384
    s_nop 0
    buffer_load_dwordx4 v108, s[4:7], s32 offen lds
    ds_read_b64_tr_b16 v[74:75], v104 offset:2048
    s_add_u32 m0, s30, 17408
    s_nop 0
    buffer_load_dwordx4 v109, s[4:7], s32 offen lds
    ds_read_b64_tr_b16 v[76:77], v105 offset:0
    v_mfma_f32_32x32x16_bf16 v[32:47], v[80:83], v[92:95], v[32:47]
    s_add_u32 m0, s31, 16384
    s_nop 0
    buffer_load_dwordx4 v110, s[8:11], s33 offen lds
    ds_read_b64_tr_b16 v[78:79], v105 offset:2048
    s_add_u32 m0, s31, 17408
    s_nop 0
    buffer_load_dwordx4 v111, s[8:11], s33 offen lds
    s_add_u32 s32, s32, 40960
    s_add_u32 s33, s33, 131072
    ds_read_b128 v[64:67], v98 offset:0
    ds_read_b128 v[68:71], v98 offset:1024
    v_mfma_f32_32x32x16_bf16 v[16:31], v[84:87], v[88:91], v[16:31]
    v_mfma_f32_32x32x16_bf16 v[48:63], v[84:87], v[92:95], v[48:63]
    s_branch G_cont_83
G_tail_82:
    s_waitcnt vmcnt(0) lgkmcnt(0)
    s_barrier
    v_mfma_f32_32x32x16_bf16 v[0:15], v[80:83], v[88:91], v[0:15]
    ds_read_b64_tr_b16 v[72:73], v104 offset:0
    ds_read_b64_tr_b16 v[74:75], v104 offset:2048
    ds_read_b64_tr_b16 v[76:77], v105 offset:0
    v_mfma_f32_32x32x16_bf16 v[32:47], v[80:83], v[92:95], v[32:47]
    ds_read_b64_tr_b16 v[78:79], v105 offset:2048
    ds_read_b128 v[64:67], v98 offset:0
    ds_read_b128 v[68:71], v98 offset:1024
    v_mfma_f32_32x32x16_bf16 v[16:31], v[84:87], v[88:91], v[16:31]
    v_mfma_f32_32x32x16_bf16 v[48:63], v[84:87], v[92:95], v[48:63]
G_cont_83:
    s_add_u32 s34, s34, 1
    s_cmp_ge_u32 s34, 54
    s_cbranch_scc1 G_end_79
    s_waitcnt lgkmcnt(0)
    v_mfma_f32_32x32x16_bf16 v[0:15], v[64:67], v[72:75], v[0:15]
    ds_read_b64_tr_b16 v[88:89], v104 offset:4096
    ds_read_b64_tr_b16 v[90:91], v104 offset:6144
    ds_read_b64_tr_b16 v[92:93], v105 offset:4096
    v_mfma_f32_32x32x16_bf16 v[32:47], v[64:67], v[76:79], v[32:47]
    ds_read_b64_tr_b16 v[94:95], v105 offset:6144
    ds_read_b128 v[80:83], v98 offset:4096
    ds_read_b128 v[84:87], v98 offset:5120
    v_mfma_f32_32x32x16_bf16 v[16:31], v[68:71], v[72:75], v[16:31]
    v_mfma_f32_32x32x16_bf16 v[48:63], v[68:71], v[76:79], v[48:63]
    s_add_u32 s35, s34, 4
    s_cmp_ge_u32 s35, 54
    s_cbranch_scc1 G_tail_84
    s_waitcnt vmcnt(8) lgkmcnt(0)
    s_barrier
    v_mfma_f32_32x32x16_bf16 v[0:15], v[80:83], v[88:91], v[0:15]
    ds_read_b64_tr_b16 v[72:73], v106 offset:0
    s_add_u32 m0, s30, 32768
    s_nop 0
    buffer_load_dwordx4 v108, s[4:7], s32 offen lds
    ds_read_b64_tr_b16 v[74:75], v106 offset:2048
    s_add_u32 m0, s30, 33792
    s_nop 0
    buffer_load_dwordx4 v109, s[4:7], s32 offen lds
    ds_read_b64_tr_b16 v[76:77], v107 offset:0
    v_mfma_f32_32x32x16_bf16 v[32:47], v[80:83], v[92:95], v[32:47]
    s_add_u32 m0, s31, 32768
    s_nop 0
    buffer_load_dwordx4 v110, s[8:11], s33 offen lds
    ds_read_b64_tr_b16 v[78:79], v107 offset:2048
    s_add_u32 m0, s31, 33792
    s_nop 0
    buffer_load_dwordx4 v111, s[8:11], s33 offen lds
    s_add_u32 s32, s32, 40960
    s_add_u32 s33, s33, 131072
    ds_read_b128 v[64:67], v99 offset:0
    ds_read_b128 v[68:71], v99 offset:1024
    v_mfma_f32_32x32x16_bf16 v[16:31], v[84:87], v[88:91], v[16:31]
    v_mfma_f32_32x32x16_bf16 v[48:63], v[84:87], v[92:95], v[48:63]
    s_branch G_cont_85
G_tail_84:
    s_waitcnt vmcnt(0) lgkmcnt(0)
    s_barrier
    v_mfma_f32_32x32x16_bf16 v[0:15], v[80:83], v[88:91], v[0:15]
    ds_read_b64_tr_b16 v[72:73], v106 offset:0
    ds_read_b64_tr_b16 v[74:75], v106 offset:2048
    ds_read_b64_tr_b16 v[76:77], v107 offset:0
    v_mfma_f32_32x32x16_bf16 v[32:47], v[80:83], v[92:95], v[32:47]
    ds_read_b64_tr_b16 v[78:79], v107 offset:2048
    ds_read_b128 v[64:67], v99 offset:0
    ds_read_b128 v[68:71], v99 offset:1024
    v_mfma_f32_32x32x16_bf16 v[16:31], v[84:87], v[88:91], v[16:31]
    v_mfma_f32_32x32x16_bf16 v[48:63], v[84:87], v[92:95], v[48:63]
G_cont_85:
    s_add_u32 s34, s34, 1
    s_cmp_ge_u32 s34, 54
    s_cbranch_scc1 G_end_79
    s_waitcnt lgkmcnt(0)
    v_mfma_f32_32x32x16_bf16 v[0:15], v[64:67], v[72:75], v[0:15]
    ds_read_b64_tr_b16 v[88:89], v106 offset:4096
    ds_read_b64_tr_b16 v[90:91], v106 offset:6144
    ds_read_b64_tr_b16 v[92:93], v107 offset:4096
    v_mfma_f32_32x32x16_bf16 v[32:47], v[64:67], v[76:79], v[32:47]
    ds_read_b64_tr_b16 v[94:95], v107 offset:6144
    ds_read_b128 v[80:83], v99 offset:4096
    ds_read_b128 v[84:87], v99 offset:5120
    v_mfma_f32_32x32x16_bf16 v[16:31], v[68:71], v[72:75], v[16:31]
    v_mfma_f32_32x32x16_bf16 v[48:63], v[68:71], v[76:79], v[48:63]
    s_add_u32 s35, s34, 4
    s_cmp_ge_u32 s35, 54
    s_cbranch_scc1 G_tail_86
    s_waitcnt vmcnt(8) lgkmcnt(0)
    s_barrier
    v_mfma_f32_32x32x16_bf16 v[0:15], v[80:83], v[88:91], v[0:15]
    ds_read_b64_tr_b16 v[72:73], v100 offset:0
    s_add_u32 m0, s30, 49152
    s_nop 0
    buffer_load_dwordx4 v108, s[4:7], s32 offen lds
    ds_read_b64_tr_b16 v[74:75], v100 offset:2048
    s_add_u32 m0, s30, 50176
    s_nop 0
    buffer_load_dwordx4 v109, s[4:7], s32 offen lds
    ds_read_b64_tr_b16 v[76:77], v101 offset:0
    v_mfma_f32_32x32x16_bf16 v[32:47], v[80:83], v[92:95], v[32:47]
    s_add_u32 m0, s31, 49152
    s_nop 0
    buffer_load_dwordx4 v110, s[8:11], s33 offen lds
    ds_read_b64_tr_b16 v[78:79], v101 offset:2048
    s_add_u32 m0, s31, 50176
    s_nop 0
    buffer_load_dwordx4 v111, s[8:11], s33 offen lds
    s_add_u32 s32, s32, 40960
    s_add_u32 s33, s33, 131072
    ds_read_b128 v[64:67], v96 offset:0
    ds_read_b128 v[68:71], v96 offset:1024
    v_mfma_f32_32x32x16_bf16 v[16:31], v[84:87], v[88:91], v[16:31]
    v_mfma_f32_32x32x16_bf16 v[48:63], v[84:87], v[92:95], v[48:63]
    s_branch G_cont_87
G_tail_86:
    s_waitcnt vmcnt(0) lgkmcnt(0)
    s_barrier
    v_mfma_f32_32x32x16_bf16 v[0:15], v[80:83], v[88:91], v[0:15]
    ds_read_b64_tr_b16 v[72:73], v100 offset:0
    ds_read_b64_tr_b16 v[74:75], v100 offset:2048
    ds_read_b64_tr_b16 v[76:77], v101 offset:0
    v_mfma_f32_32x32x16_bf16 v[32:47], v[80:83], v[92:95], v[32:47]
    ds_read_b64_tr_b16 v[78:79], v101 offset:2048
    ds_read_b128 v[64:67], v96 offset:0
    ds_read_b128 v[68:71], v96 offset:1024
    v_mfma_f32_32x32x16_bf16 v[16:31], v[84:87], v[88:91], v[16:31]
    v_mfma_f32_32x32x16_bf16 v[48:63], v[84:87], v[92:95], v[48:63]
G_cont_87:
    s_add_u32 s34, s34, 1
    s_cmp_ge_u32 s34, 54
    s_cbranch_scc1 G_end_79
    s_branch G_loop_78
G_end_79:
    s_waitcnt lgkmcnt(0)
F_ep_67:
    s_nop 15
    s_add_u32 s12, s52, 0x6000000
    s_addc_u32 s13, s53, 0
    s_and_b32 s13, s13, 0xffff
    s_mov_b32 s14, 0xf00000
    s_mov_b32 s15, 0x00020000
    v_and_b32 v114, 31, v112
    s_lshl_b32 s25, s27, 6
    s_add_u32 s25, s25, s22
    v_add_u32 v114, s25, v114
    v_lshlrev_b32 v114, 5, v114
    v_lshrrev_b32 v115, 5, v112
    v_lshl_add_u32 v114, v115, 4, v114
    s_lshl_b32 s25, s28, 6
    s_add_u32 s25, s25, s23
    s_lshr_b32 s25, s25, 3
    s_lshl_b32 s25, s25, 16
    s_mul_i32 s26, s37, 5242880
    s_add_u32 s25, s25, s26
    v_add_u32 v114, s25, v114
    s_mov_b32 s39, 0
    buffer_store_dwordx4 v[0:3], v114, s[12:15], s39 offen offset:0
    s_mov_b32 s39, 65536
    buffer_store_dwordx4 v[4:7], v114, s[12:15], s39 offen offset:0
    s_mov_b32 s39, 131072
    buffer_store_dwordx4 v[8:11], v114, s[12:15], s39 offen offset:0
    s_mov_b32 s39, 196608
    buffer_store_dwordx4 v[12:15], v114, s[12:15], s39 offen offset:0
    s_mov_b32 s39, 262144
    buffer_store_dwordx4 v[16:19], v114, s[12:15], s39 offen offset:0
    s_mov_b32 s39, 327680
    buffer_store_dwordx4 v[20:23], v114, s[12:15], s39 offen offset:0
    s_mov_b32 s39, 393216
    buffer_store_dwordx4 v[24:27], v114, s[12:15], s39 offen offset:0
    s_mov_b32 s39, 458752
    buffer_store_dwordx4 v[28:31], v114, s[12:15], s39 offen offset:0
    s_mov_b32 s39, 0
    buffer_store_dwordx4 v[32:35], v114, s[12:15], s39 offen offset:1024
    s_mov_b32 s39, 65536
    buffer_store_dwordx4 v[36:39], v114, s[12:15], s39 offen offset:1024
    s_mov_b32 s39, 131072
    buffer_store_dwordx4 v[40:43], v114, s[12:15], s39 offen offset:1024
    s_mov_b32 s39, 196608
    buffer_store_dwordx4 v[44:47], v114, s[12:15], s39 offen offset:1024
    s_mov_b32 s39, 262144
    buffer_store_dwordx4 v[48:51], v114, s[12:15], s39 offen offset:1024
    s_mov_b32 s39, 327680
    buffer_store_dwordx4 v[52:55], v114, s[12:15], s39 offen offset:1024
    s_mov_b32 s39, 393216
    buffer_store_dwordx4 v[56:59], v114, s[12:15], s39 offen offset:1024
    s_mov_b32 s39, 458752
    buffer_store_dwordx4 v[60:63], v114, s[12:15], s39 offen offset:1024
F_done_66:
    s_endpgm
.globl comb_kernel
.type comb_kernel,@function
.p2align 8
comb_kernel:
    s_load_dwordx2 s[40:41], s[0:1], 0
    s_load_dwordx4 s[44:47], s[0:1], 80
    s_load_dwordx2 s[52:53], s[0:1], 104
    s_cmp_ge_u32 s2, 640
    s_cbranch_scc1 C_done_88
    s_mul_hi_u32 s3, s2, 0x1999999a
    s_mul_i32 s4, s3, 10
    s_sub_u32 s4, s2, s4
    v_lshrrev_b32 v1, 3, v0
    s_lshl_b32 s3, s3, 5
    v_add_u32 v1, s3, v1
    v_and_b32 v2, 7, v0
    s_lshl_b32 s4, s4, 3
    v_add_u32 v2, s4, v2
    v_lshlrev_b32 v3, 16, v2
    v_lshl_add_u32 v3, v1, 5, v3
    v_mul_u32_u24 v4, 1280, v1
    v_lshl_add_u32 v4, v2, 4, v4
    v_lshlrev_b32 v5, 1, v1
    s_waitcnt lgkmcnt(0)
    s_add_u32 s8, s52, 0x6000000
    s_addc_u32 s9, s53, 0
    s_and_b32 s9, s9, 0xffff
    s_mov_b32 s10, 0xf00000
    s_mov_b32 s11, 0x00020000
    s_mov_b32 s12, s40
    s_and_b32 s13, s41, 0xffff
    s_mov_b32 s14, 0x280000
    s_mov_b32 s15, 0x00020000
    s_mov_b32 s16, s44
    s_and_b32 s17, s45, 0xffff
    s_mov_b32 s18, 0x1000
    s_mov_b32 s19, 0x00020000
    s_mov_b32 s20, s46
    s_and_b32 s21, s47, 0xffff
    s_mov_b32 s22, 0x280000
    s_mov_b32 s23, 0x00020000
    s_mov_b32 s5, 5242880
    s_mov_b32 s6, 10485760
    buffer_load_dwordx4 v[8:11], v3, s[8:11], 0 offen
    buffer_load_dwordx4 v[12:15], v3, s[8:11], 0 offen offset:16
    buffer_load_dwordx4 v[16:19], v3, s[8:11], s5 offen
    buffer_load_dwordx4 v[20:23], v3, s[8:11], s5 offen offset:16
    buffer_load_dwordx4 v[24:27], v3, s[8:11], s6 offen
    buffer_load_dwordx4 v[28:31], v3, s[8:11], s6 offen offset:16
    buffer_load_dwordx4 v[32:35], v4, s[12:15], 0 offen
    buffer_load_ushort v36, v5, s[16:19], 0 offen
    s_waitcnt vmcnt(0)
    v_lshlrev_b32 v36, 16, v36
    v_lshlrev_b32 v40, 16, v32
    v_and_b32 v41, 0xffff0000, v32
    v_lshlrev_b32 v42, 16, v33
    v_and_b32 v43, 0xffff0000, v33
    v_lshlrev_b32 v44, 16, v34
    v_and_b32 v45, 0xffff0000, v34
    v_lshlrev_b32 v46, 16, v35
    v_and_b32 v47, 0xffff0000, v35
    v_add_f32 v8, v8, v16
    v_add_f32 v8, v8, v24
    v_add_f32 v8, v8, v36
    v_add_f32 v8, v8, v40
    v_add_f32 v9, v9, v17
    v_add_f32 v9, v9, v25
    v_add_f32 v9, v9, v36
    v_add_f32 v9, v9, v41
    v_add_f32 v10, v10, v18
    v_add_f32 v10, v10, v26
    v_add_f32 v10, v10, v36
    v_add_f32 v10, v10, v42
    v_add_f32 v11, v11, v19
    v_add_f32 v11, v11, v27
    v_add_f32 v11, v11, v36
    v_add_f32 v11, v11, v43
    v_add_f32 v12, v12, v20
    v_add_f32 v12, v12, v28
    v_add_f32 v12, v12, v36
    v_add_f32 v12, v12, v44
    v_add_f32 v13, v13, v21
    v_add_f32 v13, v13, v29
    v_add_f32 v13, v13, v36
    v_add_f32 v13, v13, v45
    v_add_f32 v14, v14, v22
    v_add_f32 v14, v14, v30
    v_add_f32 v14, v14, v36
    v_add_f32 v14, v14, v46
    v_add_f32 v15, v15, v23
    v_add_f32 v15, v15, v31
    v_add_f32 v15, v15, v36
    v_add_f32 v15, v15, v47
    v_cvt_pk_bf16_f32 v48, v8, v9
    v_cvt_pk_bf16_f32 v49, v10, v11
    v_cvt_pk_bf16_f32 v50, v12, v13
    v_cvt_pk_bf16_f32 v51, v14, v15
    buffer_store_dwordx4 v[48:51], v4, s[20:23], 0 offen
C_done_88:
    s_endpgm
.section .rodata,"a"
.p2align 6
.amdhsa_kernel ln_kernel
  .amdhsa_next_free_vgpr 32
  .amdhsa_next_free_sgpr 102
  .amdhsa_accum_offset 32
  .amdhsa_group_segment_fixed_size 0
  .amdhsa_kernarg_size 112
  .amdhsa_user_sgpr_count 2
  .amdhsa_user_sgpr_kernarg_segment_ptr 1
  .amdhsa_system_sgpr_workgroup_id_x 1
.end_amdhsa_kernel
.p2align 6
.amdhsa_kernel gemm1_kernel
  .amdhsa_next_free_vgpr 221
  .amdhsa_next_free_sgpr 102
  .amdhsa_accum_offset 224
  .amdhsa_group_segment_fixed_size 0
  .amdhsa_kernarg_size 112
  .amdhsa_user_sgpr_count 2
  .amdhsa_user_sgpr_kernarg_segment_ptr 1
  .amdhsa_system_sgpr_workgroup_id_x 1
.end_amdhsa_kernel
.p2align 6
.amdhsa_kernel attn_kernel
  .amdhsa_next_free_vgpr 256
  .amdhsa_next_free_sgpr 102
  .amdhsa_accum_offset 256
  .amdhsa_group_segment_fixed_size 0
  .amdhsa_kernarg_size 112
  .amdhsa_user_sgpr_count 2
  .amdhsa_user_sgpr_kernarg_segment_ptr 1
  .amdhsa_system_sgpr_workgroup_id_x 1
.end_amdhsa_kernel
.p2align 6
.amdhsa_kernel final_kernel
  .amdhsa_next_free_vgpr 141
  .amdhsa_next_free_sgpr 102
  .amdhsa_accum_offset 144
  .amdhsa_group_segment_fixed_size 0
  .amdhsa_kernarg_size 112
  .amdhsa_user_sgpr_count 2
  .amdhsa_user_sgpr_kernarg_segment_ptr 1
  .amdhsa_system_sgpr_workgroup_id_x 1
.end_amdhsa_kernel
.p2align 6
.amdhsa_kernel comb_kernel
  .amdhsa_next_free_vgpr 56
  .amdhsa_next_free_sgpr 102
  .amdhsa_accum_offset 56
  .amdhsa_group_segment_fixed_size 0
  .amdhsa_kernarg_size 112
  .amdhsa_user_sgpr_count 2
  .amdhsa_user_sgpr_kernarg_segment_ptr 1
  .amdhsa_system_sgpr_workgroup_id_x 1
.end_amdhsa_kernel
```
